```python
import torch

def _softmax(x, axis=-1):
    return torch.softmax(x, dim=axis)
def _gelu(x):
    return torch.nn.functional.gelu(x, approximate="tanh")
def _silu(x):
    return torch.nn.functional.silu(x)
def _sigmoid(x):
    return torch.sigmoid(x)
def _layernorm(x, axis=-1, eps=1e-5):
    m = x.mean(dim=axis, keepdim=True)
    v = x.var(dim=axis, keepdim=True, unbiased=False)
    return (x - m) / torch.sqrt(v + eps)
def _scatter_add(tgt, idx, src, axis=0):
    return tgt.clone().index_add_(axis, idx, src)
def _segment_sum(src, seg, n):
    out = torch.zeros((n,) + src.shape[1:], dtype=src.dtype)
    return out.index_add_(0, seg, src)
def _pad(x, pw):
    flat = tuple(v for pair in reversed(pw) for v in pair)
    return torch.nn.functional.pad(x, flat)

kernel_name = 'recurrent_scan__linear_kernel_hedgehog__dense_activation_silu__prompt'

def setup_inputs():

    _w = (lambda a: (lambda t: t.to(torch.bfloat16) if t.is_floating_point() else t)(torch.as_tensor(a)))
    def _A_setup():
        B, S, D, H = 1, 2048, 512, 32
        Dh = D // H
        return {
            "x": _w((lambda *s: torch.randn(*s, dtype=torch.bfloat16) * 0.05)(B, S, D)),
            "wqkv": _w((lambda *s: torch.randn(*s, dtype=torch.bfloat16) * 0.4)(D, 3 * D)),
            "w_phi": _w((lambda *s: torch.randn(*s, dtype=torch.bfloat16) * 0.4)(H, Dh, Dh) * (Dh ** -0.5)),
            "wo": _w((lambda *s: torch.randn(*s, dtype=torch.bfloat16) * 0.2)(D, D)),
        }
    _A_in = _A_setup()

    def _B_setup():
        B, S, D, F = 1, 2048, 512, 1792
        return {
            "x": _w((lambda *s: torch.randn(*s, dtype=torch.bfloat16) * 0.05)(B, S, D)),
            "w1": _w((lambda *s: torch.randn(*s, dtype=torch.bfloat16) * 0.4)(D, F) * (D ** -0.5)),
            "w2": _w((lambda *s: torch.randn(*s, dtype=torch.bfloat16) * 0.1)(F, D) * (F ** -0.5)),
        }
    _B_in = _B_setup()

    return {
        "A_x": _A_in["x"],
        "A_wqkv": _A_in["wqkv"],
        "A_w_phi": _A_in["w_phi"],
        "A_wo": _A_in["wo"],
        "B_x": _B_in["x"],
        "B_w1": _B_in["w1"],
        "B_w2": _B_in["w2"],
    }

def reference(A_x, A_wqkv, A_w_phi, A_wo, B_x, B_w1, B_w2):
    def _A_ref(x, wqkv, w_phi, wo):
        B, S, D = x.shape
        H = 32; Dh = D // H
        qkv = (lambda x, *d: x.permute(*d))((x @ wqkv).reshape(B, S, 3, H, Dh), 2, 0, 3, 1, 4)
        q, k, v = qkv[0], qkv[1], qkv[2]
        pq = torch.einsum("bhsd,hdf->bhsf", q, w_phi)
        pk = torch.einsum("bhsd,hdf->bhsf", k, w_phi)
        phi_q = torch.concatenate([_softmax(pq, axis=-1), _softmax(-pq, axis=-1)], axis=-1)
        phi_k = torch.concatenate([_softmax(pk, axis=-1), _softmax(-pk, axis=-1)], axis=-1)
        kv = torch.einsum("bhsf,bhsd->bhfd", phi_k, v)
        z  = torch.einsum("bhsf->bhf", phi_k)
        num = torch.einsum("bhqf,bhfd->bhqd", phi_q, kv)
        den = torch.einsum("bhqf,bhf->bhq", phi_q, z)[..., None] + 1e-6
        o = num / den
        return (lambda x, *d: x.permute(*d))(o, 0, 2, 1, 3).reshape(B, S, D) @ wo

    def _B_ref(x, w1, w2):
        h = torch.einsum("bsd,df->bsf", x, w1)
        h = _silu(h)
        out = torch.einsum("bsf,fd->bsd", h, w2)
        return out

    x = A_x
    xn = _layernorm(x, axis=-1)
    s = _A_ref(xn, A_wqkv, A_w_phi, A_wo)
    g = _silu(_B_ref(xn, B_w1, B_w2))
    return x + s * g
```

```asm
; @launch grid=(256,1,1) block=(512,1,1) lds=163840
.amdgcn_target "amdgcn-amd-amdhsa--gfx950"
.text
.globl recurrent_scan__linear_kernel_hedgehog__dense_activation_silu__prompt_kernel
.p2align 12
.type recurrent_scan__linear_kernel_hedgehog__dense_activation_silu__prompt_kernel,@function
recurrent_scan__linear_kernel_hedgehog__dense_activation_silu__prompt_kernel:
s_load_dwordx2 s[8:9], s[0:1], 0
s_bitcmp1_b32 s2, 6
s_cselect_b32 s7, 40, 8
s_load_dwordx2 s[12:13], s[0:1], s7
s_load_dwordx2 s[16:17], s[0:1], 72
s_movk_i32 s60, 3072
s_cmovk_i32 s60, 3584
s_movk_i32 s47, 128
s_cmovk_i32 s47, 448
s_cselect_b32 s3, 2, 0
s_lshr_b32 s4, s2, 8
s_cbranch_scc1 K_done
v_readfirstlane_b32 s49, v0
s_lshr_b32 s5, s2, 3
s_getpc_b64 s[6:7]
L_pc:
s_lshl_b32 s4, s5, 11
v_lshl_add_u32 v2, v0, 2, s4
v_min_u32 v2, K_done-L_pc, v2
global_load_dword v255, v2, s[6:7]
v_lshrrev_b32 v14, 4, v0
v_xor_b32 v15, v14, v0
v_and_b32 v15, 7, v15
v_lshlrev_b32 v15, 4, v15
v_lshrrev_b32 v13, 3, v0
v_lshl_add_u32 v10, v13, 10, v15
s_and_b32 s4, s5, 7
s_and_b32 s6, s2, 1
s_lshl3_add_u32 s36, s6, s4
s_lshr_b32 s6, s2, 6
s_lshr_b32 s7, s2, 1
s_add_u32 s5, s4, s6
s_and_b32 s5, s5, 3
s_xor_b32 s40, s7, s2
s_and_b32 s40, s40, 1
s_lshl2_add_u32 s40, s40, s5
s_and_b32 s7, s7, 3
s_lshl2_add_u32 s59, s7, s6
s_and_b32 s45, s40, 4
s_lshl_b32 s46, s36, 17
s_lshl_b32 s43, s45, 7
s_add_u32 s43, s43, s46
s_lshl_b32 s10, 1, 21
s_lshl_b32 s11, 1, 17
s_lshl_b32 s49, s49, 4
v_add_u32 v11, 0x10000, v10
v_lshlrev_b32 v3, 4, v0
v_and_b32 v9, 0xfffffe00, v3
v_add_u32 v9, v9, v3
s_lshl_b32 s66, s59, 13
s_add_u32 s66, s66, s46
s_lshr_b32 s37, s59, 1
v_bfi_b32 v15, 2, v13, v14
v_and_b32 v15, 6, v15
v_xor_b32 v15, v15, v0
v_and_b32 v15, 7, v15
v_lshlrev_b32 v15, 4, v15
s_and_b32 s5, s2, 32
v_xor_b32 v13, s5, v13
s_lshl_b32 s5, s5, 7
s_xor_b32 s71, s49, s5
v_mad_u32_u24 v12, v13, s60, v15
s_mul_i32 s47, s47, s37
s_add_u32 s47, s47, 64
s_and_b32 s47, s47, 0xffffff80
s_lshl_b32 s14, s60, 9
s_mov_b32 s15, s11
s_lshl_b32 s41, s45, 6
s_mul_i32 s41, s41, s60
s_add_u32 s44, s41, s47
s_cmp_eq_u32 s3, 0
s_cselect_b32 s41, 10, 7
s_lshl_b32 s41, 1, s41
s_add_u32 s69, s44, s41
s_add_u32 s71, s71, 114688
s_movk_i32 s42, 8192
s_bitcmp1_b32 s2, 4
s_cselect_b32 s5, -1, 1
s_mul_i32 s41, s41, s5
s_mul_i32 s42, s42, s5
s_sub_u32 s67, s69, s41
s_add_u32 s68, s69, s41
s_lshr_b32 s38, s49, 10
s_cmp_ge_u32 s49, 4096
s_waitcnt lgkmcnt(0)
s_cbranch_scc1 K_norow
s_load_dword s50, s[16:17], 0
buffer_load_dwordx4 v[240:243], v9, s[8:11], s66 offen
buffer_load_dwordx4 v[244:247], v9, s[8:11], s66 offen offset:512
K_norow:
s_bitcmp1_b32 s40, 0
s_cbranch_scc1 K_wx
s_add_u32 m0, s49, 90112
s_nop 0
buffer_load_dwordx4 v10, s[8:11], s43 offen lds
s_add_u32 m0, s49, 98304
s_nop 0
buffer_load_dwordx4 v11, s[8:11], s43 offen lds
s_sub_u32 m0, s71, s42
s_nop 0
buffer_load_dwordx4 v12, s[12:15], s67 offen lds
s_mov_b32 m0, s71
s_nop 0
buffer_load_dwordx4 v12, s[12:15], s69 offen lds
s_add_u32 m0, s71, s42
s_nop 0
buffer_load_dwordx4 v12, s[12:15], s68 offen lds
s_branch K_xw
K_wx:
s_sub_u32 m0, s71, s42
s_nop 0
buffer_load_dwordx4 v12, s[12:15], s67 offen lds
s_mov_b32 m0, s71
s_nop 0
buffer_load_dwordx4 v12, s[12:15], s69 offen lds
s_add_u32 m0, s71, s42
s_nop 0
buffer_load_dwordx4 v12, s[12:15], s68 offen lds
s_add_u32 m0, s49, 90112
s_nop 0
buffer_load_dwordx4 v10, s[8:11], s43 offen lds
s_add_u32 m0, s49, 98304
s_nop 0
buffer_load_dwordx4 v11, s[8:11], s43 offen lds
K_xw:
v_and_b32 v1, 63, v0
v_lshlrev_b32 v3, 4, v1
s_lshl_b32 s18, 1, 24
s_mov_b32 s19, s11
s_and_b32 s39, s38, 3
s_lshr_b32 s4, s38, 2
s_add_u32 s3, s3, s4
s_cmp_eq_u32 s3, 1
s_cbranch_scc1 K_LA
s_cmp_eq_u32 s3, 0
s_cbranch_scc1 K_CA
s_cmp_eq_u32 s3, 2
s_cbranch_scc1 K_CF
K_LF:
s_setprio 1
s_load_dwordx2 s[24:25], s[0:1], 48
s_mov_b32 s26, 1835008
s_mov_b32 s27, 0x20000
s_load_dwordx2 s[32:33], s[0:1], 24
s_mov_b32 s34, 524288
s_mov_b32 s35, 0x20000
s_sub_u32 s49, s49, 4096
v_or_b32 v64, 0x8000, v10
v_or_b32 v65, 0x8000, v11
v_and_b32 v10, 0xffff7fff, v10
v_and_b32 v11, 0xffff7fff, v11
s_bitcmp1_b32 s2, 5
s_cselect_b32 s4, 0, 114688
v_subrev_u32 v12, s4, v12
v_add_u32 v66, 114688, v12
s_and_b32 s4, s40, 3
s_lshl_b32 s4, s4, 2
s_lshr_b32 s4, 0x32103210, s4
s_and_b32 s4, s4, 0xffff
s_lshl_b32 s4, s4, 16
s_and_b32 s5, s36, 7
s_and_b32 s6, s59, 3
s_add_u32 s5, s5, s6
s_lshl_b32 s5, s5, 1
s_lshr_b32 s5, 1198372, s5
s_and_b32 s5, s5, 3
s_lshl_b32 s5, s5, 2
s_lshr_b32 s5, 0x213210, s5
s_and_b32 s5, s5, 0xfff0
s_or_b32 s4, s4, s5
s_cmp_ge_u32 s40, 4
s_mov_b32 s5, 0x44440000
s_cmovk_i32 s5, 0x4444
s_or_b32 s40, s4, s5
s_and_b32 s41, s37, 1
s_mul_i32 s41, s41, 448
s_sub_u32 s48, 384, s41
s_mul_i32 s41, s39, 57344
s_add_u32 s48, s48, s41
v_lshrrev_b32 v16, 2, v1
v_and_b32 v17, 3, v1
v_lshrrev_b32 v18, 4, v1
v_and_b32 v18, 2, v18
v_xor_b32 v18, v18, v17
v_lshlrev_b32_e64 v18, 4, v18
v_mul_u32_u24 v67, 3584, v16
v_add_u32 v67, v67, v18
s_add_u32 s45, s44, s48
s_add_u32 m0, s49, 131072
s_nop 0
buffer_load_dwordx4 v67, s[12:15], s45 offen lds
s_bfe_u32 s41, s40, 0x40004
s_lshl_b32 s43, s41, 7
s_add_u32 s43, s43, s46
s_mul_i32 s41, s41, 229376
s_add_u32 s44, s41, s47
s_add_u32 s45, s44, s48
s_add_u32 m0, s49, 45056
s_nop 0
buffer_load_dwordx4 v10, s[8:11], s43 offen lds
s_add_u32 m0, s49, 61440
s_nop 0
buffer_load_dwordx4 v12, s[12:15], s44 offen lds
s_add_u32 m0, s49, 69504
s_nop 0
buffer_load_dwordx4 v12, s[12:15], s44 offen offset:128 lds
s_add_u32 m0, s49, 49152
s_nop 0
buffer_load_dwordx4 v64, s[8:11], s43 offen lds
s_add_u32 m0, s49, 77568
s_nop 0
buffer_load_dwordx4 v12, s[12:15], s44 offen offset:256 lds
s_and_b32 s4, s2, 7
s_lshr_b32 s5, s2, 3
s_and_b32 s6, s5, 15
s_lshr_b32 s6, 0x880, s6
s_and_b32 s6, s6, 1
s_mul_i32 s6, s6, 12
s_xor_b32 s5, s5, s6
s_lshl_b32 s4, s4, 2
s_lshr_b32 s6, s5, 3
s_add_u32 s52, s4, s6
s_and_b32 s53, s5, 7
s_and_b32 s7, s53, 3
s_cmp_eq_u32 s7, 3
s_cselect_b32 s7, 3, 2
s_and_b32 s6, s6, s7
s_add_u32 s6, s6, s53
s_and_b32 s7, s6, 3
s_lshl_b32 s7, s7, 2
s_lshr_b32 s4, 0x98109810, s7
s_and_b32 s4, s4, 0xffff
s_mul_i32 s54, s4, 0x10001
s_add_u32 s54, s54, 0x22220000
s_bitcmp1_b32 s6, 1
s_cselect_b32 s5, 0x110000, 0
s_xor_b32 s5, s5, 0x764444
s_add_u32 s55, s4, s5
s_mul_i32 s4, s39, 14
s_mul_i32 s57, s52, 72
s_add_u32 s57, s57, s4
s_lshl_b32 s57, s57, 12
s_add_u32 s57, s57, 1048576
s_lshl_b32 s56, s4, 15
s_lshl_b32 s5, s53, 7
s_add_u32 s56, s56, s5
s_lshl_b32 s98, s39, 17
s_add_u32 s98, s98, s5
s_lshl_b32 s58, s39, 12
v_lshrrev_b32 v16, 3, v1
v_and_b32 v17, 6, v16
v_and_b32 v18, 7, v1
v_xor_b32 v17, v17, v18
v_lshlrev_b32_e64 v17, 4, v17
v_lshl_add_u32 v8, v16, 10, v17
v_add_u32 v9, 0x2000, v8
v_lshrrev_b32 v16, 2, v1
v_lshlrev_b32 v16, 7, v16
v_and_b32_e64 v17, 3, v1
v_lshl_add_u32 v16, v17, 3, v16
v_add_u32_e64 v16, s58, v16
v_bfe_u32 v17, v1, 3, 2
v_xor_b32_e64 v4, 0, v17
v_lshl_add_u32 v4, v4, 5, v16
v_xor_b32_e64 v5, 1, v17
v_lshl_add_u32 v5, v5, 5, v16
v_xor_b32_e64 v6, 2, v17
v_lshl_add_u32 v6, v6, 5, v16
v_xor_b32_e64 v7, 3, v17
v_lshl_add_u32 v7, v7, 5, v16
v_add_u32 v13, 102400, v4
v_add_u32 v14, 102400, v5
v_add_u32 v15, 102400, v6
v_add_u32 v2, 102400, v7
v_mov_b32 v70, 154112
v_mov_b32 v71, 1
s_lshr_b32 s99, s52, 1
s_lshl_b32 s99, s99, 14
s_and_b32 s4, s52, 1
s_lshl_b32 s4, s4, 11
s_add_u32 s99, s99, s4
s_add_u32 s99, s99, 525312
s_lshl_b32 s4, s39, 8
s_add_u32 s99, s99, s4
v_and_b32 v24, 15, v1
v_lshrrev_b32 v25, 4, v1
s_cmp_eq_u32 s39, 3
s_cselect_b32 s4, 6, 7
s_cselect_b32 s5, 1, 3
s_cselect_b32 s6, 1, 0
s_lshl_b32 s7, s39, 13
s_and_b32 s41, s36, 7
s_lshr_b32 s41, 0xb8, s41
s_and_b32 s41, s41, 1
s_lshl_b32 s41, s41, 5
s_lshr_b32 s66, s66, 6
s_lshl_b32 s42, s39, 5
s_add_u32 s66, s66, s42
s_add_u32 s51, s66, 196608
s_lshl_b32 s42, s39, 4
s_add_u32 s42, s42, 154176
v_and_b32_e64 v76, 1, v1
v_lshl_add_u32 v76, v76, 3, s42
v_lshrrev_b32_e64 v77, 1, v1
v_lshl_add_u32 v77, v77, 26, v3
v_lshrrev_b32_e64 v16, 2, v24
v_lshl_add_u32 v16, v25, 3, v16
v_add_u32 v16, s41, v16
v_lshlrev_b32 v16, s4, v16
v_and_b32_e64 v17, 3, v24
v_lshl_add_u32 v16, v17, 3, v16
s_add_u32 s7, s7, 106496
s_and_b32 s42, s36, 6
s_cmp_lg_u32 s42, 6
s_cselect_b32 s42, 45056, 0
s_sub_u32 s7, s7, s42
v_add_u32 v16, s7, v16
v_lshrrev_b32 v18, 3, v24
v_and_b32 v17, 1, v25
v_lshl_or_b32 v18, v17, 1, v18
v_lshrrev_b32 v18, s6, v18
v_xor_b32 v17, 0, v18
v_and_b32_e64 v17, s5, v17
v_lshl_add_u32 v20, v17, 5, v16
v_xor_b32 v17, 1, v18
v_and_b32 v17, s5, v17
v_lshl_add_u32 v21, v17, 5, v16
v_xor_b32 v17, 2, v18
v_and_b32 v17, s5, v17
v_lshl_add_u32 v22, v17, 5, v16
v_xor_b32 v17, 3, v18
v_and_b32 v17, s5, v17
v_lshl_add_u32 v23, v17, 5, v16
s_lshl_b32 s5, 4, s4
s_nop 0
v_mov_b32 v28, 0x3f803f80
v_mov_b32 v29, 0x3f803f80
v_mov_b32 v30, 0x3f803f80
v_mov_b32 v31, 0x3f803f80
v_mov_b32 v26, 154112
v_mov_b32 v27, 0xff
s_lshl_b32 s67, s59, 14
s_lshl_b32 s41, s39, 8
s_add_u32 s67, s67, s41
s_add_u32 s67, s67, 262144
s_lshl_b32 s41, s36, 10
s_add_u32 s68, s67, s41
s_lshl_b32 s66, s36, 2
s_add_u32 s66, s66, s39
s_lshl_b32 s66, s66, 9
s_add_u32 s66, s66, 196608
s_add_u32 m0, s49, 53248
s_nop 0
buffer_load_dwordx4 v11, s[8:11], s43 offen lds
s_add_u32 m0, s49, 65536
s_nop 0
buffer_load_dwordx4 v66, s[12:15], s44 offen lds
s_add_u32 m0, s49, 73600
s_nop 0
buffer_load_dwordx4 v66, s[12:15], s44 offen offset:128 lds
s_add_u32 m0, s49, 57344
s_nop 0
buffer_load_dwordx4 v65, s[8:11], s43 offen lds
s_add_u32 m0, s49, 81664
s_nop 0
buffer_load_dwordx4 v66, s[12:15], s44 offen offset:256 lds
s_add_u32 m0, s49, 86016
s_nop 0
buffer_load_dwordx4 v67, s[12:15], s45 offen lds
s_waitcnt vmcnt(11)
s_barrier
ds_read_b32 v26, v26
ds_read_b64 v[72:73], v76
s_and_b32 s42, s36, 6
s_cmp_eq_u32 s42, 6
s_cbranch_scc0 CS_1
ds_read_b64_tr_b16 v[32:33], v20
ds_read_b64_tr_b16 v[36:37], v21
ds_read_b64_tr_b16 v[40:41], v22
ds_read_b64_tr_b16 v[44:45], v23
v_add_u32 v20, s5, v20
v_add_u32 v21, s5, v21
v_add_u32 v22, s5, v22
v_add_u32 v23, s5, v23
ds_read_b64_tr_b16 v[34:35], v20
ds_read_b64_tr_b16 v[38:39], v21
ds_read_b64_tr_b16 v[42:43], v22
ds_read_b64_tr_b16 v[46:47], v23
CS_1:
s_bfe_u32 s41, s40, 0x40008
s_lshl_b32 s43, s41, 7
s_add_u32 s43, s43, s46
s_mul_i32 s41, s41, 229376
s_add_u32 s44, s41, s47
s_add_u32 s45, s44, s48
s_add_u32 m0, s49, 0
s_nop 0
buffer_load_dwordx4 v10, s[8:11], s43 offen lds
s_add_u32 m0, s49, 16384
s_nop 0
buffer_load_dwordx4 v12, s[12:15], s44 offen lds
s_add_u32 m0, s49, 24448
s_nop 0
buffer_load_dwordx4 v12, s[12:15], s44 offen offset:128 lds
s_add_u32 m0, s49, 4096
s_nop 0
buffer_load_dwordx4 v64, s[8:11], s43 offen lds
s_add_u32 m0, s49, 32512
s_nop 0
buffer_load_dwordx4 v12, s[12:15], s44 offen offset:256 lds
s_add_u32 m0, s49, 8192
s_nop 0
buffer_load_dwordx4 v11, s[8:11], s43 offen lds
s_waitcnt vmcnt(6) lgkmcnt(0)
s_barrier
s_and_b32 s42, s36, 6
s_cmp_eq_u32 s42, 6
s_cbranch_scc1 CS_2
ds_read_b64_tr_b16 v[32:33], v20
ds_read_b64_tr_b16 v[36:37], v21
ds_read_b64_tr_b16 v[40:41], v22
ds_read_b64_tr_b16 v[44:45], v23
v_add_u32 v20, s5, v20
v_add_u32 v21, s5, v21
v_add_u32 v22, s5, v22
v_add_u32 v23, s5, v23
ds_read_b64_tr_b16 v[34:35], v20
ds_read_b64_tr_b16 v[38:39], v21
ds_read_b64_tr_b16 v[42:43], v22
ds_read_b64_tr_b16 v[46:47], v23
CS_2:
s_add_u32 m0, s49, 20480
s_nop 0
buffer_load_dwordx4 v66, s[12:15], s44 offen lds
s_add_u32 m0, s49, 28544
s_nop 0
buffer_load_dwordx4 v66, s[12:15], s44 offen offset:128 lds
s_add_u32 m0, s49, 12288
s_nop 0
buffer_load_dwordx4 v65, s[8:11], s43 offen lds
s_add_u32 m0, s49, 36608
s_nop 0
buffer_load_dwordx4 v66, s[12:15], s44 offen offset:256 lds
s_add_u32 m0, s49, 40960
s_nop 0
buffer_load_dwordx4 v67, s[12:15], s45 offen lds
s_bfe_u32 s41, s40, 0x4000c
s_lshl_b32 s43, s41, 7
s_add_u32 s43, s43, s46
s_mul_i32 s41, s41, 229376
s_add_u32 s44, s41, s47
s_add_u32 s45, s44, s48
s_add_u32 m0, s49, 90112
s_nop 0
buffer_load_dwordx4 v10, s[8:11], s43 offen lds
s_add_u32 m0, s49, 106496
s_nop 0
buffer_load_dwordx4 v12, s[12:15], s44 offen lds
s_add_u32 m0, s49, 114560
s_nop 0
buffer_load_dwordx4 v12, s[12:15], s44 offen offset:128 lds
s_add_u32 m0, s49, 94208
s_nop 0
buffer_load_dwordx4 v64, s[8:11], s43 offen lds
s_add_u32 m0, s49, 122624
s_nop 0
buffer_load_dwordx4 v12, s[12:15], s44 offen offset:256 lds
s_add_u32 m0, s49, 98304
s_nop 0
buffer_load_dwordx4 v11, s[8:11], s43 offen lds
s_waitcnt lgkmcnt(0)
v_readfirstlane_b32 s50, v26
s_setprio 3
v_mfma_f32_16x16x32_bf16 v[48:51], v[28:31], v[32:35], 0
v_mfma_f32_16x16x32_bf16 v[52:55], v[28:31], v[36:39], 0
v_mfma_f32_16x16x32_bf16 v[56:59], v[28:31], v[40:43], 0
v_mfma_f32_16x16x32_bf16 v[60:63], v[28:31], v[44:47], 0
s_lshr_b32 s61, s50, 8
s_lshr_b32 s62, s50, 16
s_lshr_b32 s63, s50, 24
s_mov_b32 s96, 0x0c0c0400
s_mov_b32 s97, 0x04000c0c
v_lshrrev_b32_e64 v16, 4, v1
v_lshl_add_u32 v16, v16, 26, v3
v_bfi_b32 v48, v27, s50, v48
v_bfi_b32 v49, v27, s61, v52
v_bfi_b32 v50, v27, s62, v56
v_bfi_b32 v51, v27, s63, v60
s_setprio 1
v_mov_b32 v74, v26
v_mov_b32 v75, v26
v_and_b32 v20, 15, v1
v_lshlrev_b32_e64 v20, 4, v20
v_lshl_add_u32 v20, v25, 10, v20
v_and_b32 v21, 0x1f0, v3
s_add_u32 s69, s67, 4096
s_add_u32 s70, s67, 8192
s_add_u32 s71, s67, 12288
buffer_store_dwordx4 v[48:51], v16, s[16:19], s68 offen sc1
buffer_store_dwordx4 v[72:75], v77, s[16:19], s51 offen sc1
s_cmp_gt_u32 s59, 6
s_subb_u32 s41, s59, 0
s_lshl4_add_u32 s41, s41, s36
s_lshl2_add_u32 s41, s41, s39
s_cmp_eq_u32 s59, 6
s_cselect_b32 s41, 0x10000, s41
s_sub_u32 s42, s41, 448
s_lshl_b32 s42, s42, 10
s_lshl_b32 s41, s41, 11
s_mov_b32 m0, 159744
s_min_u32 s42, s42, 1073741824
buffer_load_dwordx4 v3, s[24:27], s41 offen offset:0  lds
buffer_load_dwordx4 v3, s[24:27], s41 offen offset:1024  lds
buffer_load_dwordx4 v3, s[32:35], s42 offen  lds
s_waitcnt vmcnt(11) lgkmcnt(0)
s_barrier
s_add_u32 m0, s49, 110592
s_nop 0
buffer_load_dwordx4 v66, s[12:15], s44 offen lds
s_add_u32 m0, s49, 118656
s_nop 0
buffer_load_dwordx4 v66, s[12:15], s44 offen offset:128 lds
s_add_u32 m0, s49, 102400
s_nop 0
buffer_load_dwordx4 v65, s[8:11], s43 offen lds
s_add_u32 m0, s49, 126720
s_nop 0
buffer_load_dwordx4 v66, s[12:15], s44 offen offset:256 lds
s_add_u32 m0, s49, 131072
s_nop 0
buffer_load_dwordx4 v67, s[12:15], s45 offen lds
s_bfe_u32 s41, s40, 0x40010
s_lshl_b32 s43, s41, 7
s_add_u32 s43, s43, s46
s_mul_i32 s41, s41, 229376
s_add_u32 s44, s41, s47
s_add_u32 s45, s44, s48
s_add_u32 m0, s49, 45056
s_nop 0
buffer_load_dwordx4 v10, s[8:11], s43 offen lds
s_add_u32 m0, s49, 61440
s_nop 0
buffer_load_dwordx4 v12, s[12:15], s44 offen lds
s_add_u32 m0, s49, 69504
s_nop 0
buffer_load_dwordx4 v12, s[12:15], s44 offen offset:128 lds
s_add_u32 m0, s49, 49152
s_nop 0
buffer_load_dwordx4 v64, s[8:11], s43 offen lds
s_add_u32 m0, s49, 77568
s_nop 0
buffer_load_dwordx4 v12, s[12:15], s44 offen offset:256 lds
s_add_u32 m0, s49, 53248
s_nop 0
buffer_load_dwordx4 v11, s[8:11], s43 offen lds
s_add_u32 m0, s49, 65536
s_nop 0
buffer_load_dwordx4 v66, s[12:15], s44 offen lds
s_add_u32 m0, s49, 73600
s_nop 0
buffer_load_dwordx4 v66, s[12:15], s44 offen offset:128 lds
s_add_u32 m0, s49, 57344
s_nop 0
buffer_load_dwordx4 v65, s[8:11], s43 offen lds
s_add_u32 m0, s49, 81664
s_nop 0
buffer_load_dwordx4 v66, s[12:15], s44 offen offset:256 lds
s_add_u32 m0, s49, 86016
s_nop 0
buffer_load_dwordx4 v67, s[12:15], s45 offen lds
s_waitcnt vmcnt(11)
s_barrier
s_bfe_u32 s41, s40, 0x40014
s_lshl_b32 s43, s41, 7
s_add_u32 s43, s43, s46
s_mul_i32 s41, s41, 229376
s_add_u32 s44, s41, s47
s_add_u32 s45, s44, s48
s_add_u32 m0, s49, 0
s_nop 0
buffer_load_dwordx4 v10, s[8:11], s43 offen lds
s_add_u32 m0, s49, 16384
WS_F2:
WS_586:
s_cbranch_execz WS_7392
s_nop 0
s_nop 0
buffer_load_dwordx4 v12, s[12:15], s44 offen lds
s_add_u32 m0, s49, 24448
s_nop 0
buffer_load_dwordx4 v12, s[12:15], s44 offen offset:128 lds
s_add_u32 m0, s49, 4096
s_nop 0
buffer_load_dwordx4 v64, s[8:11], s43 offen lds
s_add_u32 m0, s49, 32512
s_nop 0
buffer_load_dwordx4 v12, s[12:15], s44 offen offset:256 lds
s_add_u32 m0, s49, 8192
s_nop 0
buffer_load_dwordx4 v11, s[8:11], s43 offen lds
s_add_u32 m0, s49, 20480
s_nop 0
buffer_load_dwordx4 v66, s[12:15], s44 offen lds
s_add_u32 m0, s49, 28544
s_nop 0
buffer_load_dwordx4 v66, s[12:15], s44 offen offset:128 lds
s_add_u32 m0, s49, 12288
s_nop 0
buffer_load_dwordx4 v65, s[8:11], s43 offen lds
s_add_u32 m0, s49, 36608
s_nop 0
buffer_load_dwordx4 v66, s[12:15], s44 offen offset:256 lds
s_add_u32 m0, s49, 40960
s_nop 0
buffer_load_dwordx4 v67, s[12:15], s45 offen lds
s_waitcnt vmcnt(11)
s_barrier
s_bfe_u32 s41, s40, 0x40018
s_lshl_b32 s43, s41, 7
s_add_u32 s43, s43, s46
s_mul_i32 s41, s41, 229376
s_add_u32 s44, s41, s47
s_add_u32 s45, s44, s48
s_add_u32 m0, s49, 90112
s_nop 0
buffer_load_dwordx4 v10, s[8:11], s43 offen lds
s_add_u32 m0, s49, 106496
s_nop 0
buffer_load_dwordx4 v12, s[12:15], s44 offen lds
s_add_u32 m0, s49, 114560
s_nop 0
buffer_load_dwordx4 v12, s[12:15], s44 offen offset:128 lds
s_add_u32 m0, s49, 94208
s_nop 0
buffer_load_dwordx4 v64, s[8:11], s43 offen lds
s_add_u32 m0, s49, 122624
s_nop 0
buffer_load_dwordx4 v12, s[12:15], s44 offen offset:256 lds
s_add_u32 m0, s49, 98304
s_nop 0
buffer_load_dwordx4 v11, s[8:11], s43 offen lds
s_add_u32 m0, s49, 110592
s_nop 0
buffer_load_dwordx4 v66, s[12:15], s44 offen lds
s_add_u32 m0, s49, 118656
s_nop 0
buffer_load_dwordx4 v66, s[12:15], s44 offen offset:128 lds
s_add_u32 m0, s49, 102400
s_nop 0
buffer_load_dwordx4 v65, s[8:11], s43 offen lds
s_add_u32 m0, s49, 126720
s_nop 0
buffer_load_dwordx4 v66, s[12:15], s44 offen offset:256 lds
s_add_u32 m0, s49, 131072
s_nop 0
buffer_load_dwordx4 v67, s[12:15], s45 offen lds
s_waitcnt vmcnt(11)
s_barrier
s_bfe_u32 s41, s40, 0x4001c
s_lshl_b32 s43, s41, 7
s_add_u32 s43, s43, s46
s_mul_i32 s41, s41, 229376
s_add_u32 s44, s41, s47
s_add_u32 s45, s44, s48
s_add_u32 m0, s49, 45056
s_nop 0
buffer_load_dwordx4 v10, s[8:11], s43 offen lds
s_add_u32 m0, s49, 61440
s_nop 0
buffer_load_dwordx4 v12, s[12:15], s44 offen lds
s_add_u32 m0, s49, 69504
s_nop 0
buffer_load_dwordx4 v12, s[12:15], s44 offen offset:128 lds
s_add_u32 m0, s49, 49152
s_nop 0
buffer_load_dwordx4 v64, s[8:11], s43 offen lds
s_add_u32 m0, s49, 77568
s_nop 0
buffer_load_dwordx4 v12, s[12:15], s44 offen offset:256 lds
s_add_u32 m0, s49, 53248
s_nop 0
buffer_load_dwordx4 v11, s[8:11], s43 offen lds
s_add_u32 m0, s49, 65536
s_nop 0
buffer_load_dwordx4 v66, s[12:15], s44 offen lds
s_add_u32 m0, s49, 73600
s_nop 0
buffer_load_dwordx4 v66, s[12:15], s44 offen offset:128 lds
s_add_u32 m0, s49, 57344
s_nop 0
buffer_load_dwordx4 v65, s[8:11], s43 offen lds
s_add_u32 m0, s49, 81664
s_nop 0
buffer_load_dwordx4 v66, s[12:15], s44 offen offset:256 lds
s_add_u32 m0, s49, 86016
s_nop 0
buffer_load_dwordx4 v67, s[12:15], s45 offen lds
buffer_load_dwordx4 v[48:51], v21, s[16:19], s66 offen sc1
buffer_load_dwordx4 v[32:35], v20, s[16:19], s67 offen sc1
buffer_load_dwordx4 v[36:39], v20, s[16:19], s69 offen sc1
buffer_load_dwordx4 v[40:43], v20, s[16:19], s70 offen sc1
buffer_load_dwordx4 v[44:47], v20, s[16:19], s71 offen sc1
s_waitcnt vmcnt(16)
s_barrier
s_add_u32 s41, s39, 0
s_and_b32 s41, s41, 3
s_lshl_b32 s41, s41, 10
v_add_u32 v10, s41, v3
s_add_u32 s41, s39, 1
s_and_b32 s41, s41, 3
s_lshl_b32 s41, s41, 10
v_add_u32 v11, s41, v3
s_add_u32 s41, s39, 2
s_and_b32 s41, s41, 3
s_lshl_b32 s41, s41, 10
v_add_u32 v12, s41, v3
s_add_u32 s41, s39, 3
s_and_b32 s41, s41, 3
s_lshl_b32 s41, s41, 10
v_add_u32 v0, s41, v3
s_bfe_u32 s64, s54, 0x40000
s_lshl_b32 s64, s64, 15
s_add_u32 s64, s64, s56
s_add_u32 s65, s64, 16384
s_add_u32 m0, s58, 135168
s_nop 0
buffer_load_dwordx4 v8, s[24:27], s64 offen  lds
s_add_u32 m0, s58, 136192
s_nop 0
buffer_load_dwordx4 v9, s[24:27], s64 offen  lds
s_add_u32 m0, s58, 137216
s_nop 0
buffer_load_dwordx4 v8, s[24:27], s65 offen  lds
s_add_u32 m0, s58, 138240
s_nop 0
buffer_load_dwordx4 v9, s[24:27], s65 offen  lds
s_bfe_u32 s64, s54, 0x40004
s_lshl_b32 s64, s64, 15
s_add_u32 s64, s64, s56
s_add_u32 s65, s64, 16384
s_add_u32 m0, s58, 0
s_nop 0
buffer_load_dwordx4 v8, s[24:27], s64 offen  lds
s_add_u32 m0, s58, 1024
s_nop 0
buffer_load_dwordx4 v9, s[24:27], s64 offen  lds
s_add_u32 m0, s58, 2048
s_nop 0
buffer_load_dwordx4 v8, s[24:27], s65 offen  lds
s_add_u32 m0, s58, 3072
s_nop 0
buffer_load_dwordx4 v9, s[24:27], s65 offen  lds
s_bfe_u32 s64, s54, 0x40010
s_lshl_b32 s64, s64, 15
s_add_u32 s64, s64, s56
s_add_u32 s65, s64, 16384
s_add_u32 m0, s58, 16384
s_nop 0
buffer_load_dwordx4 v8, s[24:27], s64 offen  lds
s_add_u32 m0, s58, 17408
s_nop 0
buffer_load_dwordx4 v9, s[24:27], s64 offen  lds
s_add_u32 m0, s58, 18432
s_nop 0
buffer_load_dwordx4 v8, s[24:27], s65 offen  lds
s_add_u32 m0, s58, 19456
s_nop 0
buffer_load_dwordx4 v9, s[24:27], s65 offen  lds
s_waitcnt vmcnt(17) lgkmcnt(0)
s_barrier
s_waitcnt vmcnt(12)
s_mov_b32 s51, 400000
s_branch PC_4
s_nop 0
PL_3:
buffer_load_dwordx4 v[48:51], v21, s[16:19], s66 offen sc1
buffer_load_dwordx4 v[32:35], v20, s[16:19], s67 offen sc1
buffer_load_dwordx4 v[36:39], v20, s[16:19], s69 offen sc1
buffer_load_dwordx4 v[40:43], v20, s[16:19], s70 offen sc1
buffer_load_dwordx4 v[44:47], v20, s[16:19], s71 offen sc1
s_waitcnt vmcnt(0)
s_nop 0
PC_4:
v_perm_b32 v56, v33, v32, s96
v_perm_b32 v60, v35, v34, s97
v_bitop3_b32 v56, v56, v60, s50 bitop3:0x96
v_perm_b32 v57, v37, v36, s96
v_perm_b32 v61, v39, v38, s97
v_bitop3_b32 v57, v57, v61, s50 bitop3:0x96
v_perm_b32 v58, v41, v40, s96
v_perm_b32 v62, v43, v42, s97
v_bitop3_b32 v58, v58, v62, s50 bitop3:0x96
v_perm_b32 v59, v45, v44, s96
v_perm_b32 v63, v47, v46, s97
v_bitop3_b32 v59, v59, v63, s50 bitop3:0x96
v_bitop3_b32 v60, v50, v51, s50 bitop3:0x7e
v_or3_b32 v56, v56, v57, v58
v_or3_b32 v56, v56, v59, v60
v_cmp_ne_u32 vcc, 0, v56
s_nop 0
s_and_b64 s[4:5], vcc, exec
s_cbranch_scc0 PD_5
s_sleep 2
s_sub_u32 s51, s51, 1
s_cbranch_scc0 PL_3
s_nop 0
PD_5:
v_and_b32 v32, 0xffffff00, v32
v_and_b32 v33, 0xffffff00, v33
v_and_b32 v34, 0xffffff00, v34
v_and_b32 v35, 0xffffff00, v35
v_and_b32 v36, 0xffffff00, v36
v_and_b32 v37, 0xffffff00, v37
v_and_b32 v38, 0xffffff00, v38
v_and_b32 v39, 0xffffff00, v39
v_and_b32 v40, 0xffffff00, v40
v_and_b32 v41, 0xffffff00, v41
v_and_b32 v42, 0xffffff00, v42
v_and_b32 v43, 0xffffff00, v43
v_and_b32 v44, 0xffffff00, v44
v_and_b32 v45, 0xffffff00, v45
v_and_b32 v46, 0xffffff00, v46
v_and_b32 v47, 0xffffff00, v47
v_add_f32 v32, v32, v36
v_add_f32 v40, v40, v44
v_add_f32 v33, v33, v37
v_add_f32 v41, v41, v45
v_add_f32 v34, v34, v38
v_add_f32 v42, v42, v46
v_add_f32 v35, v35, v39
v_add_f32 v43, v43, v47
v_add_f32 v32, v32, v40
v_add_f32 v33, v33, v41
v_add_f32 v34, v34, v42
v_add_f32 v35, v35, v43
s_lshl_b32 s41, s39, 8
v_permlane32_swap_b32 v32, v34
v_permlane32_swap_b32 v33, v35
v_add_f32 v32, v32, v34
v_add_f32 v33, v33, v35
s_add_u32 s41, s41, 153088
s_lshl_b32 s42, s39, 7
v_permlane16_swap_b32 v32, v33
v_add_f32 v32, v32, v33
v_lshl_add_u32 v20, v1, 2, s41
ds_write_b32 v20, v32
s_add_u32 s42, s42, 151552
v_lshrrev_b32 v21, 2, v21
v_add_u32 v21, s42, v21
v_sub_f32_e64 v48, 0, v48
ds_write_b32 v21, v48
v_mul_f32 v50, 0xbfb8aa3b, v49
ds_write_b32 v21, v50 offset:512
s_bfe_u32 s64, s54, 0x40014
s_lshl_b32 s64, s64, 15
s_add_u32 s64, s64, s56
s_add_u32 s65, s64, 16384
s_add_u32 m0, s58, 102400
s_nop 0
buffer_load_dwordx4 v8, s[24:27], s64 offen  lds
s_add_u32 m0, s58, 103424
s_nop 0
buffer_load_dwordx4 v9, s[24:27], s64 offen  lds
s_add_u32 m0, s58, 104448
s_nop 0
buffer_load_dwordx4 v8, s[24:27], s65 offen  lds
s_add_u32 m0, s58, 105472
s_nop 0
buffer_load_dwordx4 v9, s[24:27], s65 offen  lds
s_bfe_u32 s64, s55, 0x40000
s_lshl_b32 s64, s64, 15
s_add_u32 s64, s64, s56
s_add_u32 s65, s64, 16384
s_add_u32 m0, s58, 118784
s_nop 0
buffer_load_dwordx4 v8, s[24:27], s64 offen  lds
s_add_u32 m0, s58, 119808
s_nop 0
buffer_load_dwordx4 v9, s[24:27], s64 offen  lds
s_add_u32 m0, s58, 120832
s_nop 0
buffer_load_dwordx4 v8, s[24:27], s65 offen  lds
s_add_u32 m0, s58, 121856
s_nop 0
buffer_load_dwordx4 v9, s[24:27], s65 offen  lds
s_waitcnt lgkmcnt(0)
s_barrier
s_setprio 0
s_and_b32 s100, s52, 2
s_xor_b32 s42, s100, 0
s_lshl_b32 s101, s42, 12
s_lshl2_add_u32 s101, s58, s101
s_lshl_b32 s41, s42, 15
s_add_u32 s41, s41, s98
s_add_u32 s42, s41, 16384
s_add_u32 m0, s101, 32768
s_waitcnt vmcnt(7)
buffer_load_dwordx4 v8, s[32:35], s41 offen  lds
s_add_u32 m0, s101, 33792
s_waitcnt vmcnt(7)
buffer_load_dwordx4 v8, s[32:35], s42 offen  lds
s_add_u32 m0, s101, 34816
s_waitcnt vmcnt(7)
buffer_load_dwordx4 v9, s[32:35], s41 offen  lds
s_add_u32 m0, s101, 35840
s_waitcnt vmcnt(7)
buffer_load_dwordx4 v9, s[32:35], s42 offen  lds
s_xor_b32 s42, s100, 1
s_lshl_b32 s101, s42, 12
s_lshl2_add_u32 s101, s58, s101
s_lshl_b32 s41, s42, 15
s_add_u32 s41, s41, s98
s_add_u32 s42, s41, 16384
s_add_u32 m0, s101, 32768
s_waitcnt vmcnt(7)
buffer_load_dwordx4 v8, s[32:35], s41 offen  lds
s_add_u32 m0, s101, 33792
s_waitcnt vmcnt(7)
buffer_load_dwordx4 v8, s[32:35], s42 offen  lds
s_add_u32 m0, s101, 34816
s_waitcnt vmcnt(7)
buffer_load_dwordx4 v9, s[32:35], s41 offen  lds
s_add_u32 m0, s101, 35840
s_waitcnt vmcnt(7)
buffer_load_dwordx4 v9, s[32:35], s42 offen  lds
s_waitcnt vmcnt(24)
ds_read_b64_tr_b16 v[112:113], v13 offset:32768
ds_read_b64_tr_b16 v[114:115], v13 offset:34816
ds_read_b64_tr_b16 v[116:117], v14 offset:32768
ds_read_b64_tr_b16 v[118:119], v14 offset:34816
ds_read_b64_tr_b16 v[120:121], v15 offset:32768
ds_read_b64_tr_b16 v[122:123], v15 offset:34816
ds_read_b64_tr_b16 v[124:125], v2 offset:32768
ds_read_b64_tr_b16 v[126:127], v2 offset:34816
s_waitcnt vmcnt(20)
ds_read_b64_tr_b16 v[80:81], v4 offset:0
ds_read_b64_tr_b16 v[82:83], v4 offset:2048
ds_read_b64_tr_b16 v[84:85], v5 offset:0
ds_read_b64_tr_b16 v[86:87], v5 offset:2048
ds_read_b64_tr_b16 v[88:89], v6 offset:0
ds_read_b64_tr_b16 v[90:91], v6 offset:2048
ds_read_b64_tr_b16 v[92:93], v7 offset:0
ds_read_b64_tr_b16 v[94:95], v7 offset:2048
s_waitcnt lgkmcnt(8)
s_bfe_u32 s64, s55, 0x40004
s_lshl_b32 s64, s64, 15
s_add_u32 s64, s64, s56
s_add_u32 s65, s64, 16384
s_add_u32 m0, s58, 135168
s_waitcnt vmcnt(7)
buffer_load_dwordx4 v8, s[24:27], s64 offen  lds
s_add_u32 m0, s58, 136192
s_waitcnt vmcnt(7)
buffer_load_dwordx4 v9, s[24:27], s64 offen  lds
s_add_u32 m0, s58, 137216
s_waitcnt vmcnt(7)
buffer_load_dwordx4 v8, s[24:27], s65 offen  lds
s_add_u32 m0, s58, 138240
s_waitcnt vmcnt(7)
buffer_load_dwordx4 v9, s[24:27], s65 offen  lds
s_waitcnt vmcnt(20)
ds_read_b64_tr_b16 v[128:129], v4 offset:16384
ds_read_b64_tr_b16 v[130:131], v4 offset:18432
ds_read_b64_tr_b16 v[132:133], v5 offset:16384
ds_read_b64_tr_b16 v[134:135], v5 offset:18432
ds_read_b64_tr_b16 v[136:137], v6 offset:16384
ds_read_b64_tr_b16 v[138:139], v6 offset:18432
ds_read_b64_tr_b16 v[140:141], v7 offset:16384
ds_read_b64_tr_b16 v[142:143], v7 offset:18432
s_waitcnt lgkmcnt(8)
s_bfe_u32 s64, s55, 0x40010
s_lshl_b32 s64, s64, 15
s_add_u32 s64, s64, s56
s_add_u32 s65, s64, 16384
s_add_u32 m0, s58, 0
s_waitcnt vmcnt(7)
s_mov_b32 exec_lo, 0
v_add_u32 v8, 0x1000, v8
s_mov_b32 exec_lo, -1
buffer_load_dwordx4 v8, s[24:27], s64 offen  lds
s_add_u32 m0, s58, 1024
s_waitcnt vmcnt(7)
buffer_load_dwordx4 v8, s[24:27], s65 offen  lds
s_add_u32 m0, s58, 2048
s_waitcnt vmcnt(7)
s_add_u32 s64, s64, 4096
s_add_u32 s65, s65, 4096
buffer_load_dwordx4 v8, s[24:27], s64 offen  lds
s_add_u32 m0, s58, 3072
s_waitcnt vmcnt(7)
buffer_load_dwordx4 v8, s[24:27], s65 offen  lds
s_mov_b32 exec_lo, 0
v_subrev_u32 v8, 0x1000, v8
s_mov_b32 exec_lo, -1
s_waitcnt vmcnt(20)
ds_read_b64_tr_b16 v[144:145], v13 offset:0
ds_read_b64_tr_b16 v[146:147], v13 offset:2048
ds_read_b64_tr_b16 v[148:149], v14 offset:0
ds_read_b64_tr_b16 v[150:151], v14 offset:2048
ds_read_b64_tr_b16 v[152:153], v15 offset:0
ds_read_b64_tr_b16 v[154:155], v15 offset:2048
ds_read_b64_tr_b16 v[156:157], v2 offset:0
ds_read_b64_tr_b16 v[158:159], v2 offset:2048
s_waitcnt lgkmcnt(8)
s_bfe_u32 s64, s54, 0x40008
s_lshl_b32 s64, s64, 15
s_add_u32 s64, s64, s56
s_add_u32 s65, s64, 16384
s_add_u32 m0, s58, 16384
s_waitcnt vmcnt(7)
buffer_load_dwordx4 v8, s[24:27], s64 offen  lds
s_add_u32 m0, s58, 17408
s_waitcnt vmcnt(7)
buffer_load_dwordx4 v9, s[24:27], s64 offen  lds
s_add_u32 m0, s58, 18432
s_waitcnt vmcnt(7)
buffer_load_dwordx4 v8, s[24:27], s65 offen  lds
s_add_u32 m0, s58, 19456
s_waitcnt vmcnt(7)
buffer_load_dwordx4 v9, s[24:27], s65 offen  lds
s_waitcnt vmcnt(20)
ds_read_b64_tr_b16 v[160:161], v13 offset:16384
ds_read_b64_tr_b16 v[162:163], v13 offset:18432
ds_read_b64_tr_b16 v[164:165], v14 offset:16384
ds_read_b64_tr_b16 v[166:167], v14 offset:18432
ds_read_b64_tr_b16 v[168:169], v15 offset:16384
ds_read_b64_tr_b16 v[170:171], v15 offset:18432
ds_read_b64_tr_b16 v[172:173], v2 offset:16384
ds_read_b64_tr_b16 v[174:175], v2 offset:18432
s_waitcnt lgkmcnt(8)
s_bfe_u32 s64, s54, 0x4000c
s_lshl_b32 s64, s64, 15
s_add_u32 s64, s64, s56
s_add_u32 s65, s64, 16384
s_add_u32 m0, s58, 102400
s_waitcnt vmcnt(7)
buffer_load_dwordx4 v8, s[24:27], s64 offen  lds
s_add_u32 m0, s58, 103424
s_waitcnt vmcnt(7)
buffer_load_dwordx4 v9, s[24:27], s64 offen  lds
s_add_u32 m0, s58, 104448
s_waitcnt vmcnt(7)
buffer_load_dwordx4 v8, s[24:27], s65 offen  lds
s_add_u32 m0, s58, 105472
s_waitcnt vmcnt(7)
buffer_load_dwordx4 v9, s[24:27], s65 offen  lds
s_waitcnt vmcnt(12)
ds_read_b64_tr_b16 v[176:177], v13 offset:32768
ds_read_b64_tr_b16 v[178:179], v13 offset:34816
ds_read_b64_tr_b16 v[180:181], v14 offset:32768
ds_read_b64_tr_b16 v[182:183], v14 offset:34816
ds_read_b64_tr_b16 v[184:185], v15 offset:32768
ds_read_b64_tr_b16 v[186:187], v15 offset:34816
ds_read_b64_tr_b16 v[188:189], v2 offset:32768
ds_read_b64_tr_b16 v[190:191], v2 offset:34816
s_waitcnt lgkmcnt(8)
s_bfe_u32 s64, s54, 0x40018
s_lshl_b32 s64, s64, 15
s_add_u32 s64, s64, s56
s_add_u32 s65, s64, 16384
s_add_u32 m0, s58, 118784
s_waitcnt vmcnt(7)
buffer_load_dwordx4 v8, s[24:27], s64 offen  lds
s_add_u32 m0, s58, 119808
s_waitcnt vmcnt(7)
buffer_load_dwordx4 v9, s[24:27], s64 offen  lds
s_add_u32 m0, s58, 120832
s_waitcnt vmcnt(7)
buffer_load_dwordx4 v8, s[24:27], s65 offen  lds
s_add_u32 m0, s58, 121856
s_waitcnt vmcnt(7)
buffer_load_dwordx4 v9, s[24:27], s65 offen  lds
s_waitcnt vmcnt(12)
ds_read_b64_tr_b16 v[192:193], v4 offset:0
ds_read_b64_tr_b16 v[194:195], v4 offset:2048
ds_read_b64_tr_b16 v[196:197], v5 offset:0
ds_read_b64_tr_b16 v[198:199], v5 offset:2048
ds_read_b64_tr_b16 v[200:201], v6 offset:0
ds_read_b64_tr_b16 v[202:203], v6 offset:2048
ds_read_b64_tr_b16 v[204:205], v7 offset:0
ds_read_b64_tr_b16 v[206:207], v7 offset:2048
s_waitcnt lgkmcnt(8)
s_bfe_u32 s64, s54, 0x4001c
s_lshl_b32 s64, s64, 15
s_add_u32 s64, s64, s56
s_add_u32 s65, s64, 16384
s_add_u32 m0, s58, 135168
s_waitcnt vmcnt(7)
buffer_load_dwordx4 v8, s[24:27], s64 offen  lds
s_add_u32 m0, s58, 136192
s_waitcnt vmcnt(7)
buffer_load_dwordx4 v9, s[24:27], s64 offen  lds
s_mov_b32 s68, 0
s_atomic_add s68, s[16:17], s99 glc
s_add_u32 s69, s50, 4
s_add_u32 m0, s58, 137216
s_waitcnt vmcnt(7)
buffer_load_dwordx4 v8, s[24:27], s65 offen  lds
s_add_u32 m0, s58, 138240
s_waitcnt vmcnt(7)
buffer_load_dwordx4 v9, s[24:27], s65 offen  lds
s_waitcnt vmcnt(12)
ds_read_b64_tr_b16 v[96:97], v4 offset:16384
ds_read_b64_tr_b16 v[98:99], v4 offset:18432
ds_read_b64_tr_b16 v[100:101], v5 offset:16384
ds_read_b64_tr_b16 v[102:103], v5 offset:18432
ds_read_b64_tr_b16 v[104:105], v6 offset:16384
ds_read_b64_tr_b16 v[106:107], v6 offset:18432
ds_read_b64_tr_b16 v[108:109], v7 offset:16384
ds_read_b64_tr_b16 v[110:111], v7 offset:18432
s_waitcnt lgkmcnt(8)
s_bfe_u32 s64, s55, 0x40008
s_lshl_b32 s64, s64, 15
s_add_u32 s64, s64, s56
s_add_u32 s65, s64, 16384
s_add_u32 m0, s58, 0
s_waitcnt vmcnt(7)
buffer_load_dwordx4 v8, s[24:27], s64 offen  lds
s_add_u32 m0, s58, 1024
s_waitcnt vmcnt(7)
buffer_load_dwordx4 v9, s[24:27], s64 offen  lds
s_add_u32 m0, s58, 2048
s_waitcnt vmcnt(7)
buffer_load_dwordx4 v8, s[24:27], s65 offen  lds
s_add_u32 m0, s58, 3072
s_waitcnt vmcnt(7)
buffer_load_dwordx4 v9, s[24:27], s65 offen  lds
s_waitcnt lgkmcnt(0)
s_bfe_u32 s64, s55, 0x4000c
s_lshl_b32 s64, s64, 15
s_add_u32 s64, s64, s56
s_add_u32 s65, s64, 16384
s_add_u32 m0, s58, 16384
s_waitcnt vmcnt(7)
buffer_load_dwordx4 v8, s[24:27], s64 offen  lds
s_add_u32 m0, s58, 17408
s_waitcnt vmcnt(7)
buffer_load_dwordx4 v9, s[24:27], s64 offen  lds
s_waitcnt lgkmcnt(0)
s_cmp_eq_u32 s68, s69
s_cbranch_scc1 H0_6
s_mov_b32 s68, 0
s_atomic_add s68, s[16:17], s99 glc
H0_6:
s_add_u32 m0, s58, 18432
s_waitcnt vmcnt(7)
buffer_load_dwordx4 v8, s[24:27], s65 offen  lds
s_add_u32 m0, s58, 19456
s_waitcnt vmcnt(7)
buffer_load_dwordx4 v9, s[24:27], s65 offen  lds
s_waitcnt lgkmcnt(0)
s_cmp_eq_u32 s68, s69
s_cbranch_scc1 H1_7
s_add_u32 s42, s50, 4
s_mov_b32 s51, 400000
SP_8:
s_mov_b32 s41, 0
s_atomic_add s41, s[16:17], s99 glc
s_waitcnt lgkmcnt(0)
s_cmp_eq_u32 s41, s42
s_cbranch_scc1 SD_9
s_sleep 2
s_sub_u32 s51, s51, 1
s_cbranch_scc0 SP_8
SD_9:
H1_7:
s_bfe_u32 s67, s54, 0x40000
s_lshl_b32 s67, s67, 12
s_add_u32 s67, s67, s57
buffer_load_dwordx4 v[208:211], v10, s[16:19], s67 offen sc1
buffer_load_dwordx4 v[212:215], v11, s[16:19], s67 offen sc1
buffer_load_dwordx4 v[216:219], v12, s[16:19], s67 offen sc1
buffer_load_dwordx4 v[220:223], v0, s[16:19], s67 offen sc1
s_bfe_u32 s67, s54, 0x40004
s_lshl_b32 s67, s67, 12
s_add_u32 s67, s67, s57
buffer_load_dwordx4 v[224:227], v10, s[16:19], s67 offen sc1
buffer_load_dwordx4 v[228:231], v11, s[16:19], s67 offen sc1
buffer_load_dwordx4 v[232:235], v12, s[16:19], s67 offen sc1
buffer_load_dwordx4 v[236:239], v0, s[16:19], s67 offen sc1
s_bfe_u32 s67, s54, 0x40008
s_lshl_b32 s67, s67, 12
s_add_u32 s67, s67, s57
buffer_load_dwordx4 v[240:243], v10, s[16:19], s67 offen sc1
buffer_load_dwordx4 v[244:247], v11, s[16:19], s67 offen sc1
buffer_load_dwordx4 v[248:251], v12, s[16:19], s67 offen sc1
s_add_u32 s69, s50, 4
s_mov_b32 s68, 0
s_atomic_add s68, s[16:17], s99 offset:8192 glc
s_waitcnt vmcnt(10)
v_mfma_f32_16x16x32_bf16 v[16:19], v[112:115], v[208:211], 0
v_mfma_f32_16x16x32_bf16 v[20:23], v[116:119], v[208:211], 0
s_xor_b32 s42, s100, 2
s_lshl_b32 s101, s42, 12
s_lshl2_add_u32 s101, s58, s101
s_lshl_b32 s41, s42, 15
s_add_u32 s41, s41, s98
s_add_u32 s42, s41, 16384
s_add_u32 m0, s101, 32768
s_nop 0
buffer_load_dwordx4 v8, s[32:35], s41 offen  lds
v_mfma_f32_16x16x32_bf16 v[24:27], v[120:123], v[208:211], 0
v_mfma_f32_16x16x32_bf16 v[28:31], v[124:127], v[208:211], 0
buffer_load_dwordx4 v[252:255], v0, s[16:19], s67 offen sc1
s_waitcnt vmcnt(11)
v_mfma_f32_16x16x32_bf16 v[44:47], v[124:127], v[212:215], 0
s_bfe_u32 s67, s54, 0x4000c
v_mfma_f32_16x16x32_bf16 v[40:43], v[120:123], v[212:215], 0
s_lshl_b32 s67, s67, 12
v_mfma_f32_16x16x32_bf16 v[36:39], v[116:119], v[212:215], 0
s_add_u32 s67, s67, s57
v_mfma_f32_16x16x32_bf16 v[32:35], v[112:115], v[212:215], 0
buffer_load_dwordx4 v[208:211], v10, s[16:19], s67 offen sc1
s_waitcnt vmcnt(11)
v_mfma_f32_16x16x32_bf16 v[48:51], v[112:115], v[216:219], 0
v_mfma_f32_16x16x32_bf16 v[52:55], v[116:119], v[216:219], 0
s_add_u32 m0, s101, 33792
s_nop 0
buffer_load_dwordx4 v8, s[32:35], s42 offen  lds
v_mfma_f32_16x16x32_bf16 v[56:59], v[120:123], v[216:219], 0
v_mfma_f32_16x16x32_bf16 v[60:63], v[124:127], v[216:219], 0
buffer_load_dwordx4 v[212:215], v11, s[16:19], s67 offen sc1
s_waitcnt vmcnt(12)
v_mfma_f32_16x16x32_bf16 v[76:79], v[124:127], v[220:223], 0
v_mfma_f32_16x16x32_bf16 v[72:75], v[120:123], v[220:223], 0
s_add_u32 m0, s101, 34816
s_nop 0
buffer_load_dwordx4 v9, s[32:35], s41 offen  lds
v_mfma_f32_16x16x32_bf16 v[68:71], v[116:119], v[220:223], 0
v_mfma_f32_16x16x32_bf16 v[64:67], v[112:115], v[220:223], 0
buffer_load_dwordx4 v[216:219], v12, s[16:19], s67 offen sc1
s_waitcnt lgkmcnt(0)
s_cmp_eq_u32 s68, s69
s_cbranch_scc1 H2_10
s_mov_b32 s70, s41
s_mov_b32 s71, s42
s_add_u32 s42, s50, 4
s_mov_b32 s51, 400000
SP_11:
WS_F3:
WS_1239:
s_cbranch_execz WS_7116
s_nop 0
s_mov_b32 s41, 0
s_atomic_add s41, s[16:17], s99 offset:8192 glc
s_waitcnt lgkmcnt(0)
s_cmp_eq_u32 s41, s42
s_cbranch_scc1 SD_12
s_sleep 2
s_sub_u32 s51, s51, 1
s_cbranch_scc0 SP_11
SD_12:
s_mov_b32 s41, s70
s_mov_b32 s42, s71
H2_10:
s_waitcnt vmcnt(13)
v_mfma_f32_16x16x32_bf16 v[16:19], v[80:83], v[224:227], v[16:19]
ds_read_b64_tr_b16 v[112:113], v13 offset:0
v_mfma_f32_16x16x32_bf16 v[20:23], v[84:87], v[224:227], v[20:23]
s_add_u32 m0, s101, 35840
s_nop 0
buffer_load_dwordx4 v9, s[32:35], s42 offen  lds
ds_read_b64_tr_b16 v[114:115], v13 offset:2048
v_mfma_f32_16x16x32_bf16 v[24:27], v[88:91], v[224:227], v[24:27]
ds_read_b64_tr_b16 v[116:117], v14 offset:0
v_mfma_f32_16x16x32_bf16 v[28:31], v[92:95], v[224:227], v[28:31]
buffer_load_dwordx4 v[220:223], v0, s[16:19], s67 offen sc1
s_waitcnt vmcnt(14)
v_mfma_f32_16x16x32_bf16 v[44:47], v[92:95], v[228:231], v[44:47]
s_bfe_u32 s67, s54, 0x40010
ds_read_b64_tr_b16 v[118:119], v14 offset:2048
v_mfma_f32_16x16x32_bf16 v[40:43], v[88:91], v[228:231], v[40:43]
s_lshl_b32 s67, s67, 12
ds_read_b64_tr_b16 v[120:121], v15 offset:0
v_mfma_f32_16x16x32_bf16 v[36:39], v[84:87], v[228:231], v[36:39]
s_add_u32 s67, s67, s57
ds_read_b64_tr_b16 v[122:123], v15 offset:2048
v_mfma_f32_16x16x32_bf16 v[32:35], v[80:83], v[228:231], v[32:35]
buffer_load_dwordx4 v[224:227], v10, s[16:19], s67 offen sc1
s_waitcnt vmcnt(14)
v_mfma_f32_16x16x32_bf16 v[48:51], v[80:83], v[232:235], v[48:51]
ds_read_b64_tr_b16 v[124:125], v2 offset:0
v_mfma_f32_16x16x32_bf16 v[52:55], v[84:87], v[232:235], v[52:55]
s_xor_b32 s42, s100, 3
s_lshl_b32 s101, s42, 12
s_lshl2_add_u32 s101, s58, s101
s_lshl_b32 s41, s42, 15
s_add_u32 s41, s41, s98
s_add_u32 s42, s41, 16384
s_add_u32 m0, s101, 32768
s_nop 0
buffer_load_dwordx4 v8, s[32:35], s41 offen  lds
ds_read_b64_tr_b16 v[126:127], v2 offset:2048
v_mfma_f32_16x16x32_bf16 v[56:59], v[88:91], v[232:235], v[56:59]
v_mfma_f32_16x16x32_bf16 v[60:63], v[92:95], v[232:235], v[60:63]
buffer_load_dwordx4 v[228:231], v11, s[16:19], s67 offen sc1
s_waitcnt vmcnt(15)
v_mfma_f32_16x16x32_bf16 v[76:79], v[92:95], v[236:239], v[76:79]
v_mfma_f32_16x16x32_bf16 v[72:75], v[88:91], v[236:239], v[72:75]
s_add_u32 m0, s101, 33792
s_nop 0
buffer_load_dwordx4 v8, s[32:35], s42 offen  lds
v_mfma_f32_16x16x32_bf16 v[68:71], v[84:87], v[236:239], v[68:71]
v_mfma_f32_16x16x32_bf16 v[64:67], v[80:83], v[236:239], v[64:67]
buffer_load_dwordx4 v[232:235], v12, s[16:19], s67 offen sc1
s_mov_b32 s68, 0
s_atomic_add s68, s[16:17], s99 offset:128 glc
s_waitcnt vmcnt(16)
v_mfma_f32_16x16x32_bf16 v[16:19], v[96:99], v[240:243], v[16:19]
ds_read_b64_tr_b16 v[80:81], v13 offset:16384
v_mfma_f32_16x16x32_bf16 v[20:23], v[100:103], v[240:243], v[20:23]
s_add_u32 m0, s101, 34816
s_nop 0
buffer_load_dwordx4 v9, s[32:35], s41 offen  lds
ds_read_b64_tr_b16 v[82:83], v13 offset:18432
v_mfma_f32_16x16x32_bf16 v[24:27], v[104:107], v[240:243], v[24:27]
ds_read_b64_tr_b16 v[84:85], v14 offset:16384
v_mfma_f32_16x16x32_bf16 v[28:31], v[108:111], v[240:243], v[28:31]
buffer_load_dwordx4 v[236:239], v0, s[16:19], s67 offen sc1
s_waitcnt vmcnt(17)
v_mfma_f32_16x16x32_bf16 v[44:47], v[108:111], v[244:247], v[44:47]
s_bfe_u32 s67, s54, 0x40014
ds_read_b64_tr_b16 v[86:87], v14 offset:18432
v_mfma_f32_16x16x32_bf16 v[40:43], v[104:107], v[244:247], v[40:43]
s_lshl_b32 s67, s67, 12
ds_read_b64_tr_b16 v[88:89], v15 offset:16384
v_mfma_f32_16x16x32_bf16 v[36:39], v[100:103], v[244:247], v[36:39]
s_add_u32 s67, s67, s57
ds_read_b64_tr_b16 v[90:91], v15 offset:18432
v_mfma_f32_16x16x32_bf16 v[32:35], v[96:99], v[244:247], v[32:35]
buffer_load_dwordx4 v[240:243], v10, s[16:19], s67 offen sc1
s_waitcnt vmcnt(17)
v_mfma_f32_16x16x32_bf16 v[48:51], v[96:99], v[248:251], v[48:51]
ds_read_b64_tr_b16 v[92:93], v2 offset:16384
v_mfma_f32_16x16x32_bf16 v[52:55], v[100:103], v[248:251], v[52:55]
s_add_u32 m0, s101, 35840
s_nop 0
buffer_load_dwordx4 v9, s[32:35], s42 offen  lds
ds_read_b64_tr_b16 v[94:95], v2 offset:18432
v_mfma_f32_16x16x32_bf16 v[56:59], v[104:107], v[248:251], v[56:59]
v_mfma_f32_16x16x32_bf16 v[60:63], v[108:111], v[248:251], v[60:63]
buffer_load_dwordx4 v[244:247], v11, s[16:19], s67 offen sc1
s_waitcnt vmcnt(17)
v_mfma_f32_16x16x32_bf16 v[76:79], v[108:111], v[252:255], v[76:79]
v_mfma_f32_16x16x32_bf16 v[72:75], v[104:107], v[252:255], v[72:75]
v_mfma_f32_16x16x32_bf16 v[68:71], v[100:103], v[252:255], v[68:71]
v_mfma_f32_16x16x32_bf16 v[64:67], v[96:99], v[252:255], v[64:67]
buffer_load_dwordx4 v[248:251], v12, s[16:19], s67 offen sc1
s_waitcnt lgkmcnt(8)
s_setprio 2
s_waitcnt vmcnt(17)
v_mfma_f32_16x16x32_bf16 v[16:19], v[112:115], v[208:211], v[16:19]
ds_read_b64_tr_b16 v[96:97], v13 offset:32768
v_mfma_f32_16x16x32_bf16 v[20:23], v[116:119], v[208:211], v[20:23]
s_bfe_u32 s64, s55, 0x40014
s_lshl_b32 s64, s64, 15
s_add_u32 s64, s64, s56
s_add_u32 s65, s64, 16384
s_add_u32 m0, s58, 102400
s_mov_b32 exec_lo, 0
v_add_u32 v8, 0x1000, v8
s_mov_b32 exec_lo, -1
buffer_load_dwordx4 v8, s[24:27], s64 offen  lds
ds_read_b64_tr_b16 v[98:99], v13 offset:34816
v_mfma_f32_16x16x32_bf16 v[24:27], v[120:123], v[208:211], v[24:27]
ds_read_b64_tr_b16 v[100:101], v14 offset:32768
v_mfma_f32_16x16x32_bf16 v[28:31], v[124:127], v[208:211], v[28:31]
buffer_load_dwordx4 v[252:255], v0, s[16:19], s67 offen sc1
s_waitcnt vmcnt(17)
v_mfma_f32_16x16x32_bf16 v[44:47], v[124:127], v[212:215], v[44:47]
s_bfe_u32 s67, s54, 0x40018
ds_read_b64_tr_b16 v[102:103], v14 offset:34816
v_mfma_f32_16x16x32_bf16 v[40:43], v[120:123], v[212:215], v[40:43]
s_lshl_b32 s67, s67, 12
ds_read_b64_tr_b16 v[104:105], v15 offset:32768
v_mfma_f32_16x16x32_bf16 v[36:39], v[116:119], v[212:215], v[36:39]
s_add_u32 s67, s67, s57
ds_read_b64_tr_b16 v[106:107], v15 offset:34816
v_mfma_f32_16x16x32_bf16 v[32:35], v[112:115], v[212:215], v[32:35]
buffer_load_dwordx4 v[208:211], v10, s[16:19], s67 offen sc1
s_waitcnt vmcnt(16)
v_mfma_f32_16x16x32_bf16 v[48:51], v[112:115], v[216:219], v[48:51]
ds_read_b64_tr_b16 v[108:109], v2 offset:32768
v_mfma_f32_16x16x32_bf16 v[52:55], v[116:119], v[216:219], v[52:55]
s_add_u32 m0, s58, 103424
s_nop 0
buffer_load_dwordx4 v8, s[24:27], s65 offen  lds
ds_read_b64_tr_b16 v[110:111], v2 offset:34816
v_mfma_f32_16x16x32_bf16 v[56:59], v[120:123], v[216:219], v[56:59]
v_mfma_f32_16x16x32_bf16 v[60:63], v[124:127], v[216:219], v[60:63]
buffer_load_dwordx4 v[212:215], v11, s[16:19], s67 offen sc1
s_waitcnt vmcnt(16)
v_mfma_f32_16x16x32_bf16 v[76:79], v[124:127], v[220:223], v[76:79]
v_mfma_f32_16x16x32_bf16 v[72:75], v[120:123], v[220:223], v[72:75]
s_add_u32 m0, s58, 104448
s_add_u32 s64, s64, 4096
s_add_u32 s65, s65, 4096
buffer_load_dwordx4 v8, s[24:27], s64 offen  lds
v_mfma_f32_16x16x32_bf16 v[68:71], v[116:119], v[220:223], v[68:71]
v_mfma_f32_16x16x32_bf16 v[64:67], v[112:115], v[220:223], v[64:67]
buffer_load_dwordx4 v[216:219], v12, s[16:19], s67 offen sc1
s_add_u32 m0, s58, 105472
s_nop 0
buffer_load_dwordx4 v8, s[24:27], s65 offen  lds
s_mov_b32 exec_lo, 0
v_subrev_u32 v8, 0x1000, v8
s_mov_b32 exec_lo, -1
s_waitcnt vmcnt(18)
v_mfma_f32_16x16x32_bf16 v[16:19], v[128:131], v[224:227], v[16:19]
ds_read_b64_tr_b16 v[112:113], v4 offset:0
v_mfma_f32_16x16x32_bf16 v[20:23], v[132:135], v[224:227], v[20:23]
ds_read_b64_tr_b16 v[114:115], v4 offset:2048
v_mfma_f32_16x16x32_bf16 v[24:27], v[136:139], v[224:227], v[24:27]
ds_read_b64_tr_b16 v[116:117], v5 offset:0
v_mfma_f32_16x16x32_bf16 v[28:31], v[140:143], v[224:227], v[28:31]
buffer_load_dwordx4 v[220:223], v0, s[16:19], s67 offen sc1
s_waitcnt vmcnt(17)
v_mfma_f32_16x16x32_bf16 v[44:47], v[140:143], v[228:231], v[44:47]
s_bfe_u32 s67, s54, 0x4001c
ds_read_b64_tr_b16 v[118:119], v5 offset:2048
v_mfma_f32_16x16x32_bf16 v[40:43], v[136:139], v[228:231], v[40:43]
s_lshl_b32 s67, s67, 12
ds_read_b64_tr_b16 v[120:121], v6 offset:0
v_mfma_f32_16x16x32_bf16 v[36:39], v[132:135], v[228:231], v[36:39]
s_add_u32 s67, s67, s57
ds_read_b64_tr_b16 v[122:123], v6 offset:2048
v_mfma_f32_16x16x32_bf16 v[32:35], v[128:131], v[228:231], v[32:35]
buffer_load_dwordx4 v[224:227], v10, s[16:19], s67 offen sc1
s_waitcnt vmcnt(16)
v_mfma_f32_16x16x32_bf16 v[48:51], v[128:131], v[232:235], v[48:51]
ds_read_b64_tr_b16 v[124:125], v7 offset:0
v_mfma_f32_16x16x32_bf16 v[52:55], v[132:135], v[232:235], v[52:55]
ds_read_b64_tr_b16 v[126:127], v7 offset:2048
v_mfma_f32_16x16x32_bf16 v[56:59], v[136:139], v[232:235], v[56:59]
v_mfma_f32_16x16x32_bf16 v[60:63], v[140:143], v[232:235], v[60:63]
buffer_load_dwordx4 v[228:231], v11, s[16:19], s67 offen sc1
s_waitcnt vmcnt(15)
v_mfma_f32_16x16x32_bf16 v[76:79], v[140:143], v[236:239], v[76:79]
v_mfma_f32_16x16x32_bf16 v[72:75], v[136:139], v[236:239], v[72:75]
v_mfma_f32_16x16x32_bf16 v[68:71], v[132:135], v[236:239], v[68:71]
v_mfma_f32_16x16x32_bf16 v[64:67], v[128:131], v[236:239], v[64:67]
buffer_load_dwordx4 v[232:235], v12, s[16:19], s67 offen sc1
s_waitcnt lgkmcnt(0)
s_cmp_eq_u32 s68, s69
s_cbranch_scc1 H2_13
s_mov_b32 s70, s41
s_mov_b32 s71, s42
s_add_u32 s42, s50, 4
s_mov_b32 s51, 400000
SP_14:
s_mov_b32 s41, 0
s_atomic_add s41, s[16:17], s99 offset:128 glc
s_waitcnt lgkmcnt(0)
s_cmp_eq_u32 s41, s42
s_cbranch_scc1 SD_15
s_sleep 2
s_sub_u32 s51, s51, 1
s_cbranch_scc0 SP_14
SD_15:
s_mov_b32 s41, s70
s_mov_b32 s42, s71
H2_13:
s_mov_b32 s68, 0
s_atomic_add s68, s[16:17], s99 offset:8320 glc
s_waitcnt vmcnt(15)
v_mfma_f32_16x16x32_bf16 v[16:19], v[144:147], v[240:243], v[16:19]
ds_read_b64_tr_b16 v[128:129], v4 offset:16384
v_mfma_f32_16x16x32_bf16 v[20:23], v[148:151], v[240:243], v[20:23]
ds_read_b64_tr_b16 v[130:131], v4 offset:18432
v_mfma_f32_16x16x32_bf16 v[24:27], v[152:155], v[240:243], v[24:27]
ds_read_b64_tr_b16 v[132:133], v5 offset:16384
v_mfma_f32_16x16x32_bf16 v[28:31], v[156:159], v[240:243], v[28:31]
buffer_load_dwordx4 v[236:239], v0, s[16:19], s67 offen sc1
s_waitcnt vmcnt(14)
v_mov_b32 v8, 154112
v_mov_b32 v9, 1
s_mov_b64 exec, 1
ds_add_u32 v8, v9 offset:4
s_mov_b64 exec, -1
v_mfma_f32_16x16x32_bf16 v[44:47], v[156:159], v[244:247], v[44:47]
s_bfe_u32 s67, s55, 0x40000
ds_read_b64_tr_b16 v[134:135], v5 offset:18432
v_mfma_f32_16x16x32_bf16 v[40:43], v[152:155], v[244:247], v[40:43]
s_lshl_b32 s67, s67, 12
ds_read_b64_tr_b16 v[136:137], v6 offset:16384
v_mfma_f32_16x16x32_bf16 v[36:39], v[148:151], v[244:247], v[36:39]
s_add_u32 s67, s67, s57
ds_read_b64_tr_b16 v[138:139], v6 offset:18432
v_mfma_f32_16x16x32_bf16 v[32:35], v[144:147], v[244:247], v[32:35]
buffer_load_dwordx4 v[240:243], v10, s[16:19], s67 offen sc1
s_waitcnt vmcnt(14)
v_mfma_f32_16x16x32_bf16 v[48:51], v[144:147], v[248:251], v[48:51]
ds_read_b64_tr_b16 v[140:141], v7 offset:16384
v_mfma_f32_16x16x32_bf16 v[52:55], v[148:151], v[248:251], v[52:55]
ds_read_b64_tr_b16 v[142:143], v7 offset:18432
v_mfma_f32_16x16x32_bf16 v[56:59], v[152:155], v[248:251], v[56:59]
v_mfma_f32_16x16x32_bf16 v[60:63], v[156:159], v[248:251], v[60:63]
buffer_load_dwordx4 v[244:247], v11, s[16:19], s67 offen sc1
s_waitcnt vmcnt(13)
v_mfma_f32_16x16x32_bf16 v[76:79], v[156:159], v[252:255], v[76:79]
v_mfma_f32_16x16x32_bf16 v[72:75], v[152:155], v[252:255], v[72:75]
v_mfma_f32_16x16x32_bf16 v[68:71], v[148:151], v[252:255], v[68:71]
v_mfma_f32_16x16x32_bf16 v[64:67], v[144:147], v[252:255], v[64:67]
buffer_load_dwordx4 v[248:251], v12, s[16:19], s67 offen sc1
s_waitcnt vmcnt(13)
v_mfma_f32_16x16x32_bf16 v[16:19], v[80:83], v[208:211], v[16:19]
v_mfma_f32_16x16x32_bf16 v[20:23], v[84:87], v[208:211], v[20:23]
v_mfma_f32_16x16x32_bf16 v[24:27], v[88:91], v[208:211], v[24:27]
v_mfma_f32_16x16x32_bf16 v[28:31], v[92:95], v[208:211], v[28:31]
buffer_load_dwordx4 v[252:255], v0, s[16:19], s67 offen sc1
s_waitcnt vmcnt(12)
v_mfma_f32_16x16x32_bf16 v[44:47], v[92:95], v[212:215], v[44:47]
s_bfe_u32 s67, s55, 0x40004
v_mfma_f32_16x16x32_bf16 v[40:43], v[88:91], v[212:215], v[40:43]
s_lshl_b32 s67, s67, 12
v_mfma_f32_16x16x32_bf16 v[36:39], v[84:87], v[212:215], v[36:39]
s_add_u32 s67, s67, s57
v_mfma_f32_16x16x32_bf16 v[32:35], v[80:83], v[212:215], v[32:35]
buffer_load_dwordx4 v[208:211], v10, s[16:19], s67 offen sc1
s_waitcnt vmcnt(11)
v_mfma_f32_16x16x32_bf16 v[48:51], v[80:83], v[216:219], v[48:51]
v_mfma_f32_16x16x32_bf16 v[52:55], v[84:87], v[216:219], v[52:55]
v_mfma_f32_16x16x32_bf16 v[56:59], v[88:91], v[216:219], v[56:59]
v_mfma_f32_16x16x32_bf16 v[60:63], v[92:95], v[216:219], v[60:63]
buffer_load_dwordx4 v[212:215], v11, s[16:19], s67 offen sc1
s_waitcnt vmcnt(10)
v_mfma_f32_16x16x32_bf16 v[76:79], v[92:95], v[220:223], v[76:79]
v_mfma_f32_16x16x32_bf16 v[72:75], v[88:91], v[220:223], v[72:75]
v_mfma_f32_16x16x32_bf16 v[68:71], v[84:87], v[220:223], v[68:71]
v_mfma_f32_16x16x32_bf16 v[64:67], v[80:83], v[220:223], v[64:67]
buffer_load_dwordx4 v[216:219], v12, s[16:19], s67 offen sc1
s_waitcnt vmcnt(10)
v_mfma_f32_16x16x32_bf16 v[16:19], v[96:99], v[224:227], v[16:19]
v_mfma_f32_16x16x32_bf16 v[20:23], v[100:103], v[224:227], v[20:23]
v_mfma_f32_16x16x32_bf16 v[24:27], v[104:107], v[224:227], v[24:27]
v_mfma_f32_16x16x32_bf16 v[28:31], v[108:111], v[224:227], v[28:31]
buffer_load_dwordx4 v[220:223], v0, s[16:19], s67 offen sc1
s_waitcnt vmcnt(10)
v_mfma_f32_16x16x32_bf16 v[44:47], v[108:111], v[228:231], v[44:47]
s_bfe_u32 s67, s55, 0x40008
v_mfma_f32_16x16x32_bf16 v[40:43], v[104:107], v[228:231], v[40:43]
s_lshl_b32 s67, s67, 12
v_mfma_f32_16x16x32_bf16 v[36:39], v[100:103], v[228:231], v[36:39]
s_add_u32 s67, s67, s57
v_mfma_f32_16x16x32_bf16 v[32:35], v[96:99], v[228:231], v[32:35]
buffer_load_dwordx4 v[224:227], v10, s[16:19], s67 offen sc1
s_waitcnt vmcnt(10)
v_mfma_f32_16x16x32_bf16 v[48:51], v[96:99], v[232:235], v[48:51]
v_mfma_f32_16x16x32_bf16 v[52:55], v[100:103], v[232:235], v[52:55]
v_mfma_f32_16x16x32_bf16 v[56:59], v[104:107], v[232:235], v[56:59]
v_mfma_f32_16x16x32_bf16 v[60:63], v[108:111], v[232:235], v[60:63]
buffer_load_dwordx4 v[228:231], v11, s[16:19], s67 offen sc1
s_waitcnt vmcnt(10)
v_mfma_f32_16x16x32_bf16 v[76:79], v[108:111], v[236:239], v[76:79]
v_mfma_f32_16x16x32_bf16 v[72:75], v[104:107], v[236:239], v[72:75]
v_mfma_f32_16x16x32_bf16 v[68:71], v[100:103], v[236:239], v[68:71]
v_mfma_f32_16x16x32_bf16 v[64:67], v[96:99], v[236:239], v[64:67]
buffer_load_dwordx4 v[232:235], v12, s[16:19], s67 offen sc1
s_waitcnt lgkmcnt(0)
s_cmp_eq_u32 s68, s69
s_cbranch_scc1 H2_16
s_mov_b32 s70, s41
s_mov_b32 s71, s42
s_add_u32 s42, s50, 4
s_mov_b32 s51, 400000
SP_17:
s_mov_b32 s41, 0
s_atomic_add s41, s[16:17], s99 offset:8320 glc
s_waitcnt lgkmcnt(0)
s_cmp_eq_u32 s41, s42
s_cbranch_scc1 SD_18
s_sleep 2
s_sub_u32 s51, s51, 1
s_cbranch_scc0 SP_17
SD_18:
s_mov_b32 s41, s70
s_mov_b32 s42, s71
H2_16:
s_waitcnt vmcnt(10)
v_mfma_f32_16x16x32_bf16 v[16:19], v[160:163], v[240:243], v[16:19]
v_mfma_f32_16x16x32_bf16 v[20:23], v[164:167], v[240:243], v[20:23]
v_mfma_f32_16x16x32_bf16 v[24:27], v[168:171], v[240:243], v[24:27]
v_mfma_f32_16x16x32_bf16 v[28:31], v[172:175], v[240:243], v[28:31]
buffer_load_dwordx4 v[236:239], v0, s[16:19], s67 offen sc1
s_waitcnt vmcnt(10)
v_mfma_f32_16x16x32_bf16 v[44:47], v[172:175], v[244:247], v[44:47]
s_bfe_u32 s67, s55, 0x4000c
v_mfma_f32_16x16x32_bf16 v[40:43], v[168:171], v[244:247], v[40:43]
s_lshl_b32 s67, s67, 12
v_mfma_f32_16x16x32_bf16 v[36:39], v[164:167], v[244:247], v[36:39]
s_add_u32 s67, s67, s57
v_mfma_f32_16x16x32_bf16 v[32:35], v[160:163], v[244:247], v[32:35]
buffer_load_dwordx4 v[244:247], v11, s[16:19], s67 offen sc1
s_waitcnt vmcnt(10)
v_mfma_f32_16x16x32_bf16 v[48:51], v[160:163], v[248:251], v[48:51]
s_bfe_u32 s43, s55, 0x40010
v_mfma_f32_16x16x32_bf16 v[52:55], v[164:167], v[248:251], v[52:55]
s_lshl_b32 s43, s43, 12
v_mfma_f32_16x16x32_bf16 v[56:59], v[168:171], v[248:251], v[56:59]
s_add_u32 s43, s43, s57
v_mfma_f32_16x16x32_bf16 v[60:63], v[172:175], v[248:251], v[60:63]
buffer_load_dwordx4 v[100:103], v11, s[16:19], s43 offen sc1
s_waitcnt vmcnt(10)
v_mfma_f32_16x16x32_bf16 v[76:79], v[172:175], v[252:255], v[76:79]
s_bfe_u32 s45, s55, 0x40014
v_mfma_f32_16x16x32_bf16 v[72:75], v[168:171], v[252:255], v[72:75]
s_lshl_b32 s45, s45, 12
v_mfma_f32_16x16x32_bf16 v[68:71], v[164:167], v[252:255], v[68:71]
s_add_u32 s45, s45, s57
v_mfma_f32_16x16x32_bf16 v[64:67], v[160:163], v[252:255], v[64:67]
buffer_load_dwordx4 v[164:167], v11, s[16:19], s45 offen sc1
s_waitcnt vmcnt(10)
v_mfma_f32_16x16x32_bf16 v[16:19], v[176:179], v[208:211], v[16:19]
ds_read_b64_tr_b16 v[144:145], v13 offset:0
v_mfma_f32_16x16x32_bf16 v[20:23], v[180:183], v[208:211], v[20:23]
ds_read_b64_tr_b16 v[146:147], v13 offset:2048
v_mfma_f32_16x16x32_bf16 v[24:27], v[184:187], v[208:211], v[24:27]
ds_read_b64_tr_b16 v[148:149], v14 offset:0
v_mfma_f32_16x16x32_bf16 v[28:31], v[188:191], v[208:211], v[28:31]
buffer_load_dwordx4 v[248:251], v12, s[16:19], s67 offen sc1
s_waitcnt vmcnt(10)
v_mfma_f32_16x16x32_bf16 v[44:47], v[188:191], v[212:215], v[44:47]
ds_read_b64_tr_b16 v[150:151], v14 offset:2048
v_mfma_f32_16x16x32_bf16 v[40:43], v[184:187], v[212:215], v[40:43]
ds_read_b64_tr_b16 v[152:153], v15 offset:0
v_mfma_f32_16x16x32_bf16 v[36:39], v[180:183], v[212:215], v[36:39]
ds_read_b64_tr_b16 v[154:155], v15 offset:2048
v_mfma_f32_16x16x32_bf16 v[32:35], v[176:179], v[212:215], v[32:35]
buffer_load_dwordx4 v[104:107], v12, s[16:19], s43 offen sc1
s_waitcnt vmcnt(10)
v_mfma_f32_16x16x32_bf16 v[48:51], v[176:179], v[216:219], v[48:51]
ds_read_b64_tr_b16 v[156:157], v2 offset:0
v_mfma_f32_16x16x32_bf16 v[52:55], v[180:183], v[216:219], v[52:55]
ds_read_b64_tr_b16 v[158:159], v2 offset:2048
v_mfma_f32_16x16x32_bf16 v[56:59], v[184:187], v[216:219], v[56:59]
v_mfma_f32_16x16x32_bf16 v[60:63], v[188:191], v[216:219], v[60:63]
buffer_load_dwordx4 v[168:171], v12, s[16:19], s45 offen sc1
s_waitcnt vmcnt(10)
v_mfma_f32_16x16x32_bf16 v[76:79], v[188:191], v[220:223], v[76:79]
v_mfma_f32_16x16x32_bf16 v[72:75], v[184:187], v[220:223], v[72:75]
v_mfma_f32_16x16x32_bf16 v[68:71], v[180:183], v[220:223], v[68:71]
v_mfma_f32_16x16x32_bf16 v[64:67], v[176:179], v[220:223], v[64:67]
buffer_load_dwordx4 v[252:255], v0, s[16:19], s67 offen sc1
s_waitcnt vmcnt(10)
v_mfma_f32_16x16x32_bf16 v[16:19], v[112:115], v[224:227], v[16:19]
s_add_u32 s41, s58, 102400
v_mfma_f32_16x16x32_bf16 v[20:23], v[116:119], v[224:227], v[20:23]
v_add_u32 v80, s41, v3
v_mfma_f32_16x16x32_bf16 v[24:27], v[120:123], v[224:227], v[24:27]
s_sub_u32 s41, s39, 1
v_mfma_f32_16x16x32_bf16 v[28:31], v[124:127], v[224:227], v[28:31]
s_and_b32 s41, s41, 3
buffer_load_dwordx4 v[108:111], v0, s[16:19], s43 offen sc1
s_waitcnt vmcnt(10)
v_mfma_f32_16x16x32_bf16 v[44:47], v[124:127], v[228:231], v[44:47]
s_lshl_b32 s41, s41, 12
v_mfma_f32_16x16x32_bf16 v[40:43], v[120:123], v[228:231], v[40:43]
s_add_u32 s41, s41, 102400
v_mfma_f32_16x16x32_bf16 v[36:39], v[116:119], v[228:231], v[36:39]
v_add_u32 v84, s41, v3
v_mfma_f32_16x16x32_bf16 v[32:35], v[112:115], v[228:231], v[32:35]
s_sub_u32 s41, s39, 2
buffer_load_dwordx4 v[172:175], v0, s[16:19], s45 offen sc1
s_waitcnt vmcnt(10)
v_mfma_f32_16x16x32_bf16 v[48:51], v[112:115], v[232:235], v[48:51]
s_and_b32 s41, s41, 3
v_mfma_f32_16x16x32_bf16 v[52:55], v[116:119], v[232:235], v[52:55]
s_lshl_b32 s41, s41, 12
v_mfma_f32_16x16x32_bf16 v[56:59], v[120:123], v[232:235], v[56:59]
s_add_u32 s41, s41, 118784
v_mfma_f32_16x16x32_bf16 v[60:63], v[124:127], v[232:235], v[60:63]
v_add_u32 v85, s41, v3
buffer_load_dwordx4 v[240:243], v10, s[16:19], s67 offen sc1
s_waitcnt vmcnt(10)
v_mfma_f32_16x16x32_bf16 v[76:79], v[124:127], v[236:239], v[76:79]
s_sub_u32 s41, s39, 3
v_mfma_f32_16x16x32_bf16 v[72:75], v[120:123], v[236:239], v[72:75]
s_and_b32 s41, s41, 3
v_mfma_f32_16x16x32_bf16 v[68:71], v[116:119], v[236:239], v[68:71]
s_lshl_b32 s41, s41, 12
v_mfma_f32_16x16x32_bf16 v[64:67], v[112:115], v[236:239], v[64:67]
s_add_u32 s41, s41, 135168
buffer_load_dwordx4 v[96:99], v10, s[16:19], s43 offen sc1
s_waitcnt vmcnt(10)
v_mfma_f32_16x16x32_bf16 v[32:35], v[128:131], v[244:247], v[32:35]
v_add_u32_e64 v86, s41, v3
v_mfma_f32_16x16x32_bf16 v[36:39], v[132:135], v[244:247], v[36:39]
v_mov_b32 v88, 0xbfb8aa3b
v_mfma_f32_16x16x32_bf16 v[40:43], v[136:139], v[244:247], v[40:43]
v_mov_b32 v89, v88
v_mfma_f32_16x16x32_bf16 v[44:47], v[140:143], v[244:247], v[44:47]
v_mov_b32 v90, 1.0
buffer_load_dwordx4 v[160:163], v10, s[16:19], s45 offen sc1
v_mov_b32 v8, 154112
v_lshlrev_b32_e64 v9, s39, 1
s_mov_b64 exec, 1
ds_add_u32 v8, v9 offset:12
s_mov_b64 exec, -1
s_waitcnt vmcnt(10)
v_mfma_f32_16x16x32_bf16 v[32:35], v[192:195], v[100:103], v[32:35]
v_mov_b32 v91, 1.0
v_mfma_f32_16x16x32_bf16 v[36:39], v[196:199], v[100:103], v[36:39]
v_add_u32_e64 v82, s58, v3
v_mfma_f32_16x16x32_bf16 v[40:43], v[200:203], v[100:103], v[40:43]
v_mov_b32 v83, 154112
v_mfma_f32_16x16x32_bf16 v[44:47], v[204:207], v[100:103], v[44:47]
v_mov_b32 v81, 1
s_waitcnt lgkmcnt(0)
s_waitcnt vmcnt(9)
v_mfma_f32_16x16x32_bf16 v[32:35], v[144:147], v[164:167], v[32:35]
v_mfma_f32_16x16x32_bf16 v[36:39], v[148:151], v[164:167], v[36:39]
v_mfma_f32_16x16x32_bf16 v[40:43], v[152:155], v[164:167], v[40:43]
v_mfma_f32_16x16x32_bf16 v[44:47], v[156:159], v[164:167], v[44:47]
s_waitcnt vmcnt(8)
v_mfma_f32_16x16x32_bf16 v[48:51], v[128:131], v[248:251], v[48:51]
v_mfma_f32_16x16x32_bf16 v[52:55], v[132:135], v[248:251], v[52:55]
v_mfma_f32_16x16x32_bf16 v[56:59], v[136:139], v[248:251], v[56:59]
s_nop 0
ds_write_b128 v80, v[32:35] offset:0
v_mfma_f32_16x16x32_bf16 v[60:63], v[140:143], v[248:251], v[60:63]
s_waitcnt vmcnt(7)
v_mfma_f32_16x16x32_bf16 v[48:51], v[192:195], v[104:107], v[48:51]
v_mfma_f32_16x16x32_bf16 v[52:55], v[196:199], v[104:107], v[52:55]
ds_write_b128 v80, v[36:39] offset:1024
v_mfma_f32_16x16x32_bf16 v[56:59], v[200:203], v[104:107], v[56:59]
v_mfma_f32_16x16x32_bf16 v[60:63], v[204:207], v[104:107], v[60:63]
s_waitcnt vmcnt(6)
v_mfma_f32_16x16x32_bf16 v[48:51], v[144:147], v[168:171], v[48:51]
ds_write_b128 v80, v[40:43] offset:2048
v_mfma_f32_16x16x32_bf16 v[52:55], v[148:151], v[168:171], v[52:55]
v_mfma_f32_16x16x32_bf16 v[56:59], v[152:155], v[168:171], v[56:59]
v_mfma_f32_16x16x32_bf16 v[60:63], v[156:159], v[168:171], v[60:63]
ds_write_b128 v80, v[44:47] offset:3072
s_waitcnt vmcnt(5)
v_mfma_f32_16x16x32_bf16 v[64:67], v[128:131], v[252:255], v[64:67]
v_mfma_f32_16x16x32_bf16 v[68:71], v[132:135], v[252:255], v[68:71]
v_mfma_f32_16x16x32_bf16 v[72:75], v[136:139], v[252:255], v[72:75]
ds_write_b128 v80, v[48:51] offset:16384
v_mfma_f32_16x16x32_bf16 v[76:79], v[140:143], v[252:255], v[76:79]
s_waitcnt vmcnt(4)
v_mfma_f32_16x16x32_bf16 v[64:67], v[192:195], v[108:111], v[64:67]
v_mfma_f32_16x16x32_bf16 v[68:71], v[196:199], v[108:111], v[68:71]
ds_write_b128 v80, v[52:55] offset:17408
v_mfma_f32_16x16x32_bf16 v[72:75], v[200:203], v[108:111], v[72:75]
v_mfma_f32_16x16x32_bf16 v[76:79], v[204:207], v[108:111], v[76:79]
s_waitcnt vmcnt(3)
v_mfma_f32_16x16x32_bf16 v[64:67], v[144:147], v[172:175], v[64:67]
ds_write_b128 v80, v[56:59] offset:18432
v_mfma_f32_16x16x32_bf16 v[68:71], v[148:151], v[172:175], v[68:71]
v_mfma_f32_16x16x32_bf16 v[72:75], v[152:155], v[172:175], v[72:75]
v_mfma_f32_16x16x32_bf16 v[76:79], v[156:159], v[172:175], v[76:79]
ds_write_b128 v80, v[60:63] offset:19456
s_waitcnt vmcnt(2)
v_mfma_f32_16x16x32_bf16 v[16:19], v[128:131], v[240:243], v[16:19]
v_mfma_f32_16x16x32_bf16 v[20:23], v[132:135], v[240:243], v[20:23]
v_mfma_f32_16x16x32_bf16 v[24:27], v[136:139], v[240:243], v[24:27]
ds_write_b128 v80, v[64:67] offset:32768
v_mfma_f32_16x16x32_bf16 v[28:31], v[140:143], v[240:243], v[28:31]
s_waitcnt vmcnt(1)
v_mfma_f32_16x16x32_bf16 v[16:19], v[192:195], v[96:99], v[16:19]
v_mfma_f32_16x16x32_bf16 v[20:23], v[196:199], v[96:99], v[20:23]
ds_write_b128 v80, v[68:71] offset:33792
v_mfma_f32_16x16x32_bf16 v[24:27], v[200:203], v[96:99], v[24:27]
v_mfma_f32_16x16x32_bf16 v[28:31], v[204:207], v[96:99], v[28:31]
s_waitcnt vmcnt(0)
v_mfma_f32_16x16x32_bf16 v[16:19], v[144:147], v[160:163], v[16:19]
ds_write_b128 v80, v[72:75] offset:34816
v_mfma_f32_16x16x32_bf16 v[20:23], v[148:151], v[160:163], v[20:23]
v_mfma_f32_16x16x32_bf16 v[24:27], v[152:155], v[160:163], v[24:27]
v_mfma_f32_16x16x32_bf16 v[28:31], v[156:159], v[160:163], v[28:31]
ds_write_b128 v80, v[76:79] offset:35840
s_setprio 2
s_mov_b64 exec, 1
ds_add_u32 v83, v81 offset:8
s_mov_b64 exec, -1
s_mov_b32 s51, 1600000
LS_19:
ds_read_b32 v81, v83 offset:8
s_waitcnt lgkmcnt(0)
v_readfirstlane_b32 s41, v81
s_nop 0
s_cmp_ge_u32 s41, 4
s_cbranch_scc1 LD_20
s_sub_u32 s51, s51, 1
s_cbranch_scc0 LS_19
LD_20:
ds_read_b128 v[112:115], v84 offset:0
ds_read_b128 v[128:131], v85 offset:0
ds_read_b128 v[144:147], v86 offset:0
ds_read_b128 v[116:119], v84 offset:1024
ds_read_b128 v[132:135], v85 offset:1024
ds_read_b128 v[148:151], v86 offset:1024
ds_read_b128 v[120:123], v84 offset:2048
ds_read_b128 v[136:139], v85 offset:2048
ds_read_b128 v[152:155], v86 offset:2048
ds_read_b128 v[124:127], v84 offset:3072
ds_read_b128 v[140:143], v85 offset:3072
ds_read_b128 v[156:159], v86 offset:3072
s_waitcnt lgkmcnt(9)
v_add_f32 v16, v16, v112
v_add_f32 v128, v128, v144
v_add_f32 v17, v17, v113
v_add_f32 v129, v129, v145
v_add_f32 v18, v18, v114
v_add_f32 v130, v130, v146
v_add_f32 v19, v19, v115
v_add_f32 v131, v131, v147
v_add_f32 v16, v16, v128
v_add_f32 v17, v17, v129
v_add_f32 v18, v18, v130
v_add_f32 v19, v19, v131
v_exp_f32 v32, v16
v_exp_f32 v33, v17
v_exp_f32 v34, v18
v_exp_f32 v35, v19
v_fma_f32 v32, v32, v88, v88
v_fma_f32 v33, v33, v88, v88
v_fma_f32 v34, v34, v88, v88
v_fma_f32 v35, v35, v88, v88
v_rcp_f32 v32, v32
v_rcp_f32 v33, v33
v_rcp_f32 v34, v34
v_rcp_f32 v35, v35
v_mul_f32 v32, v32, v16
v_mul_f32 v33, v33, v17
v_mul_f32 v34, v34, v18
v_mul_f32 v35, v35, v19
ds_write_b128 v82, v[32:35] offset:0
s_waitcnt lgkmcnt(7)
v_add_f32 v20, v20, v116
v_add_f32 v132, v132, v148
v_add_f32 v21, v21, v117
v_add_f32 v133, v133, v149
v_add_f32 v22, v22, v118
v_add_f32 v134, v134, v150
v_add_f32 v23, v23, v119
v_add_f32 v135, v135, v151
v_add_f32 v20, v20, v132
v_add_f32 v21, v21, v133
v_add_f32 v22, v22, v134
v_add_f32 v23, v23, v135
v_exp_f32 v36, v20
v_exp_f32 v37, v21
v_exp_f32 v38, v22
v_exp_f32_e64 v39, v23
v_fma_f32 v36, v36, v88, v88
v_fma_f32 v37, v37, v88, v88
v_fma_f32 v38, v38, v88, v88
v_fma_f32 v39, v39, v88, v88
v_rcp_f32 v36, v36
v_rcp_f32 v37, v37
v_rcp_f32 v38, v38
v_rcp_f32 v39, v39
v_mul_f32 v36, v36, v20
v_mul_f32 v37, v37, v21
v_mul_f32 v38, v38, v22
v_mul_f32 v39, v39, v23
ds_write_b128 v82, v[36:39] offset:1024
s_waitcnt lgkmcnt(5)
v_add_f32 v24, v24, v120
v_add_f32 v136, v136, v152
v_add_f32 v25, v25, v121
v_add_f32 v137, v137, v153
v_add_f32 v26, v26, v122
v_add_f32 v138, v138, v154
v_add_f32 v27, v27, v123
v_add_f32 v139, v139, v155
v_add_f32 v24, v24, v136
v_add_f32 v25, v25, v137
v_add_f32 v26, v26, v138
v_add_f32 v27, v27, v139
v_exp_f32 v40, v24
v_exp_f32 v41, v25
v_exp_f32 v42, v26
v_exp_f32_e64 v43, v27
v_fma_f32 v40, v40, v88, v88
v_fma_f32 v41, v41, v88, v88
v_fma_f32 v42, v42, v88, v88
v_fma_f32 v43, v43, v88, v88
WS_1875:
s_cbranch_execz WR_F
s_nop 0
v_rcp_f32 v40, v40
v_rcp_f32 v41, v41
v_rcp_f32 v42, v42
v_rcp_f32 v43, v43
v_mul_f32 v40, v40, v24
v_mul_f32 v41, v41, v25
v_mul_f32 v42, v42, v26
v_mul_f32 v43, v43, v27
ds_write_b128 v82, v[40:43] offset:2048
s_waitcnt lgkmcnt(3)
v_add_f32 v28, v28, v124
v_add_f32 v140, v140, v156
v_add_f32 v29, v29, v125
v_add_f32 v141, v141, v157
v_add_f32 v30, v30, v126
v_add_f32 v142, v142, v158
v_add_f32 v31, v31, v127
v_add_f32 v143, v143, v159
v_add_f32 v28, v28, v140
v_add_f32 v29, v29, v141
v_add_f32 v30, v30, v142
v_add_f32 v31, v31, v143
v_exp_f32 v44, v28
v_exp_f32 v45, v29
v_exp_f32 v46, v30
v_exp_f32_e64 v47, v31
v_fma_f32 v44, v44, v88, v88
v_fma_f32 v45, v45, v88, v88
v_fma_f32 v46, v46, v88, v88
v_fma_f32 v47, v47, v88, v88
v_rcp_f32 v44, v44
v_rcp_f32 v45, v45
v_rcp_f32 v46, v46
v_rcp_f32 v47, v47
v_mul_f32 v44, v44, v28
v_mul_f32 v45, v45, v29
v_mul_f32 v46, v46, v30
v_mul_f32 v47, v47, v31
ds_write_b128 v82, v[44:47] offset:3072
s_waitcnt lgkmcnt(0)
s_setprio 0
s_barrier
s_branch K_end
.p2align 12
K_LA:
s_setprio 1
s_load_dwordx2 s[24:25], s[0:1], 48
s_mov_b32 s26, 1835008
s_mov_b32 s27, 0x20000
s_load_dwordx2 s[32:33], s[0:1], 24
s_mov_b32 s34, 524288
s_mov_b32 s35, 0x20000
s_load_dwordx2 s[20:21], s[0:1], 16
s_mov_b32 s22, 16384
s_mov_b32 s23, 0x20000
s_sub_u32 s49, s49, 4096
v_or_b32 v64, 0x8000, v10
v_or_b32 v65, 0x8000, v11
v_and_b32 v10, 0xffff7fff, v10
v_and_b32 v11, 0xffff7fff, v11
s_bitcmp1_b32 s2, 5
s_cselect_b32 s4, 0, 98304
v_subrev_u32 v12, s4, v12
v_add_u32 v66, 98304, v12
s_and_b32 s4, s40, 3
s_lshl_b32 s4, s4, 2
s_lshr_b32 s4, 0x32103210, s4
s_and_b32 s4, s4, 0xffff
s_lshl_b32 s4, s4, 16
s_and_b32 s5, s36, 7
s_and_b32 s6, s59, 3
s_add_u32 s5, s5, s6
s_lshl_b32 s5, s5, 1
s_lshr_b32 s5, 1198372, s5
s_and_b32 s5, s5, 3
s_lshl_b32 s5, s5, 2
s_lshr_b32 s5, 0x213210, s5
s_and_b32 s5, s5, 0xfff0
s_or_b32 s4, s4, s5
s_cmp_ge_u32 s40, 4
s_mov_b32 s5, 0x44440000
s_cmovk_i32 s5, 0x4444
s_or_b32 s40, s4, s5
s_bfe_u32 s41, s40, 0x40004
s_lshl_b32 s43, s41, 7
s_add_u32 s43, s43, s46
s_mul_i32 s41, s41, 196608
s_add_u32 s44, s41, s47
s_add_u32 m0, s49, 45056
s_nop 0
buffer_load_dwordx4 v10, s[8:11], s43 offen lds
s_add_u32 m0, s49, 61440
s_nop 0
buffer_load_dwordx4 v12, s[12:15], s44 offen lds
s_add_u32 m0, s49, 68608
s_nop 0
buffer_load_dwordx4 v12, s[12:15], s44 offen offset:1024 lds
s_add_u32 m0, s49, 49152
s_nop 0
buffer_load_dwordx4 v64, s[8:11], s43 offen lds
s_add_u32 m0, s49, 75776
s_nop 0
buffer_load_dwordx4 v12, s[12:15], s44 offen offset:2048 lds
s_and_b32 s4, s2, 7
s_lshr_b32 s5, s2, 3
s_and_b32 s6, s5, 15
s_lshr_b32 s6, 0x880, s6
s_and_b32 s6, s6, 1
s_mul_i32 s6, s6, 12
s_xor_b32 s5, s5, s6
s_lshl_b32 s4, s4, 2
s_lshr_b32 s6, s5, 3
s_add_u32 s52, s4, s6
s_and_b32 s53, s5, 7
s_and_b32 s7, s53, 3
s_cmp_eq_u32 s7, 3
s_cselect_b32 s7, 3, 2
s_and_b32 s6, s6, s7
s_add_u32 s6, s6, s53
s_and_b32 s7, s6, 3
s_lshl_b32 s7, s7, 2
s_lshr_b32 s4, 0x98109810, s7
s_and_b32 s4, s4, 0xffff
s_mul_i32 s54, s4, 0x10001
s_add_u32 s54, s54, 0x22220000
s_bitcmp1_b32 s6, 1
s_cselect_b32 s5, 0x110000, 0
s_xor_b32 s5, s5, 0x764444
s_add_u32 s55, s4, s5
s_mul_i32 s4, s39, 14
s_mul_i32 s57, s52, 72
s_add_u32 s57, s57, s4
s_lshl_b32 s57, s57, 12
s_add_u32 s57, s57, 1048576
s_lshl_b32 s56, s4, 15
s_lshl_b32 s5, s53, 7
s_add_u32 s56, s56, s5
s_lshl_b32 s98, s39, 17
s_add_u32 s98, s98, s5
s_lshl_b32 s58, s39, 12
v_lshrrev_b32 v16, 3, v1
v_and_b32 v17, 6, v16
v_and_b32 v18, 7, v1
v_xor_b32 v17, v17, v18
v_lshlrev_b32_e64 v17, 4, v17
v_lshl_add_u32 v8, v16, 10, v17
v_add_u32 v9, 0x2000, v8
v_lshrrev_b32 v16, 2, v1
v_lshlrev_b32 v16, 7, v16
v_and_b32_e64 v17, 3, v1
v_lshl_add_u32 v16, v17, 3, v16
v_add_u32_e64 v16, s58, v16
v_bfe_u32 v17, v1, 3, 2
v_xor_b32_e64 v4, 0, v17
v_lshl_add_u32 v4, v4, 5, v16
v_xor_b32_e64 v5, 1, v17
v_lshl_add_u32 v5, v5, 5, v16
v_xor_b32_e64 v6, 2, v17
v_lshl_add_u32 v6, v6, 5, v16
v_xor_b32_e64 v7, 3, v17
v_lshl_add_u32 v7, v7, 5, v16
v_add_u32 v13, 102400, v4
v_add_u32 v14, 102400, v5
v_add_u32 v15, 102400, v6
v_add_u32 v2, 102400, v7
v_mov_b32 v70, 154112
v_mov_b32 v71, 1
s_lshr_b32 s99, s52, 1
s_lshl_b32 s99, s99, 14
s_and_b32 s4, s52, 1
s_lshl_b32 s4, s4, 11
s_add_u32 s99, s99, s4
s_add_u32 s99, s99, 525312
s_lshl_b32 s4, s39, 8
s_add_u32 s99, s99, s4
v_and_b32 v24, 15, v1
v_lshrrev_b32 v25, 4, v1
s_mov_b32 s4, 7
s_mov_b32 s5, 3
s_mov_b32 s6, 0
s_min_u32 s7, s39, 2
s_lshl_b32 s7, s7, 13
s_and_b32 s41, s36, 7
s_lshr_b32 s41, 0xb8, s41
s_and_b32 s41, s41, 1
s_lshl_b32 s41, s41, 5
s_lshr_b32 s66, s66, 6
s_lshl_b32 s42, s39, 5
s_add_u32 s66, s66, s42
s_add_u32 s51, s66, 196608
s_lshl_b32 s42, s39, 4
s_add_u32 s42, s42, 154176
v_and_b32_e64 v76, 1, v1
v_lshl_add_u32 v76, v76, 3, s42
v_lshrrev_b32_e64 v77, 1, v1
v_lshl_add_u32 v77, v77, 26, v3
v_lshrrev_b32_e64 v16, 2, v24
v_lshl_add_u32 v16, v25, 3, v16
v_add_u32 v16, s41, v16
v_lshlrev_b32 v16, s4, v16
v_and_b32_e64 v17, 3, v24
v_lshl_add_u32 v16, v17, 3, v16
s_add_u32 s7, s7, 106496
s_and_b32 s42, s36, 6
s_cmp_lg_u32 s42, 6
s_cselect_b32 s42, 45056, 0
s_sub_u32 s7, s7, s42
v_add_u32 v16, s7, v16
v_lshrrev_b32 v18, 3, v24
v_and_b32 v17, 1, v25
v_lshl_or_b32 v18, v17, 1, v18
v_lshrrev_b32 v18, s6, v18
v_xor_b32 v17, 0, v18
v_and_b32_e64 v17, s5, v17
v_lshl_add_u32 v20, v17, 5, v16
v_xor_b32 v17, 1, v18
v_and_b32 v17, s5, v17
v_lshl_add_u32 v21, v17, 5, v16
v_xor_b32 v17, 2, v18
v_and_b32 v17, s5, v17
v_lshl_add_u32 v22, v17, 5, v16
v_xor_b32 v17, 3, v18
v_and_b32 v17, s5, v17
v_lshl_add_u32 v23, v17, 5, v16
s_lshl_b32 s5, 4, s4
s_nop 0
v_mov_b32 v28, 0x3f803f80
v_mov_b32 v29, 0x3f803f80
v_mov_b32 v30, 0x3f803f80
v_mov_b32 v31, 0x3f803f80
v_mov_b32 v26, 154112
v_mov_b32 v27, 0xff
s_lshl_b32 s67, s59, 14
s_lshl_b32 s41, s39, 8
s_add_u32 s67, s67, s41
s_add_u32 s67, s67, 262144
s_lshl_b32 s41, s36, 10
s_add_u32 s68, s67, s41
s_lshl_b32 s66, s36, 2
s_add_u32 s66, s66, s39
s_lshl_b32 s66, s66, 9
s_add_u32 s66, s66, 196608
s_lshl2_add_u32 s41, s37, s39
s_lshr_b32 s41, s41, 1
s_lshl_b32 s41, s41, 10
s_add_u32 m0, s49, 155648
s_waitcnt lgkmcnt(0)
buffer_load_dwordx4 v3, s[20:23], s41 offen lds
v_mov_b32 v96, 0
v_mov_b32 v97, 0
v_mov_b32 v98, 0
v_mov_b32 v99, 0
s_lshl_b32 s42, s36, 10
v_add_u32 v100, s42, v3
v_cmp_lt_u32 vcc, 2160, v100
s_nop 1
v_cndmask_b32 v100, v100, v28, vcc
s_lshl2_add_u32 s41, s37, s39
s_mul_i32 s41, s41, 2176
s_add_u32 s41, s41, 65536
buffer_store_dwordx4 v[96:99], v100, s[16:19], s41 offen sc1
s_add_u32 m0, s49, 53248
s_nop 0
buffer_load_dwordx4 v11, s[8:11], s43 offen lds
s_add_u32 m0, s49, 65536
s_nop 0
buffer_load_dwordx4 v66, s[12:15], s44 offen lds
s_add_u32 m0, s49, 72704
s_nop 0
buffer_load_dwordx4 v66, s[12:15], s44 offen offset:1024 lds
s_add_u32 m0, s49, 57344
s_nop 0
buffer_load_dwordx4 v65, s[8:11], s43 offen lds
s_add_u32 m0, s49, 79872
s_nop 0
buffer_load_dwordx4 v66, s[12:15], s44 offen offset:2048 lds
s_waitcnt vmcnt(12)
s_barrier
ds_read_b32 v26, v26
ds_read_b64 v[72:73], v76
s_and_b32 s42, s36, 6
s_cmp_eq_u32 s42, 6
s_cbranch_scc0 CS_21
ds_read_b64_tr_b16 v[32:33], v20
ds_read_b64_tr_b16 v[36:37], v21
ds_read_b64_tr_b16 v[40:41], v22
ds_read_b64_tr_b16 v[44:45], v23
v_add_u32 v20, s5, v20
v_add_u32 v21, s5, v21
v_add_u32 v22, s5, v22
v_add_u32 v23, s5, v23
ds_read_b64_tr_b16 v[34:35], v20
ds_read_b64_tr_b16 v[38:39], v21
ds_read_b64_tr_b16 v[42:43], v22
ds_read_b64_tr_b16 v[46:47], v23
CS_21:
s_bfe_u32 s41, s40, 0x40008
s_lshl_b32 s43, s41, 7
s_add_u32 s43, s43, s46
s_mul_i32 s41, s41, 196608
s_add_u32 s44, s41, s47
s_add_u32 m0, s49, 0
s_nop 0
buffer_load_dwordx4 v10, s[8:11], s43 offen lds
s_add_u32 m0, s49, 16384
s_nop 0
buffer_load_dwordx4 v12, s[12:15], s44 offen lds
s_add_u32 m0, s49, 23552
s_nop 0
buffer_load_dwordx4 v12, s[12:15], s44 offen offset:1024 lds
s_add_u32 m0, s49, 4096
s_nop 0
buffer_load_dwordx4 v64, s[8:11], s43 offen lds
s_add_u32 m0, s49, 30720
s_nop 0
buffer_load_dwordx4 v12, s[12:15], s44 offen offset:2048 lds
s_add_u32 m0, s49, 8192
s_nop 0
buffer_load_dwordx4 v11, s[8:11], s43 offen lds
s_waitcnt vmcnt(12)
v_bfe_u32 v248, v1, 3, 2
v_lshlrev_b32 v248, 3, v248
v_and_b32 v17, 3, v1
v_lshl_add_u32 v248, v17, 1, v248
v_lshrrev_b32_e64 v17, 5, v1
v_lshl_add_u32 v248, v17, 8, v248
s_and_b32 s41, s39, 1
s_lshl_b32 s41, s41, 9
s_add_u32 s41, s41, s49
s_add_u32 s41, s41, 155648
v_add_u32 v248, s41, v248
ds_read_u16 v240, v248 offset:0
ds_read_u16 v244, v248 offset:32
ds_read_u16 v241, v248 offset:64
ds_read_u16 v245, v248 offset:96
ds_read_u16 v242, v248 offset:128
ds_read_u16 v246, v248 offset:160
ds_read_u16 v243, v248 offset:192
ds_read_u16 v247, v248 offset:224
s_waitcnt vmcnt(6) lgkmcnt(0)
s_barrier
s_and_b32 s42, s36, 6
s_cmp_eq_u32 s42, 6
s_cbranch_scc1 CS_22
ds_read_b64_tr_b16 v[32:33], v20
ds_read_b64_tr_b16 v[36:37], v21
ds_read_b64_tr_b16 v[40:41], v22
ds_read_b64_tr_b16 v[44:45], v23
v_add_u32 v20, s5, v20
v_add_u32 v21, s5, v21
v_add_u32 v22, s5, v22
v_add_u32 v23, s5, v23
ds_read_b64_tr_b16 v[34:35], v20
ds_read_b64_tr_b16 v[38:39], v21
ds_read_b64_tr_b16 v[42:43], v22
ds_read_b64_tr_b16 v[46:47], v23
CS_22:
s_add_u32 m0, s49, 20480
s_nop 0
buffer_load_dwordx4 v66, s[12:15], s44 offen lds
s_add_u32 m0, s49, 27648
s_nop 0
buffer_load_dwordx4 v66, s[12:15], s44 offen offset:1024 lds
s_add_u32 m0, s49, 12288
s_nop 0
buffer_load_dwordx4 v65, s[8:11], s43 offen lds
s_add_u32 m0, s49, 34816
s_nop 0
buffer_load_dwordx4 v66, s[12:15], s44 offen offset:2048 lds
s_bfe_u32 s41, s40, 0x4000c
s_lshl_b32 s43, s41, 7
s_add_u32 s43, s43, s46
s_mul_i32 s41, s41, 196608
s_add_u32 s44, s41, s47
s_add_u32 m0, s49, 90112
s_nop 0
buffer_load_dwordx4 v10, s[8:11], s43 offen lds
s_add_u32 m0, s49, 106496
s_nop 0
buffer_load_dwordx4 v12, s[12:15], s44 offen lds
s_add_u32 m0, s49, 113664
s_nop 0
buffer_load_dwordx4 v12, s[12:15], s44 offen offset:1024 lds
s_add_u32 m0, s49, 94208
s_nop 0
buffer_load_dwordx4 v64, s[8:11], s43 offen lds
s_add_u32 m0, s49, 120832
s_nop 0
buffer_load_dwordx4 v12, s[12:15], s44 offen offset:2048 lds
s_add_u32 m0, s49, 98304
s_nop 0
buffer_load_dwordx4 v11, s[8:11], s43 offen lds
s_waitcnt lgkmcnt(0)
v_readfirstlane_b32 s50, v26
s_setprio 3
v_mfma_f32_16x16x32_bf16 v[48:51], v[28:31], v[32:35], 0
v_mfma_f32_16x16x32_bf16 v[52:55], v[28:31], v[36:39], 0
v_mfma_f32_16x16x32_bf16 v[56:59], v[28:31], v[40:43], 0
v_mfma_f32_16x16x32_bf16 v[60:63], v[28:31], v[44:47], 0
s_lshr_b32 s61, s50, 8
s_lshr_b32 s62, s50, 16
s_lshr_b32 s63, s50, 24
s_mov_b32 s96, 0x0c0c0400
s_mov_b32 s97, 0x04000c0c
v_lshrrev_b32_e64 v16, 4, v1
v_lshl_add_u32 v16, v16, 26, v3
v_bfi_b32 v48, v27, s50, v48
v_bfi_b32 v49, v27, s61, v52
v_bfi_b32 v50, v27, s62, v56
v_bfi_b32 v51, v27, s63, v60
s_setprio 1
v_mov_b32 v74, v26
v_mov_b32 v75, v26
v_and_b32 v20, 15, v1
v_lshlrev_b32_e64 v20, 4, v20
v_lshl_add_u32 v20, v25, 10, v20
v_and_b32 v21, 0x1f0, v3
s_add_u32 s69, s67, 4096
s_add_u32 s70, s67, 8192
s_add_u32 s71, s67, 12288
buffer_store_dwordx4 v[48:51], v16, s[16:19], s68 offen sc1
buffer_store_dwordx4 v[72:75], v77, s[16:19], s51 offen sc1
s_cmp_gt_u32 s59, 6
s_subb_u32 s41, s59, 0
s_lshl4_add_u32 s41, s41, s36
s_lshl2_add_u32 s41, s41, s39
s_cmp_eq_u32 s59, 6
s_cselect_b32 s41, 0x10000, s41
s_sub_u32 s42, s41, 448
s_lshl_b32 s42, s42, 10
s_lshl_b32 s41, s41, 11
s_mov_b32 m0, 159744
s_min_u32 s42, s42, 1073741824
buffer_load_dwordx4 v3, s[24:27], s41 offen offset:0  lds
buffer_load_dwordx4 v3, s[24:27], s41 offen offset:1024  lds
buffer_load_dwordx4 v3, s[32:35], s42 offen  lds
v_bfe_u32 v17, v1, 2, 1
v_mul_u32_u24 v17, 0x8000, v17
v_lshl_or_b32 v17, v17, 16, v17
v_lshl_or_b32 v240, v244, 16, v240
v_xor_b32_e64 v240, v240, v17
v_lshl_or_b32 v241, v245, 16, v241
v_xor_b32_e64 v241, v241, v17
v_lshl_or_b32 v242, v246, 16, v242
v_xor_b32_e64 v242, v242, v17
v_lshl_or_b32 v243, v247, 16, v243
v_xor_b32 v243, v243, v17
s_add_u32 s41, s49, 155648
v_add_u32 v248, s41, v3
ds_write_b128 v248, v[240:243]
s_waitcnt vmcnt(11) lgkmcnt(0)
s_barrier
s_add_u32 m0, s49, 110592
s_nop 0
buffer_load_dwordx4 v66, s[12:15], s44 offen lds
s_add_u32 m0, s49, 117760
s_nop 0
buffer_load_dwordx4 v66, s[12:15], s44 offen offset:1024 lds
s_add_u32 m0, s49, 102400
s_nop 0
buffer_load_dwordx4 v65, s[8:11], s43 offen lds
s_add_u32 m0, s49, 124928
s_nop 0
buffer_load_dwordx4 v66, s[12:15], s44 offen offset:2048 lds
s_bfe_u32 s41, s40, 0x40010
s_lshl_b32 s43, s41, 7
s_add_u32 s43, s43, s46
s_mul_i32 s41, s41, 196608
s_add_u32 s44, s41, s47
s_add_u32 m0, s49, 45056
s_nop 0
buffer_load_dwordx4 v10, s[8:11], s43 offen lds
s_add_u32 m0, s49, 61440
s_nop 0
buffer_load_dwordx4 v12, s[12:15], s44 offen lds
s_add_u32 m0, s49, 68608
s_nop 0
buffer_load_dwordx4 v12, s[12:15], s44 offen offset:1024 lds
s_add_u32 m0, s49, 49152
s_nop 0
buffer_load_dwordx4 v64, s[8:11], s43 offen lds
s_add_u32 m0, s49, 75776
s_nop 0
buffer_load_dwordx4 v12, s[12:15], s44 offen offset:2048 lds
s_add_u32 m0, s49, 53248
s_nop 0
buffer_load_dwordx4 v11, s[8:11], s43 offen lds
s_add_u32 m0, s49, 65536
s_nop 0
buffer_load_dwordx4 v66, s[12:15], s44 offen lds
s_add_u32 m0, s49, 72704
s_nop 0
buffer_load_dwordx4 v66, s[12:15], s44 offen offset:1024 lds
s_add_u32 m0, s49, 57344
s_nop 0
buffer_load_dwordx4 v65, s[8:11], s43 offen lds
s_add_u32 m0, s49, 79872
s_nop 0
buffer_load_dwordx4 v66, s[12:15], s44 offen offset:2048 lds
s_waitcnt vmcnt(10)
s_barrier
s_bfe_u32 s41, s40, 0x40014
s_lshl_b32 s43, s41, 7
s_add_u32 s43, s43, s46
s_mul_i32 s41, s41, 196608
s_add_u32 s44, s41, s47
s_add_u32 m0, s49, 0
s_nop 0
buffer_load_dwordx4 v10, s[8:11], s43 offen lds
s_add_u32 m0, s49, 16384
s_nop 0
buffer_load_dwordx4 v12, s[12:15], s44 offen lds
s_add_u32 m0, s49, 23552
s_nop 0
buffer_load_dwordx4 v12, s[12:15], s44 offen offset:1024 lds
s_add_u32 m0, s49, 4096
s_nop 0
buffer_load_dwordx4 v64, s[8:11], s43 offen lds
s_add_u32 m0, s49, 30720
s_nop 0
buffer_load_dwordx4 v12, s[12:15], s44 offen offset:2048 lds
s_add_u32 m0, s49, 8192
s_nop 0
buffer_load_dwordx4 v11, s[8:11], s43 offen lds
s_add_u32 m0, s49, 20480
s_nop 0
buffer_load_dwordx4 v66, s[12:15], s44 offen lds
s_add_u32 m0, s49, 27648
s_nop 0
buffer_load_dwordx4 v66, s[12:15], s44 offen offset:1024 lds
s_add_u32 m0, s49, 12288
s_nop 0
buffer_load_dwordx4 v65, s[8:11], s43 offen lds
s_add_u32 m0, s49, 34816
s_nop 0
buffer_load_dwordx4 v66, s[12:15], s44 offen offset:2048 lds
s_waitcnt vmcnt(10)
s_barrier
s_bfe_u32 s41, s40, 0x40018
s_lshl_b32 s43, s41, 7
s_add_u32 s43, s43, s46
s_mul_i32 s41, s41, 196608
s_add_u32 s44, s41, s47
s_add_u32 m0, s49, 90112
s_nop 0
buffer_load_dwordx4 v10, s[8:11], s43 offen lds
s_add_u32 m0, s49, 106496
s_nop 0
buffer_load_dwordx4 v12, s[12:15], s44 offen lds
s_add_u32 m0, s49, 113664
s_nop 0
buffer_load_dwordx4 v12, s[12:15], s44 offen offset:1024 lds
s_add_u32 m0, s49, 94208
s_nop 0
buffer_load_dwordx4 v64, s[8:11], s43 offen lds
s_add_u32 m0, s49, 120832
s_nop 0
buffer_load_dwordx4 v12, s[12:15], s44 offen offset:2048 lds
s_add_u32 m0, s49, 98304
s_nop 0
buffer_load_dwordx4 v11, s[8:11], s43 offen lds
s_add_u32 m0, s49, 110592
s_nop 0
buffer_load_dwordx4 v66, s[12:15], s44 offen lds
s_add_u32 m0, s49, 117760
s_nop 0
buffer_load_dwordx4 v66, s[12:15], s44 offen offset:1024 lds
s_add_u32 m0, s49, 102400
s_nop 0
buffer_load_dwordx4 v65, s[8:11], s43 offen lds
s_add_u32 m0, s49, 124928
s_nop 0
buffer_load_dwordx4 v66, s[12:15], s44 offen offset:2048 lds
s_waitcnt vmcnt(10)
s_barrier
s_bfe_u32 s41, s40, 0x4001c
s_lshl_b32 s43, s41, 7
s_add_u32 s43, s43, s46
s_mul_i32 s41, s41, 196608
s_add_u32 s44, s41, s47
s_add_u32 m0, s49, 45056
s_nop 0
buffer_load_dwordx4 v10, s[8:11], s43 offen lds
s_add_u32 m0, s49, 61440
s_nop 0
buffer_load_dwordx4 v12, s[12:15], s44 offen lds
s_add_u32 m0, s49, 68608
s_nop 0
buffer_load_dwordx4 v12, s[12:15], s44 offen offset:1024 lds
s_add_u32 m0, s49, 49152
s_nop 0
buffer_load_dwordx4 v64, s[8:11], s43 offen lds
s_add_u32 m0, s49, 75776
s_nop 0
buffer_load_dwordx4 v12, s[12:15], s44 offen offset:2048 lds
s_add_u32 m0, s49, 53248
s_nop 0
buffer_load_dwordx4 v11, s[8:11], s43 offen lds
s_add_u32 m0, s49, 65536
s_nop 0
buffer_load_dwordx4 v66, s[12:15], s44 offen lds
s_add_u32 m0, s49, 72704
s_nop 0
buffer_load_dwordx4 v66, s[12:15], s44 offen offset:1024 lds
s_add_u32 m0, s49, 57344
s_nop 0
buffer_load_dwordx4 v65, s[8:11], s43 offen lds
s_add_u32 m0, s49, 79872
s_nop 0
buffer_load_dwordx4 v66, s[12:15], s44 offen offset:2048 lds
buffer_load_dwordx4 v[48:51], v21, s[16:19], s66 offen sc1
buffer_load_dwordx4 v[32:35], v20, s[16:19], s67 offen sc1
buffer_load_dwordx4 v[36:39], v20, s[16:19], s69 offen sc1
buffer_load_dwordx4 v[40:43], v20, s[16:19], s70 offen sc1
buffer_load_dwordx4 v[44:47], v20, s[16:19], s71 offen sc1
s_waitcnt vmcnt(15)
s_barrier
s_add_u32 s41, s39, 0
s_and_b32 s41, s41, 3
s_lshl_b32 s41, s41, 10
v_add_u32 v10, s41, v3
s_add_u32 s41, s39, 1
s_and_b32 s41, s41, 3
s_lshl_b32 s41, s41, 10
v_add_u32 v11, s41, v3
s_add_u32 s41, s39, 2
s_and_b32 s41, s41, 3
s_lshl_b32 s41, s41, 10
v_add_u32 v12, s41, v3
s_add_u32 s41, s39, 3
s_and_b32 s41, s41, 3
s_lshl_b32 s41, s41, 10
v_add_u32 v0, s41, v3
s_lshr_b32 s41, s2, 4
s_and_b32 s41, s41, 8
s_and_b32 s42, s36, 7
s_add_u32 s41, s41, s42
s_lshl2_add_u32 s42, s41, s39
s_mul_i32 s41, s42, 28672
s_mov_b32 m0, 159744
s_nop 0
buffer_load_dwordx4 v8, s[24:27], s41 offen offset:384 lds
s_add_u32 s41, s41, 8192
buffer_load_dwordx4 v8, s[24:27], s41 offen offset:384 lds
s_add_u32 s41, s41, 8192
buffer_load_dwordx4 v8, s[24:27], s41 offen offset:384 lds
s_add_u32 s41, s41, 4096
buffer_load_dwordx4 v8, s[24:27], s41 offen offset:384 lds
s_lshl_b32 s42, s42, 13
buffer_load_dwordx4 v8, s[32:35], s42 offen offset:384 lds
s_bfe_u32 s64, s54, 0x40000
s_lshl_b32 s64, s64, 15
s_add_u32 s64, s64, s56
s_add_u32 s65, s64, 16384
s_add_u32 m0, s58, 135168
s_nop 0
buffer_load_dwordx4 v8, s[24:27], s64 offen  lds
s_add_u32 m0, s58, 136192
s_nop 0
buffer_load_dwordx4 v9, s[24:27], s64 offen  lds
s_add_u32 m0, s58, 137216
s_nop 0
buffer_load_dwordx4 v8, s[24:27], s65 offen  lds
s_add_u32 m0, s58, 138240
s_nop 0
buffer_load_dwordx4 v9, s[24:27], s65 offen  lds
s_waitcnt vmcnt(14) lgkmcnt(0)
s_barrier
s_waitcnt vmcnt(9)
s_mov_b32 s51, 400000
s_branch PC_24
PL_23:
buffer_load_dwordx4 v[48:51], v21, s[16:19], s66 offen sc1
buffer_load_dwordx4 v[32:35], v20, s[16:19], s67 offen sc1
buffer_load_dwordx4 v[36:39], v20, s[16:19], s69 offen sc1
buffer_load_dwordx4 v[40:43], v20, s[16:19], s70 offen sc1
buffer_load_dwordx4 v[44:47], v20, s[16:19], s71 offen sc1
s_waitcnt vmcnt(0)
s_nop 0
PC_24:
v_perm_b32 v56, v33, v32, s96
v_perm_b32 v60, v35, v34, s97
v_bitop3_b32 v56, v56, v60, s50 bitop3:0x96
v_perm_b32 v57, v37, v36, s96
v_perm_b32 v61, v39, v38, s97
v_bitop3_b32 v57, v57, v61, s50 bitop3:0x96
v_perm_b32 v58, v41, v40, s96
v_perm_b32 v62, v43, v42, s97
v_bitop3_b32 v58, v58, v62, s50 bitop3:0x96
v_perm_b32 v59, v45, v44, s96
v_perm_b32 v63, v47, v46, s97
v_bitop3_b32 v59, v59, v63, s50 bitop3:0x96
v_bitop3_b32 v60, v50, v51, s50 bitop3:0x7e
v_or3_b32 v56, v56, v57, v58
v_or3_b32 v56, v56, v59, v60
v_cmp_ne_u32 vcc, 0, v56
s_nop 0
s_and_b64 s[4:5], vcc, exec
s_cbranch_scc0 PD_25
s_sleep 2
s_sub_u32 s51, s51, 1
s_cbranch_scc0 PL_23
s_nop 0
PD_25:
v_and_b32 v32, 0xffffff00, v32
v_and_b32 v33, 0xffffff00, v33
v_and_b32 v34, 0xffffff00, v34
v_and_b32 v35, 0xffffff00, v35
v_and_b32 v36, 0xffffff00, v36
v_and_b32 v37, 0xffffff00, v37
v_and_b32 v38, 0xffffff00, v38
v_and_b32 v39, 0xffffff00, v39
v_and_b32 v40, 0xffffff00, v40
WS_A3:
WS_2587:
s_cbranch_execz WS_7116
s_nop 0
v_and_b32 v41, 0xffffff00, v41
v_and_b32 v42, 0xffffff00, v42
v_and_b32 v43, 0xffffff00, v43
v_and_b32 v44, 0xffffff00, v44
v_and_b32 v45, 0xffffff00, v45
v_and_b32 v46, 0xffffff00, v46
v_and_b32 v47, 0xffffff00, v47
v_add_f32 v32, v32, v36
v_add_f32 v40, v40, v44
v_add_f32 v33, v33, v37
v_add_f32 v41, v41, v45
v_add_f32 v34, v34, v38
v_add_f32 v42, v42, v46
v_add_f32 v35, v35, v39
v_add_f32 v43, v43, v47
v_add_f32 v32, v32, v40
v_add_f32 v33, v33, v41
v_add_f32 v34, v34, v42
v_add_f32 v35, v35, v43
s_lshl_b32 s41, s39, 8
v_permlane32_swap_b32 v32, v34
v_permlane32_swap_b32 v33, v35
v_add_f32 v32, v32, v34
v_add_f32 v33, v33, v35
s_add_u32 s41, s41, 153088
s_lshl_b32 s42, s39, 7
v_permlane16_swap_b32 v32, v33
v_add_f32 v32, v32, v33
v_lshl_add_u32 v20, v1, 2, s41
ds_write_b32 v20, v32
s_add_u32 s42, s42, 151552
v_lshrrev_b32 v21, 2, v21
v_add_u32 v21, s42, v21
v_sub_f32_e64 v48, 0, v48
ds_write_b32 v21, v48
v_mul_f32 v50, 0x3fb8aa3b, v49
ds_write_b32 v21, v50 offset:512
ds_write_b32 v21, v49 offset:1024
s_bfe_u32 s64, s54, 0x40004
s_lshl_b32 s64, s64, 15
s_add_u32 s64, s64, s56
s_add_u32 s65, s64, 16384
s_add_u32 m0, s58, 0
s_nop 0
buffer_load_dwordx4 v8, s[24:27], s64 offen  lds
s_add_u32 m0, s58, 1024
s_nop 0
buffer_load_dwordx4 v9, s[24:27], s64 offen  lds
s_add_u32 m0, s58, 2048
s_nop 0
buffer_load_dwordx4 v8, s[24:27], s65 offen  lds
s_add_u32 m0, s58, 3072
s_nop 0
buffer_load_dwordx4 v9, s[24:27], s65 offen  lds
s_bfe_u32 s64, s54, 0x40010
s_lshl_b32 s64, s64, 15
s_add_u32 s64, s64, s56
s_add_u32 s65, s64, 16384
s_add_u32 m0, s58, 16384
s_nop 0
buffer_load_dwordx4 v8, s[24:27], s64 offen  lds
s_add_u32 m0, s58, 17408
s_nop 0
buffer_load_dwordx4 v9, s[24:27], s64 offen  lds
s_add_u32 m0, s58, 18432
s_nop 0
buffer_load_dwordx4 v8, s[24:27], s65 offen  lds
s_add_u32 m0, s58, 19456
s_nop 0
buffer_load_dwordx4 v9, s[24:27], s65 offen  lds
s_waitcnt lgkmcnt(0)
s_barrier
s_setprio 0
s_and_b32 s100, s52, 2
s_bfe_u32 s64, s54, 0x40014
s_lshl_b32 s64, s64, 15
s_add_u32 s64, s64, s56
s_add_u32 s65, s64, 16384
s_add_u32 m0, s58, 102400
s_waitcnt vmcnt(6)
buffer_load_dwordx4 v8, s[24:27], s64 offen  lds
s_add_u32 m0, s58, 103424
s_waitcnt vmcnt(6)
buffer_load_dwordx4 v9, s[24:27], s64 offen  lds
s_add_u32 m0, s58, 104448
s_waitcnt vmcnt(6)
buffer_load_dwordx4 v8, s[24:27], s65 offen  lds
s_add_u32 m0, s58, 105472
s_waitcnt vmcnt(6)
buffer_load_dwordx4 v9, s[24:27], s65 offen  lds
s_xor_b32 s42, s100, 0
s_lshl_b32 s101, s42, 12
s_lshl2_add_u32 s101, s58, s101
s_lshl_b32 s41, s42, 15
s_add_u32 s41, s41, s98
s_add_u32 s42, s41, 16384
s_add_u32 m0, s101, 32768
s_waitcnt vmcnt(6)
buffer_load_dwordx4 v8, s[32:35], s41 offen  lds
s_add_u32 m0, s101, 33792
s_waitcnt vmcnt(6)
buffer_load_dwordx4 v8, s[32:35], s42 offen  lds
s_add_u32 m0, s101, 34816
s_waitcnt vmcnt(6)
buffer_load_dwordx4 v9, s[32:35], s41 offen  lds
s_add_u32 m0, s101, 35840
s_waitcnt vmcnt(6)
buffer_load_dwordx4 v9, s[32:35], s42 offen  lds
s_xor_b32 s42, s100, 1
s_lshl_b32 s101, s42, 12
s_lshl2_add_u32 s101, s58, s101
s_lshl_b32 s41, s42, 15
s_add_u32 s41, s41, s98
s_add_u32 s42, s41, 16384
s_add_u32 m0, s101, 32768
s_waitcnt vmcnt(6)
buffer_load_dwordx4 v8, s[32:35], s41 offen  lds
s_add_u32 m0, s101, 33792
s_waitcnt vmcnt(6)
buffer_load_dwordx4 v8, s[32:35], s42 offen  lds
s_add_u32 m0, s101, 34816
s_waitcnt vmcnt(6)
buffer_load_dwordx4 v9, s[32:35], s41 offen  lds
s_add_u32 m0, s101, 35840
s_waitcnt vmcnt(6)
buffer_load_dwordx4 v9, s[32:35], s42 offen  lds
s_bfe_u32 s64, s55, 0x40000
s_lshl_b32 s64, s64, 15
s_add_u32 s64, s64, s56
s_add_u32 s65, s64, 16384
s_add_u32 m0, s58, 118784
s_waitcnt vmcnt(6)
buffer_load_dwordx4 v8, s[24:27], s64 offen  lds
s_add_u32 m0, s58, 119808
s_waitcnt vmcnt(6)
buffer_load_dwordx4 v9, s[24:27], s64 offen  lds
s_add_u32 m0, s58, 120832
s_waitcnt vmcnt(6)
buffer_load_dwordx4 v8, s[24:27], s65 offen  lds
s_add_u32 m0, s58, 121856
s_waitcnt vmcnt(6)
buffer_load_dwordx4 v9, s[24:27], s65 offen  lds
s_waitcnt vmcnt(24)
ds_read_b64_tr_b16 v[112:113], v13 offset:32768
ds_read_b64_tr_b16 v[114:115], v13 offset:34816
ds_read_b64_tr_b16 v[116:117], v14 offset:32768
ds_read_b64_tr_b16 v[118:119], v14 offset:34816
ds_read_b64_tr_b16 v[120:121], v15 offset:32768
ds_read_b64_tr_b16 v[122:123], v15 offset:34816
ds_read_b64_tr_b16 v[124:125], v2 offset:32768
ds_read_b64_tr_b16 v[126:127], v2 offset:34816
s_waitcnt vmcnt(20)
ds_read_b64_tr_b16 v[80:81], v4 offset:0
ds_read_b64_tr_b16 v[82:83], v4 offset:2048
ds_read_b64_tr_b16 v[84:85], v5 offset:0
ds_read_b64_tr_b16 v[86:87], v5 offset:2048
ds_read_b64_tr_b16 v[88:89], v6 offset:0
ds_read_b64_tr_b16 v[90:91], v6 offset:2048
ds_read_b64_tr_b16 v[92:93], v7 offset:0
ds_read_b64_tr_b16 v[94:95], v7 offset:2048
s_waitcnt lgkmcnt(8)
s_bfe_u32 s64, s55, 0x40004
s_lshl_b32 s64, s64, 15
s_add_u32 s64, s64, s56
s_add_u32 s65, s64, 16384
s_add_u32 m0, s58, 135168
s_waitcnt vmcnt(6)
buffer_load_dwordx4 v8, s[24:27], s64 offen  lds
s_add_u32 m0, s58, 136192
s_waitcnt vmcnt(6)
buffer_load_dwordx4 v9, s[24:27], s64 offen  lds
s_add_u32 m0, s58, 137216
s_waitcnt vmcnt(6)
buffer_load_dwordx4 v8, s[24:27], s65 offen  lds
s_add_u32 m0, s58, 138240
s_waitcnt vmcnt(6)
buffer_load_dwordx4 v9, s[24:27], s65 offen  lds
s_waitcnt vmcnt(20)
ds_read_b64_tr_b16 v[128:129], v4 offset:16384
ds_read_b64_tr_b16 v[130:131], v4 offset:18432
ds_read_b64_tr_b16 v[132:133], v5 offset:16384
ds_read_b64_tr_b16 v[134:135], v5 offset:18432
ds_read_b64_tr_b16 v[136:137], v6 offset:16384
ds_read_b64_tr_b16 v[138:139], v6 offset:18432
ds_read_b64_tr_b16 v[140:141], v7 offset:16384
ds_read_b64_tr_b16 v[142:143], v7 offset:18432
s_waitcnt lgkmcnt(8)
s_bfe_u32 s64, s55, 0x40010
s_lshl_b32 s64, s64, 15
s_add_u32 s64, s64, s56
s_add_u32 s65, s64, 16384
s_add_u32 m0, s58, 0
s_waitcnt vmcnt(6)
s_mov_b32 exec_lo, 0
v_add_u32 v8, 0x1000, v8
s_mov_b32 exec_lo, -1
buffer_load_dwordx4 v8, s[24:27], s64 offen  lds
s_add_u32 m0, s58, 1024
s_waitcnt vmcnt(6)
buffer_load_dwordx4 v8, s[24:27], s65 offen  lds
s_add_u32 m0, s58, 2048
s_waitcnt vmcnt(6)
s_add_u32 s64, s64, 4096
s_add_u32 s65, s65, 4096
buffer_load_dwordx4 v8, s[24:27], s64 offen  lds
s_add_u32 m0, s58, 3072
s_waitcnt vmcnt(6)
buffer_load_dwordx4 v8, s[24:27], s65 offen  lds
s_mov_b32 exec_lo, 0
v_subrev_u32 v8, 0x1000, v8
s_mov_b32 exec_lo, -1
s_waitcnt vmcnt(20)
ds_read_b64_tr_b16 v[144:145], v13 offset:0
ds_read_b64_tr_b16 v[146:147], v13 offset:2048
ds_read_b64_tr_b16 v[148:149], v14 offset:0
ds_read_b64_tr_b16 v[150:151], v14 offset:2048
ds_read_b64_tr_b16 v[152:153], v15 offset:0
ds_read_b64_tr_b16 v[154:155], v15 offset:2048
ds_read_b64_tr_b16 v[156:157], v2 offset:0
ds_read_b64_tr_b16 v[158:159], v2 offset:2048
s_waitcnt lgkmcnt(8)
s_bfe_u32 s64, s54, 0x40008
s_lshl_b32 s64, s64, 15
s_add_u32 s64, s64, s56
s_add_u32 s65, s64, 16384
s_add_u32 m0, s58, 16384
s_waitcnt vmcnt(6)
buffer_load_dwordx4 v8, s[24:27], s64 offen  lds
s_add_u32 m0, s58, 17408
s_waitcnt vmcnt(6)
buffer_load_dwordx4 v9, s[24:27], s64 offen  lds
s_add_u32 m0, s58, 18432
s_waitcnt vmcnt(6)
buffer_load_dwordx4 v8, s[24:27], s65 offen  lds
s_add_u32 m0, s58, 19456
s_waitcnt vmcnt(6)
buffer_load_dwordx4 v9, s[24:27], s65 offen  lds
s_waitcnt vmcnt(12)
ds_read_b64_tr_b16 v[160:161], v13 offset:16384
ds_read_b64_tr_b16 v[162:163], v13 offset:18432
ds_read_b64_tr_b16 v[164:165], v14 offset:16384
ds_read_b64_tr_b16 v[166:167], v14 offset:18432
ds_read_b64_tr_b16 v[168:169], v15 offset:16384
ds_read_b64_tr_b16 v[170:171], v15 offset:18432
ds_read_b64_tr_b16 v[172:173], v2 offset:16384
ds_read_b64_tr_b16 v[174:175], v2 offset:18432
s_waitcnt lgkmcnt(8)
s_bfe_u32 s64, s54, 0x4000c
s_lshl_b32 s64, s64, 15
s_add_u32 s64, s64, s56
s_add_u32 s65, s64, 16384
s_add_u32 m0, s58, 102400
s_waitcnt vmcnt(6)
buffer_load_dwordx4 v8, s[24:27], s64 offen  lds
s_add_u32 m0, s58, 103424
s_waitcnt vmcnt(6)
buffer_load_dwordx4 v9, s[24:27], s64 offen  lds
s_add_u32 m0, s58, 104448
s_waitcnt vmcnt(6)
buffer_load_dwordx4 v8, s[24:27], s65 offen  lds
s_add_u32 m0, s58, 105472
s_waitcnt vmcnt(6)
buffer_load_dwordx4 v9, s[24:27], s65 offen  lds
s_waitcnt vmcnt(12)
ds_read_b64_tr_b16 v[176:177], v13 offset:32768
ds_read_b64_tr_b16 v[178:179], v13 offset:34816
ds_read_b64_tr_b16 v[180:181], v14 offset:32768
ds_read_b64_tr_b16 v[182:183], v14 offset:34816
ds_read_b64_tr_b16 v[184:185], v15 offset:32768
ds_read_b64_tr_b16 v[186:187], v15 offset:34816
ds_read_b64_tr_b16 v[188:189], v2 offset:32768
ds_read_b64_tr_b16 v[190:191], v2 offset:34816
s_waitcnt lgkmcnt(8)
s_bfe_u32 s64, s54, 0x40018
s_lshl_b32 s64, s64, 15
s_add_u32 s64, s64, s56
s_add_u32 s65, s64, 16384
s_add_u32 m0, s58, 118784
s_waitcnt vmcnt(6)
buffer_load_dwordx4 v8, s[24:27], s64 offen  lds
s_add_u32 m0, s58, 119808
s_waitcnt vmcnt(6)
buffer_load_dwordx4 v9, s[24:27], s64 offen  lds
s_add_u32 m0, s58, 120832
s_waitcnt vmcnt(6)
buffer_load_dwordx4 v8, s[24:27], s65 offen  lds
s_add_u32 m0, s58, 121856
s_waitcnt vmcnt(6)
buffer_load_dwordx4 v9, s[24:27], s65 offen  lds
s_waitcnt vmcnt(12)
ds_read_b64_tr_b16 v[192:193], v4 offset:0
ds_read_b64_tr_b16 v[194:195], v4 offset:2048
ds_read_b64_tr_b16 v[196:197], v5 offset:0
ds_read_b64_tr_b16 v[198:199], v5 offset:2048
ds_read_b64_tr_b16 v[200:201], v6 offset:0
ds_read_b64_tr_b16 v[202:203], v6 offset:2048
ds_read_b64_tr_b16 v[204:205], v7 offset:0
ds_read_b64_tr_b16 v[206:207], v7 offset:2048
s_waitcnt lgkmcnt(8)
s_bfe_u32 s64, s54, 0x4001c
s_lshl_b32 s64, s64, 15
s_add_u32 s64, s64, s56
s_add_u32 s65, s64, 16384
s_add_u32 m0, s58, 135168
s_waitcnt vmcnt(6)
buffer_load_dwordx4 v8, s[24:27], s64 offen  lds
s_add_u32 m0, s58, 136192
s_waitcnt vmcnt(6)
buffer_load_dwordx4 v9, s[24:27], s64 offen  lds
s_add_u32 m0, s58, 137216
s_waitcnt vmcnt(6)
buffer_load_dwordx4 v8, s[24:27], s65 offen  lds
s_add_u32 m0, s58, 138240
s_waitcnt vmcnt(6)
buffer_load_dwordx4 v9, s[24:27], s65 offen  lds
s_waitcnt vmcnt(12)
ds_read_b64_tr_b16 v[96:97], v4 offset:16384
ds_read_b64_tr_b16 v[98:99], v4 offset:18432
ds_read_b64_tr_b16 v[100:101], v5 offset:16384
ds_read_b64_tr_b16 v[102:103], v5 offset:18432
ds_read_b64_tr_b16 v[104:105], v6 offset:16384
ds_read_b64_tr_b16 v[106:107], v6 offset:18432
ds_read_b64_tr_b16 v[108:109], v7 offset:16384
ds_read_b64_tr_b16 v[110:111], v7 offset:18432
s_waitcnt lgkmcnt(8)
s_bfe_u32 s64, s55, 0x40008
s_lshl_b32 s64, s64, 15
s_add_u32 s64, s64, s56
s_add_u32 s65, s64, 16384
s_add_u32 m0, s58, 0
s_waitcnt vmcnt(6)
buffer_load_dwordx4 v8, s[24:27], s64 offen  lds
s_add_u32 m0, s58, 1024
s_waitcnt vmcnt(6)
buffer_load_dwordx4 v9, s[24:27], s64 offen  lds
s_add_u32 m0, s58, 2048
s_waitcnt vmcnt(6)
buffer_load_dwordx4 v8, s[24:27], s65 offen  lds
s_add_u32 m0, s58, 3072
s_waitcnt vmcnt(6)
buffer_load_dwordx4 v9, s[24:27], s65 offen  lds
s_waitcnt lgkmcnt(0)
s_bfe_u32 s64, s55, 0x4000c
s_lshl_b32 s64, s64, 15
s_add_u32 s64, s64, s56
s_add_u32 s65, s64, 16384
s_add_u32 m0, s58, 16384
s_waitcnt vmcnt(6)
buffer_load_dwordx4 v8, s[24:27], s64 offen  lds
s_add_u32 m0, s58, 17408
s_waitcnt vmcnt(6)
buffer_load_dwordx4 v9, s[24:27], s64 offen  lds
s_add_u32 m0, s58, 18432
s_waitcnt vmcnt(6)
buffer_load_dwordx4 v8, s[24:27], s65 offen  lds
s_add_u32 m0, s58, 19456
s_waitcnt vmcnt(6)
buffer_load_dwordx4 v9, s[24:27], s65 offen  lds
s_xor_b32 s42, s100, 2
s_lshl_b32 s101, s42, 12
s_lshl2_add_u32 s101, s58, s101
s_lshl_b32 s41, s42, 15
s_add_u32 s41, s41, s98
s_add_u32 s42, s41, 16384
s_add_u32 m0, s101, 32768
s_waitcnt vmcnt(6)
buffer_load_dwordx4 v8, s[32:35], s41 offen  lds
s_mov_b32 s68, 0
s_atomic_add s68, s[16:17], s99 glc
s_add_u32 s69, s50, 4
s_add_u32 m0, s101, 33792
s_waitcnt vmcnt(6)
buffer_load_dwordx4 v8, s[32:35], s42 offen  lds
s_add_u32 m0, s101, 34816
s_waitcnt vmcnt(6)
buffer_load_dwordx4 v9, s[32:35], s41 offen  lds
s_add_u32 m0, s101, 35840
s_waitcnt vmcnt(6)
buffer_load_dwordx4 v9, s[32:35], s42 offen  lds
s_xor_b32 s42, s100, 3
s_lshl_b32 s101, s42, 12
s_lshl2_add_u32 s101, s58, s101
s_lshl_b32 s41, s42, 15
s_add_u32 s41, s41, s98
s_add_u32 s42, s41, 16384
s_add_u32 m0, s101, 32768
s_waitcnt vmcnt(6)
buffer_load_dwordx4 v8, s[32:35], s41 offen  lds
s_add_u32 m0, s101, 33792
s_waitcnt vmcnt(6)
buffer_load_dwordx4 v8, s[32:35], s42 offen  lds
s_add_u32 m0, s101, 34816
s_waitcnt vmcnt(6)
buffer_load_dwordx4 v9, s[32:35], s41 offen  lds
s_add_u32 m0, s101, 35840
s_waitcnt vmcnt(6)
buffer_load_dwordx4 v9, s[32:35], s42 offen  lds
s_waitcnt lgkmcnt(0)
s_cmp_eq_u32 s68, s69
s_cbranch_scc1 H1_26
s_add_u32 s42, s50, 4
s_mov_b32 s51, 400000
SP_27:
s_mov_b32 s41, 0
s_atomic_add s41, s[16:17], s99 glc
s_waitcnt lgkmcnt(0)
s_cmp_eq_u32 s41, s42
s_cbranch_scc1 SD_28
s_sleep 2
s_sub_u32 s51, s51, 1
s_cbranch_scc0 SP_27
SD_28:
H1_26:
s_bfe_u32 s67, s54, 0x40000
s_lshl_b32 s67, s67, 12
s_add_u32 s67, s67, s57
buffer_load_dwordx4 v[208:211], v10, s[16:19], s67 offen sc1
buffer_load_dwordx4 v[212:215], v11, s[16:19], s67 offen sc1
buffer_load_dwordx4 v[216:219], v12, s[16:19], s67 offen sc1
buffer_load_dwordx4 v[220:223], v0, s[16:19], s67 offen sc1
s_bfe_u32 s67, s54, 0x40004
s_lshl_b32 s67, s67, 12
s_add_u32 s67, s67, s57
buffer_load_dwordx4 v[224:227], v10, s[16:19], s67 offen sc1
buffer_load_dwordx4 v[228:231], v11, s[16:19], s67 offen sc1
buffer_load_dwordx4 v[232:235], v12, s[16:19], s67 offen sc1
buffer_load_dwordx4 v[236:239], v0, s[16:19], s67 offen sc1
s_bfe_u32 s67, s54, 0x40008
s_lshl_b32 s67, s67, 12
s_add_u32 s67, s67, s57
buffer_load_dwordx4 v[240:243], v10, s[16:19], s67 offen sc1
buffer_load_dwordx4 v[244:247], v11, s[16:19], s67 offen sc1
s_add_u32 s69, s50, 4
s_mov_b32 s68, 0
s_atomic_add s68, s[16:17], s99 offset:8192 glc
s_waitcnt vmcnt(9)
s_mov_b64 exec, 1
ds_add_u32 v70, v71 offset:4
s_mov_b64 exec, -1
v_mfma_f32_16x16x32_bf16 v[16:19], v[112:115], v[208:211], 0
v_mfma_f32_16x16x32_bf16 v[20:23], v[116:119], v[208:211], 0
v_mfma_f32_16x16x32_bf16 v[24:27], v[120:123], v[208:211], 0
v_mfma_f32_16x16x32_bf16 v[28:31], v[124:127], v[208:211], 0
buffer_load_dwordx4 v[248:251], v12, s[16:19], s67 offen sc1
s_waitcnt vmcnt(9)
v_mfma_f32_16x16x32_bf16 v[44:47], v[124:127], v[212:215], 0
v_mfma_f32_16x16x32_bf16 v[40:43], v[120:123], v[212:215], 0
v_mfma_f32_16x16x32_bf16 v[36:39], v[116:119], v[212:215], 0
v_mfma_f32_16x16x32_bf16 v[32:35], v[112:115], v[212:215], 0
buffer_load_dwordx4 v[252:255], v0, s[16:19], s67 offen sc1
s_waitcnt vmcnt(9)
v_mfma_f32_16x16x32_bf16 v[48:51], v[112:115], v[216:219], 0
s_bfe_u32 s67, s54, 0x4000c
v_mfma_f32_16x16x32_bf16 v[52:55], v[116:119], v[216:219], 0
s_lshl_b32 s67, s67, 12
v_mfma_f32_16x16x32_bf16 v[56:59], v[120:123], v[216:219], 0
s_add_u32 s67, s67, s57
v_mfma_f32_16x16x32_bf16 v[60:63], v[124:127], v[216:219], 0
buffer_load_dwordx4 v[208:211], v10, s[16:19], s67 offen sc1
s_waitcnt vmcnt(9)
v_mfma_f32_16x16x32_bf16 v[76:79], v[124:127], v[220:223], 0
v_mfma_f32_16x16x32_bf16 v[72:75], v[120:123], v[220:223], 0
v_mfma_f32_16x16x32_bf16 v[68:71], v[116:119], v[220:223], 0
v_mfma_f32_16x16x32_bf16 v[64:67], v[112:115], v[220:223], 0
buffer_load_dwordx4 v[212:215], v11, s[16:19], s67 offen sc1
s_waitcnt lgkmcnt(0)
s_cmp_eq_u32 s68, s69
s_cbranch_scc1 H2_29
s_mov_b32 s70, s41
s_mov_b32 s71, s42
s_add_u32 s42, s50, 4
s_mov_b32 s51, 400000
SP_30:
s_mov_b32 s41, 0
s_atomic_add s41, s[16:17], s99 offset:8192 glc
s_waitcnt lgkmcnt(0)
s_cmp_eq_u32 s41, s42
s_cbranch_scc1 SD_31
s_sleep 2
s_sub_u32 s51, s51, 1
s_cbranch_scc0 SP_30
SD_31:
s_mov_b32 s41, s70
s_mov_b32 s42, s71
H2_29:
s_waitcnt vmcnt(9)
v_mfma_f32_16x16x32_bf16 v[16:19], v[80:83], v[224:227], v[16:19]
ds_read_b64_tr_b16 v[112:113], v13 offset:0
v_mfma_f32_16x16x32_bf16 v[20:23], v[84:87], v[224:227], v[20:23]
ds_read_b64_tr_b16 v[114:115], v13 offset:2048
v_mfma_f32_16x16x32_bf16 v[24:27], v[88:91], v[224:227], v[24:27]
ds_read_b64_tr_b16 v[116:117], v14 offset:0
v_mfma_f32_16x16x32_bf16 v[28:31], v[92:95], v[224:227], v[28:31]
buffer_load_dwordx4 v[216:219], v12, s[16:19], s67 offen sc1
s_waitcnt vmcnt(9)
v_mfma_f32_16x16x32_bf16 v[44:47], v[92:95], v[228:231], v[44:47]
ds_read_b64_tr_b16 v[118:119], v14 offset:2048
v_mfma_f32_16x16x32_bf16 v[40:43], v[88:91], v[228:231], v[40:43]
ds_read_b64_tr_b16 v[120:121], v15 offset:0
v_mfma_f32_16x16x32_bf16 v[36:39], v[84:87], v[228:231], v[36:39]
ds_read_b64_tr_b16 v[122:123], v15 offset:2048
v_mfma_f32_16x16x32_bf16 v[32:35], v[80:83], v[228:231], v[32:35]
buffer_load_dwordx4 v[220:223], v0, s[16:19], s67 offen sc1
s_waitcnt vmcnt(9)
v_mfma_f32_16x16x32_bf16 v[48:51], v[80:83], v[232:235], v[48:51]
s_bfe_u32 s67, s54, 0x40010
ds_read_b64_tr_b16 v[124:125], v2 offset:0
v_mfma_f32_16x16x32_bf16 v[52:55], v[84:87], v[232:235], v[52:55]
s_lshl_b32 s67, s67, 12
ds_read_b64_tr_b16 v[126:127], v2 offset:2048
v_mfma_f32_16x16x32_bf16 v[56:59], v[88:91], v[232:235], v[56:59]
s_add_u32 s67, s67, s57
v_mfma_f32_16x16x32_bf16 v[60:63], v[92:95], v[232:235], v[60:63]
buffer_load_dwordx4 v[224:227], v10, s[16:19], s67 offen sc1
s_waitcnt vmcnt(9)
v_mfma_f32_16x16x32_bf16 v[76:79], v[92:95], v[236:239], v[76:79]
v_mfma_f32_16x16x32_bf16 v[72:75], v[88:91], v[236:239], v[72:75]
v_mfma_f32_16x16x32_bf16 v[68:71], v[84:87], v[236:239], v[68:71]
v_mfma_f32_16x16x32_bf16 v[64:67], v[80:83], v[236:239], v[64:67]
buffer_load_dwordx4 v[228:231], v11, s[16:19], s67 offen sc1
s_mov_b32 s68, 0
s_atomic_add s68, s[16:17], s99 offset:128 glc
s_waitcnt vmcnt(9)
v_mfma_f32_16x16x32_bf16 v[16:19], v[96:99], v[240:243], v[16:19]
ds_read_b64_tr_b16 v[80:81], v13 offset:16384
v_mfma_f32_16x16x32_bf16 v[20:23], v[100:103], v[240:243], v[20:23]
ds_read_b64_tr_b16 v[82:83], v13 offset:18432
v_mfma_f32_16x16x32_bf16 v[24:27], v[104:107], v[240:243], v[24:27]
ds_read_b64_tr_b16 v[84:85], v14 offset:16384
v_mfma_f32_16x16x32_bf16 v[28:31], v[108:111], v[240:243], v[28:31]
buffer_load_dwordx4 v[232:235], v12, s[16:19], s67 offen sc1
s_waitcnt vmcnt(9)
v_mfma_f32_16x16x32_bf16 v[44:47], v[108:111], v[244:247], v[44:47]
ds_read_b64_tr_b16 v[86:87], v14 offset:18432
v_mfma_f32_16x16x32_bf16 v[40:43], v[104:107], v[244:247], v[40:43]
ds_read_b64_tr_b16 v[88:89], v15 offset:16384
v_mfma_f32_16x16x32_bf16 v[36:39], v[100:103], v[244:247], v[36:39]
ds_read_b64_tr_b16 v[90:91], v15 offset:18432
v_mfma_f32_16x16x32_bf16 v[32:35], v[96:99], v[244:247], v[32:35]
buffer_load_dwordx4 v[236:239], v0, s[16:19], s67 offen sc1
s_waitcnt vmcnt(9)
v_mfma_f32_16x16x32_bf16 v[48:51], v[96:99], v[248:251], v[48:51]
s_bfe_u32 s67, s54, 0x40014
ds_read_b64_tr_b16 v[92:93], v2 offset:16384
v_mfma_f32_16x16x32_bf16 v[52:55], v[100:103], v[248:251], v[52:55]
s_lshl_b32 s67, s67, 12
ds_read_b64_tr_b16 v[94:95], v2 offset:18432
v_mfma_f32_16x16x32_bf16 v[56:59], v[104:107], v[248:251], v[56:59]
s_add_u32 s67, s67, s57
v_mfma_f32_16x16x32_bf16 v[60:63], v[108:111], v[248:251], v[60:63]
buffer_load_dwordx4 v[240:243], v10, s[16:19], s67 offen sc1
s_waitcnt vmcnt(9)
v_mfma_f32_16x16x32_bf16 v[76:79], v[108:111], v[252:255], v[76:79]
v_mfma_f32_16x16x32_bf16 v[72:75], v[104:107], v[252:255], v[72:75]
v_mfma_f32_16x16x32_bf16 v[68:71], v[100:103], v[252:255], v[68:71]
v_mfma_f32_16x16x32_bf16 v[64:67], v[96:99], v[252:255], v[64:67]
buffer_load_dwordx4 v[244:247], v11, s[16:19], s67 offen sc1
s_waitcnt lgkmcnt(8)
s_waitcnt vmcnt(9)
v_mfma_f32_16x16x32_bf16 v[16:19], v[112:115], v[208:211], v[16:19]
ds_read_b64_tr_b16 v[96:97], v13 offset:32768
v_mfma_f32_16x16x32_bf16 v[20:23], v[116:119], v[208:211], v[20:23]
s_bfe_u32 s64, s55, 0x40014
s_lshl_b32 s64, s64, 15
s_add_u32 s64, s64, s56
s_add_u32 s65, s64, 16384
s_add_u32 m0, s58, 102400
s_mov_b32 exec_lo, 0
v_add_u32 v8, 0x1000, v8
s_mov_b32 exec_lo, -1
buffer_load_dwordx4 v8, s[24:27], s64 offen  lds
ds_read_b64_tr_b16 v[98:99], v13 offset:34816
v_mfma_f32_16x16x32_bf16 v[24:27], v[120:123], v[208:211], v[24:27]
ds_read_b64_tr_b16 v[100:101], v14 offset:32768
v_mfma_f32_16x16x32_bf16 v[28:31], v[124:127], v[208:211], v[28:31]
buffer_load_dwordx4 v[248:251], v12, s[16:19], s67 offen sc1
s_waitcnt vmcnt(10)
v_mfma_f32_16x16x32_bf16 v[44:47], v[124:127], v[212:215], v[44:47]
ds_read_b64_tr_b16 v[102:103], v14 offset:34816
v_mfma_f32_16x16x32_bf16 v[40:43], v[120:123], v[212:215], v[40:43]
s_add_u32 m0, s58, 103424
s_nop 0
buffer_load_dwordx4 v8, s[24:27], s65 offen  lds
ds_read_b64_tr_b16 v[104:105], v15 offset:32768
v_mfma_f32_16x16x32_bf16 v[36:39], v[116:119], v[212:215], v[36:39]
ds_read_b64_tr_b16 v[106:107], v15 offset:34816
v_mfma_f32_16x16x32_bf16 v[32:35], v[112:115], v[212:215], v[32:35]
buffer_load_dwordx4 v[252:255], v0, s[16:19], s67 offen sc1
s_waitcnt vmcnt(11)
v_mfma_f32_16x16x32_bf16 v[48:51], v[112:115], v[216:219], v[48:51]
s_bfe_u32 s67, s54, 0x40018
ds_read_b64_tr_b16 v[108:109], v2 offset:32768
v_mfma_f32_16x16x32_bf16 v[52:55], v[116:119], v[216:219], v[52:55]
s_lshl_b32 s67, s67, 12
ds_read_b64_tr_b16 v[110:111], v2 offset:34816
v_mfma_f32_16x16x32_bf16 v[56:59], v[120:123], v[216:219], v[56:59]
s_add_u32 s67, s67, s57
v_mfma_f32_16x16x32_bf16 v[60:63], v[124:127], v[216:219], v[60:63]
buffer_load_dwordx4 v[208:211], v10, s[16:19], s67 offen sc1
s_waitcnt vmcnt(11)
v_mfma_f32_16x16x32_bf16 v[76:79], v[124:127], v[220:223], v[76:79]
v_mfma_f32_16x16x32_bf16 v[72:75], v[120:123], v[220:223], v[72:75]
s_add_u32 m0, s58, 104448
s_add_u32 s64, s64, 4096
s_add_u32 s65, s65, 4096
buffer_load_dwordx4 v8, s[24:27], s64 offen  lds
v_mfma_f32_16x16x32_bf16 v[68:71], v[116:119], v[220:223], v[68:71]
v_mfma_f32_16x16x32_bf16 v[64:67], v[112:115], v[220:223], v[64:67]
buffer_load_dwordx4 v[212:215], v11, s[16:19], s67 offen sc1
s_add_u32 m0, s58, 105472
s_nop 0
buffer_load_dwordx4 v8, s[24:27], s65 offen  lds
s_mov_b32 exec_lo, 0
v_subrev_u32 v8, 0x1000, v8
s_mov_b32 exec_lo, -1
s_waitcnt vmcnt(13)
v_mfma_f32_16x16x32_bf16 v[16:19], v[128:131], v[224:227], v[16:19]
ds_read_b64_tr_b16 v[112:113], v4 offset:0
v_mfma_f32_16x16x32_bf16 v[20:23], v[132:135], v[224:227], v[20:23]
ds_read_b64_tr_b16 v[114:115], v4 offset:2048
v_mfma_f32_16x16x32_bf16 v[24:27], v[136:139], v[224:227], v[24:27]
ds_read_b64_tr_b16 v[116:117], v5 offset:0
v_mfma_f32_16x16x32_bf16 v[28:31], v[140:143], v[224:227], v[28:31]
buffer_load_dwordx4 v[216:219], v12, s[16:19], s67 offen sc1
s_waitcnt vmcnt(13)
v_mfma_f32_16x16x32_bf16 v[44:47], v[140:143], v[228:231], v[44:47]
ds_read_b64_tr_b16 v[118:119], v5 offset:2048
v_mfma_f32_16x16x32_bf16 v[40:43], v[136:139], v[228:231], v[40:43]
ds_read_b64_tr_b16 v[120:121], v6 offset:0
v_mfma_f32_16x16x32_bf16 v[36:39], v[132:135], v[228:231], v[36:39]
ds_read_b64_tr_b16 v[122:123], v6 offset:2048
v_mfma_f32_16x16x32_bf16 v[32:35], v[128:131], v[228:231], v[32:35]
buffer_load_dwordx4 v[220:223], v0, s[16:19], s67 offen sc1
WS_3220:
s_cbranch_execz WR_A
s_nop 0
s_waitcnt vmcnt(13)
v_mfma_f32_16x16x32_bf16 v[48:51], v[128:131], v[232:235], v[48:51]
s_bfe_u32 s67, s54, 0x4001c
ds_read_b64_tr_b16 v[124:125], v7 offset:0
v_mfma_f32_16x16x32_bf16 v[52:55], v[132:135], v[232:235], v[52:55]
s_lshl_b32 s67, s67, 12
ds_read_b64_tr_b16 v[126:127], v7 offset:2048
v_mfma_f32_16x16x32_bf16 v[56:59], v[136:139], v[232:235], v[56:59]
s_add_u32 s67, s67, s57
v_mfma_f32_16x16x32_bf16 v[60:63], v[140:143], v[232:235], v[60:63]
buffer_load_dwordx4 v[224:227], v10, s[16:19], s67 offen sc1
s_waitcnt vmcnt(13)
v_mfma_f32_16x16x32_bf16 v[76:79], v[140:143], v[236:239], v[76:79]
v_mfma_f32_16x16x32_bf16 v[72:75], v[136:139], v[236:239], v[72:75]
v_mfma_f32_16x16x32_bf16 v[68:71], v[132:135], v[236:239], v[68:71]
v_mfma_f32_16x16x32_bf16 v[64:67], v[128:131], v[236:239], v[64:67]
buffer_load_dwordx4 v[228:231], v11, s[16:19], s67 offen sc1
s_waitcnt lgkmcnt(0)
s_cmp_eq_u32 s68, s69
s_cbranch_scc1 H2_32
s_mov_b32 s70, s41
s_mov_b32 s71, s42
s_add_u32 s42, s50, 4
s_mov_b32 s51, 400000
SP_33:
s_mov_b32 s41, 0
s_atomic_add s41, s[16:17], s99 offset:128 glc
s_waitcnt lgkmcnt(0)
s_cmp_eq_u32 s41, s42
s_cbranch_scc1 SD_34
s_sleep 2
s_sub_u32 s51, s51, 1
s_cbranch_scc0 SP_33
SD_34:
s_mov_b32 s41, s70
s_mov_b32 s42, s71
H2_32:
s_mov_b32 s68, 0
s_atomic_add s68, s[16:17], s99 offset:8320 glc
s_waitcnt vmcnt(13)
v_mfma_f32_16x16x32_bf16 v[16:19], v[144:147], v[240:243], v[16:19]
ds_read_b64_tr_b16 v[128:129], v4 offset:16384
v_mfma_f32_16x16x32_bf16 v[20:23], v[148:151], v[240:243], v[20:23]
ds_read_b64_tr_b16 v[130:131], v4 offset:18432
v_mfma_f32_16x16x32_bf16 v[24:27], v[152:155], v[240:243], v[24:27]
ds_read_b64_tr_b16 v[132:133], v5 offset:16384
v_mfma_f32_16x16x32_bf16 v[28:31], v[156:159], v[240:243], v[28:31]
buffer_load_dwordx4 v[232:235], v12, s[16:19], s67 offen sc1
s_waitcnt vmcnt(13)
v_mfma_f32_16x16x32_bf16 v[44:47], v[156:159], v[244:247], v[44:47]
ds_read_b64_tr_b16 v[134:135], v5 offset:18432
v_mfma_f32_16x16x32_bf16 v[40:43], v[152:155], v[244:247], v[40:43]
ds_read_b64_tr_b16 v[136:137], v6 offset:16384
v_mfma_f32_16x16x32_bf16 v[36:39], v[148:151], v[244:247], v[36:39]
ds_read_b64_tr_b16 v[138:139], v6 offset:18432
v_mfma_f32_16x16x32_bf16 v[32:35], v[144:147], v[244:247], v[32:35]
buffer_load_dwordx4 v[236:239], v0, s[16:19], s67 offen sc1
s_waitcnt vmcnt(12)
v_mfma_f32_16x16x32_bf16 v[48:51], v[144:147], v[248:251], v[48:51]
s_bfe_u32 s67, s55, 0x40000
ds_read_b64_tr_b16 v[140:141], v7 offset:16384
v_mfma_f32_16x16x32_bf16 v[52:55], v[148:151], v[248:251], v[52:55]
s_lshl_b32 s67, s67, 12
ds_read_b64_tr_b16 v[142:143], v7 offset:18432
v_mfma_f32_16x16x32_bf16 v[56:59], v[152:155], v[248:251], v[56:59]
s_add_u32 s67, s67, s57
v_mfma_f32_16x16x32_bf16 v[60:63], v[156:159], v[248:251], v[60:63]
buffer_load_dwordx4 v[240:243], v10, s[16:19], s67 offen sc1
s_waitcnt vmcnt(11)
v_mfma_f32_16x16x32_bf16 v[76:79], v[156:159], v[252:255], v[76:79]
v_mfma_f32_16x16x32_bf16 v[72:75], v[152:155], v[252:255], v[72:75]
v_mfma_f32_16x16x32_bf16 v[68:71], v[148:151], v[252:255], v[68:71]
v_mfma_f32_16x16x32_bf16 v[64:67], v[144:147], v[252:255], v[64:67]
buffer_load_dwordx4 v[244:247], v11, s[16:19], s67 offen sc1
s_waitcnt vmcnt(11)
v_mfma_f32_16x16x32_bf16 v[16:19], v[80:83], v[208:211], v[16:19]
v_mfma_f32_16x16x32_bf16 v[20:23], v[84:87], v[208:211], v[20:23]
v_mfma_f32_16x16x32_bf16 v[24:27], v[88:91], v[208:211], v[24:27]
v_mfma_f32_16x16x32_bf16 v[28:31], v[92:95], v[208:211], v[28:31]
buffer_load_dwordx4 v[248:251], v12, s[16:19], s67 offen sc1
s_waitcnt vmcnt(10)
v_mfma_f32_16x16x32_bf16 v[44:47], v[92:95], v[212:215], v[44:47]
v_mfma_f32_16x16x32_bf16 v[40:43], v[88:91], v[212:215], v[40:43]
v_mfma_f32_16x16x32_bf16 v[36:39], v[84:87], v[212:215], v[36:39]
v_mfma_f32_16x16x32_bf16 v[32:35], v[80:83], v[212:215], v[32:35]
buffer_load_dwordx4 v[252:255], v0, s[16:19], s67 offen sc1
s_waitcnt vmcnt(9)
v_mfma_f32_16x16x32_bf16 v[48:51], v[80:83], v[216:219], v[48:51]
s_bfe_u32 s67, s55, 0x40004
v_mfma_f32_16x16x32_bf16 v[52:55], v[84:87], v[216:219], v[52:55]
s_lshl_b32 s67, s67, 12
v_mfma_f32_16x16x32_bf16 v[56:59], v[88:91], v[216:219], v[56:59]
s_add_u32 s67, s67, s57
v_mfma_f32_16x16x32_bf16 v[60:63], v[92:95], v[216:219], v[60:63]
buffer_load_dwordx4 v[208:211], v10, s[16:19], s67 offen sc1
s_waitcnt vmcnt(9)
v_mfma_f32_16x16x32_bf16 v[76:79], v[92:95], v[220:223], v[76:79]
v_mfma_f32_16x16x32_bf16 v[72:75], v[88:91], v[220:223], v[72:75]
v_mfma_f32_16x16x32_bf16 v[68:71], v[84:87], v[220:223], v[68:71]
v_mfma_f32_16x16x32_bf16 v[64:67], v[80:83], v[220:223], v[64:67]
buffer_load_dwordx4 v[212:215], v11, s[16:19], s67 offen sc1
s_waitcnt vmcnt(9)
v_mfma_f32_16x16x32_bf16 v[16:19], v[96:99], v[224:227], v[16:19]
v_mfma_f32_16x16x32_bf16 v[20:23], v[100:103], v[224:227], v[20:23]
v_mfma_f32_16x16x32_bf16 v[24:27], v[104:107], v[224:227], v[24:27]
v_mfma_f32_16x16x32_bf16 v[28:31], v[108:111], v[224:227], v[28:31]
buffer_load_dwordx4 v[216:219], v12, s[16:19], s67 offen sc1
s_waitcnt vmcnt(9)
v_mfma_f32_16x16x32_bf16 v[44:47], v[108:111], v[228:231], v[44:47]
v_mfma_f32_16x16x32_bf16 v[40:43], v[104:107], v[228:231], v[40:43]
v_mfma_f32_16x16x32_bf16 v[36:39], v[100:103], v[228:231], v[36:39]
v_mfma_f32_16x16x32_bf16 v[32:35], v[96:99], v[228:231], v[32:35]
buffer_load_dwordx4 v[220:223], v0, s[16:19], s67 offen sc1
s_waitcnt vmcnt(9)
v_mfma_f32_16x16x32_bf16 v[48:51], v[96:99], v[232:235], v[48:51]
s_bfe_u32 s67, s55, 0x40008
v_mfma_f32_16x16x32_bf16 v[52:55], v[100:103], v[232:235], v[52:55]
s_lshl_b32 s67, s67, 12
v_mfma_f32_16x16x32_bf16 v[56:59], v[104:107], v[232:235], v[56:59]
s_add_u32 s67, s67, s57
v_mfma_f32_16x16x32_bf16 v[60:63], v[108:111], v[232:235], v[60:63]
buffer_load_dwordx4 v[224:227], v10, s[16:19], s67 offen sc1
s_waitcnt vmcnt(9)
v_mfma_f32_16x16x32_bf16 v[76:79], v[108:111], v[236:239], v[76:79]
v_mfma_f32_16x16x32_bf16 v[72:75], v[104:107], v[236:239], v[72:75]
v_mfma_f32_16x16x32_bf16 v[68:71], v[100:103], v[236:239], v[68:71]
v_mfma_f32_16x16x32_bf16 v[64:67], v[96:99], v[236:239], v[64:67]
buffer_load_dwordx4 v[228:231], v11, s[16:19], s67 offen sc1
s_setprio 2
s_waitcnt lgkmcnt(0)
s_cmp_eq_u32 s68, s69
s_cbranch_scc1 H2_35
s_mov_b32 s70, s41
s_mov_b32 s71, s42
s_add_u32 s42, s50, 4
s_mov_b32 s51, 400000
SP_36:
s_mov_b32 s41, 0
s_atomic_add s41, s[16:17], s99 offset:8320 glc
s_waitcnt lgkmcnt(0)
s_cmp_eq_u32 s41, s42
s_cbranch_scc1 SD_37
s_sleep 2
s_sub_u32 s51, s51, 1
s_cbranch_scc0 SP_36
SD_37:
s_mov_b32 s41, s70
s_mov_b32 s42, s71
H2_35:
s_waitcnt vmcnt(9)
v_mfma_f32_16x16x32_bf16 v[16:19], v[160:163], v[240:243], v[16:19]
v_mfma_f32_16x16x32_bf16 v[20:23], v[164:167], v[240:243], v[20:23]
v_mfma_f32_16x16x32_bf16 v[24:27], v[168:171], v[240:243], v[24:27]
v_mfma_f32_16x16x32_bf16 v[28:31], v[172:175], v[240:243], v[28:31]
buffer_load_dwordx4 v[232:235], v12, s[16:19], s67 offen sc1
s_waitcnt vmcnt(9)
v_mfma_f32_16x16x32_bf16 v[44:47], v[172:175], v[244:247], v[44:47]
v_mfma_f32_16x16x32_bf16 v[40:43], v[168:171], v[244:247], v[40:43]
v_mfma_f32_16x16x32_bf16 v[36:39], v[164:167], v[244:247], v[36:39]
v_mfma_f32_16x16x32_bf16 v[32:35], v[160:163], v[244:247], v[32:35]
buffer_load_dwordx4 v[236:239], v0, s[16:19], s67 offen sc1
s_waitcnt vmcnt(9)
v_mfma_f32_16x16x32_bf16 v[48:51], v[160:163], v[248:251], v[48:51]
s_bfe_u32 s67, s55, 0x4000c
v_mfma_f32_16x16x32_bf16 v[52:55], v[164:167], v[248:251], v[52:55]
s_lshl_b32 s67, s67, 12
v_mfma_f32_16x16x32_bf16 v[56:59], v[168:171], v[248:251], v[56:59]
s_add_u32 s67, s67, s57
v_mfma_f32_16x16x32_bf16 v[60:63], v[172:175], v[248:251], v[60:63]
buffer_load_dwordx4 v[244:247], v11, s[16:19], s67 offen sc1
s_waitcnt vmcnt(9)
v_mfma_f32_16x16x32_bf16 v[76:79], v[172:175], v[252:255], v[76:79]
s_bfe_u32 s43, s55, 0x40010
v_mfma_f32_16x16x32_bf16 v[72:75], v[168:171], v[252:255], v[72:75]
s_lshl_b32 s43, s43, 12
v_mfma_f32_16x16x32_bf16 v[68:71], v[164:167], v[252:255], v[68:71]
s_add_u32 s43, s43, s57
v_mfma_f32_16x16x32_bf16 v[64:67], v[160:163], v[252:255], v[64:67]
buffer_load_dwordx4 v[100:103], v11, s[16:19], s43 offen sc1
s_waitcnt vmcnt(9)
v_mfma_f32_16x16x32_bf16 v[16:19], v[176:179], v[208:211], v[16:19]
s_bfe_u32 s45, s55, 0x40014
ds_read_b64_tr_b16 v[144:145], v13 offset:0
v_mfma_f32_16x16x32_bf16 v[20:23], v[180:183], v[208:211], v[20:23]
s_lshl_b32 s45, s45, 12
ds_read_b64_tr_b16 v[146:147], v13 offset:2048
v_mfma_f32_16x16x32_bf16 v[24:27], v[184:187], v[208:211], v[24:27]
s_add_u32 s45, s45, s57
ds_read_b64_tr_b16 v[148:149], v14 offset:0
v_mfma_f32_16x16x32_bf16 v[28:31], v[188:191], v[208:211], v[28:31]
buffer_load_dwordx4 v[164:167], v11, s[16:19], s45 offen sc1
s_waitcnt vmcnt(9)
v_mfma_f32_16x16x32_bf16 v[44:47], v[188:191], v[212:215], v[44:47]
ds_read_b64_tr_b16 v[150:151], v14 offset:2048
v_mfma_f32_16x16x32_bf16 v[40:43], v[184:187], v[212:215], v[40:43]
ds_read_b64_tr_b16 v[152:153], v15 offset:0
v_mfma_f32_16x16x32_bf16 v[36:39], v[180:183], v[212:215], v[36:39]
ds_read_b64_tr_b16 v[154:155], v15 offset:2048
v_mfma_f32_16x16x32_bf16 v[32:35], v[176:179], v[212:215], v[32:35]
buffer_load_dwordx4 v[248:251], v12, s[16:19], s67 offen sc1
s_waitcnt vmcnt(9)
v_mfma_f32_16x16x32_bf16 v[48:51], v[176:179], v[216:219], v[48:51]
ds_read_b64_tr_b16 v[156:157], v2 offset:0
v_mfma_f32_16x16x32_bf16 v[52:55], v[180:183], v[216:219], v[52:55]
ds_read_b64_tr_b16 v[158:159], v2 offset:2048
v_mfma_f32_16x16x32_bf16 v[56:59], v[184:187], v[216:219], v[56:59]
v_mfma_f32_16x16x32_bf16 v[60:63], v[188:191], v[216:219], v[60:63]
buffer_load_dwordx4 v[104:107], v12, s[16:19], s43 offen sc1
s_waitcnt vmcnt(9)
v_mfma_f32_16x16x32_bf16 v[76:79], v[188:191], v[220:223], v[76:79]
v_mfma_f32_16x16x32_bf16 v[72:75], v[184:187], v[220:223], v[72:75]
v_mfma_f32_16x16x32_bf16 v[68:71], v[180:183], v[220:223], v[68:71]
v_mfma_f32_16x16x32_bf16 v[64:67], v[176:179], v[220:223], v[64:67]
buffer_load_dwordx4 v[168:171], v12, s[16:19], s45 offen sc1
s_waitcnt vmcnt(9)
v_mfma_f32_16x16x32_bf16 v[16:19], v[112:115], v[224:227], v[16:19]
s_add_u32 s41, s58, 102400
v_mfma_f32_16x16x32_bf16 v[20:23], v[116:119], v[224:227], v[20:23]
v_add_u32 v80, s41, v3
v_mfma_f32_16x16x32_bf16 v[24:27], v[120:123], v[224:227], v[24:27]
s_sub_u32 s41, s39, 1
v_mfma_f32_16x16x32_bf16 v[28:31], v[124:127], v[224:227], v[28:31]
s_and_b32 s41, s41, 3
buffer_load_dwordx4 v[252:255], v0, s[16:19], s67 offen sc1
s_waitcnt vmcnt(9)
v_mfma_f32_16x16x32_bf16 v[44:47], v[124:127], v[228:231], v[44:47]
s_lshl_b32 s41, s41, 12
v_mfma_f32_16x16x32_bf16 v[40:43], v[120:123], v[228:231], v[40:43]
s_add_u32 s41, s41, 102400
v_mfma_f32_16x16x32_bf16 v[36:39], v[116:119], v[228:231], v[36:39]
v_add_u32 v84, s41, v3
v_mfma_f32_16x16x32_bf16 v[32:35], v[112:115], v[228:231], v[32:35]
s_sub_u32 s41, s39, 2
buffer_load_dwordx4 v[108:111], v0, s[16:19], s43 offen sc1
s_waitcnt vmcnt(9)
v_mfma_f32_16x16x32_bf16 v[48:51], v[112:115], v[232:235], v[48:51]
s_and_b32 s41, s41, 3
v_mfma_f32_16x16x32_bf16 v[52:55], v[116:119], v[232:235], v[52:55]
s_lshl_b32 s41, s41, 12
v_mfma_f32_16x16x32_bf16 v[56:59], v[120:123], v[232:235], v[56:59]
s_add_u32 s41, s41, 118784
v_mfma_f32_16x16x32_bf16 v[60:63], v[124:127], v[232:235], v[60:63]
v_add_u32 v85, s41, v3
buffer_load_dwordx4 v[172:175], v0, s[16:19], s45 offen sc1
s_waitcnt vmcnt(9)
v_mfma_f32_16x16x32_bf16 v[76:79], v[124:127], v[236:239], v[76:79]
s_sub_u32 s41, s39, 3
v_mfma_f32_16x16x32_bf16 v[72:75], v[120:123], v[236:239], v[72:75]
s_and_b32 s41, s41, 3
v_mfma_f32_16x16x32_bf16 v[68:71], v[116:119], v[236:239], v[68:71]
s_lshl_b32 s41, s41, 12
v_mfma_f32_16x16x32_bf16 v[64:67], v[112:115], v[236:239], v[64:67]
s_add_u32 s41, s41, 135168
buffer_load_dwordx4 v[240:243], v10, s[16:19], s67 offen sc1
s_waitcnt vmcnt(9)
v_mfma_f32_16x16x32_bf16 v[32:35], v[128:131], v[244:247], v[32:35]
v_add_u32_e64 v86, s41, v3
v_mfma_f32_16x16x32_bf16 v[36:39], v[132:135], v[244:247], v[36:39]
v_mov_b32 v88, 0xbfb8aa3b
v_mfma_f32_16x16x32_bf16 v[40:43], v[136:139], v[244:247], v[40:43]
v_mov_b32 v89, v88
v_mfma_f32_16x16x32_bf16 v[44:47], v[140:143], v[244:247], v[44:47]
v_mov_b32 v90, 1.0
buffer_load_dwordx4 v[96:99], v10, s[16:19], s43 offen sc1
s_waitcnt vmcnt(9)
v_mfma_f32_16x16x32_bf16 v[32:35], v[192:195], v[100:103], v[32:35]
v_mov_b32 v91, 1.0
v_mfma_f32_16x16x32_bf16 v[36:39], v[196:199], v[100:103], v[36:39]
v_add_u32_e64 v82, s58, v3
v_mfma_f32_16x16x32_bf16 v[40:43], v[200:203], v[100:103], v[40:43]
v_mov_b32 v83, 154112
v_mfma_f32_16x16x32_bf16 v[44:47], v[204:207], v[100:103], v[44:47]
v_mov_b32_e64 v81, 1
buffer_load_dwordx4 v[160:163], v10, s[16:19], s45 offen sc1
v_mov_b32 v8, 154112
v_lshlrev_b32_e64 v9, s39, 1
s_mov_b64 exec, 1
ds_add_u32 v8, v9 offset:12
s_mov_b64 exec, -1
s_waitcnt lgkmcnt(0)
s_waitcnt vmcnt(9)
v_mfma_f32_16x16x32_bf16 v[32:35], v[144:147], v[164:167], v[32:35]
v_mfma_f32_16x16x32_bf16 v[36:39], v[148:151], v[164:167], v[36:39]
v_mfma_f32_16x16x32_bf16 v[40:43], v[152:155], v[164:167], v[40:43]
v_mfma_f32_16x16x32_bf16 v[44:47], v[156:159], v[164:167], v[44:47]
s_waitcnt vmcnt(8)
v_mfma_f32_16x16x32_bf16 v[48:51], v[128:131], v[248:251], v[48:51]
v_mfma_f32_16x16x32_bf16 v[52:55], v[132:135], v[248:251], v[52:55]
v_mfma_f32_16x16x32_bf16 v[56:59], v[136:139], v[248:251], v[56:59]
s_nop 0
ds_write_b128 v80, v[32:35] offset:0
v_mfma_f32_16x16x32_bf16 v[60:63], v[140:143], v[248:251], v[60:63]
s_waitcnt vmcnt(7)
v_mfma_f32_16x16x32_bf16 v[48:51], v[192:195], v[104:107], v[48:51]
v_mfma_f32_16x16x32_bf16 v[52:55], v[196:199], v[104:107], v[52:55]
ds_write_b128 v80, v[36:39] offset:1024
v_mfma_f32_16x16x32_bf16 v[56:59], v[200:203], v[104:107], v[56:59]
v_mfma_f32_16x16x32_bf16 v[60:63], v[204:207], v[104:107], v[60:63]
s_waitcnt vmcnt(6)
v_mfma_f32_16x16x32_bf16 v[48:51], v[144:147], v[168:171], v[48:51]
ds_write_b128 v80, v[40:43] offset:2048
v_mfma_f32_16x16x32_bf16 v[52:55], v[148:151], v[168:171], v[52:55]
v_mfma_f32_16x16x32_bf16 v[56:59], v[152:155], v[168:171], v[56:59]
v_mfma_f32_16x16x32_bf16 v[60:63], v[156:159], v[168:171], v[60:63]
ds_write_b128 v80, v[44:47] offset:3072
s_waitcnt vmcnt(5)
v_mfma_f32_16x16x32_bf16 v[64:67], v[128:131], v[252:255], v[64:67]
v_mfma_f32_16x16x32_bf16 v[68:71], v[132:135], v[252:255], v[68:71]
v_mfma_f32_16x16x32_bf16 v[72:75], v[136:139], v[252:255], v[72:75]
ds_write_b128 v80, v[48:51] offset:16384
v_mfma_f32_16x16x32_bf16 v[76:79], v[140:143], v[252:255], v[76:79]
s_waitcnt vmcnt(4)
v_mfma_f32_16x16x32_bf16 v[64:67], v[192:195], v[108:111], v[64:67]
v_mfma_f32_16x16x32_bf16 v[68:71], v[196:199], v[108:111], v[68:71]
ds_write_b128 v80, v[52:55] offset:17408
v_mfma_f32_16x16x32_bf16 v[72:75], v[200:203], v[108:111], v[72:75]
v_mfma_f32_16x16x32_bf16 v[76:79], v[204:207], v[108:111], v[76:79]
s_waitcnt vmcnt(3)
v_mfma_f32_16x16x32_bf16 v[64:67], v[144:147], v[172:175], v[64:67]
ds_write_b128 v80, v[56:59] offset:18432
v_mfma_f32_16x16x32_bf16 v[68:71], v[148:151], v[172:175], v[68:71]
v_mfma_f32_16x16x32_bf16 v[72:75], v[152:155], v[172:175], v[72:75]
v_mfma_f32_16x16x32_bf16 v[76:79], v[156:159], v[172:175], v[76:79]
ds_write_b128 v80, v[60:63] offset:19456
s_waitcnt vmcnt(2)
v_mfma_f32_16x16x32_bf16 v[16:19], v[128:131], v[240:243], v[16:19]
v_mfma_f32_16x16x32_bf16 v[20:23], v[132:135], v[240:243], v[20:23]
v_mfma_f32_16x16x32_bf16 v[24:27], v[136:139], v[240:243], v[24:27]
ds_write_b128 v80, v[64:67] offset:32768
v_mfma_f32_16x16x32_bf16 v[28:31], v[140:143], v[240:243], v[28:31]
s_waitcnt vmcnt(1)
v_mfma_f32_16x16x32_bf16 v[16:19], v[192:195], v[96:99], v[16:19]
v_mfma_f32_16x16x32_bf16 v[20:23], v[196:199], v[96:99], v[20:23]
ds_write_b128 v80, v[68:71] offset:33792
v_mfma_f32_16x16x32_bf16 v[24:27], v[200:203], v[96:99], v[24:27]
v_mfma_f32_16x16x32_bf16 v[28:31], v[204:207], v[96:99], v[28:31]
s_waitcnt vmcnt(0)
v_mfma_f32_16x16x32_bf16 v[16:19], v[144:147], v[160:163], v[16:19]
ds_write_b128 v80, v[72:75] offset:34816
v_mfma_f32_16x16x32_bf16 v[20:23], v[148:151], v[160:163], v[20:23]
v_mfma_f32_16x16x32_bf16 v[24:27], v[152:155], v[160:163], v[24:27]
v_mfma_f32_16x16x32_bf16 v[28:31], v[156:159], v[160:163], v[28:31]
ds_write_b128 v80, v[76:79] offset:35840
s_setprio 2
s_mov_b64 exec, 1
ds_add_u32 v83, v81 offset:8
s_mov_b64 exec, -1
s_mov_b32 s51, 1600000
LS_38:
ds_read_b32 v81, v83 offset:8
s_waitcnt lgkmcnt(0)
v_readfirstlane_b32 s41, v81
s_nop 0
s_cmp_ge_u32 s41, 4
s_cbranch_scc1 LD_39
s_sub_u32 s51, s51, 1
s_cbranch_scc0 LS_38
LD_39:
ds_read_b128 v[112:115], v84 offset:0
ds_read_b128 v[128:131], v85 offset:0
ds_read_b128 v[144:147], v86 offset:0
ds_read_b128 v[116:119], v84 offset:1024
ds_read_b128 v[132:135], v85 offset:1024
ds_read_b128 v[148:151], v86 offset:1024
ds_read_b128 v[120:123], v84 offset:2048
ds_read_b128 v[136:139], v85 offset:2048
ds_read_b128 v[152:155], v86 offset:2048
ds_read_b128 v[124:127], v84 offset:3072
ds_read_b128 v[140:143], v85 offset:3072
ds_read_b128 v[156:159], v86 offset:3072
s_waitcnt lgkmcnt(9)
v_add_f32 v16, v16, v112
v_add_f32 v128, v128, v144
v_add_f32 v17, v17, v113
v_add_f32 v129, v129, v145
v_add_f32 v18, v18, v114
v_add_f32 v130, v130, v146
v_add_f32 v19, v19, v115
v_add_f32 v131, v131, v147
v_add_f32 v16, v16, v128
v_add_f32 v17, v17, v129
v_add_f32 v18, v18, v130
v_add_f32 v19, v19, v131
v_exp_f32 v32, v16
v_exp_f32 v33, v17
v_exp_f32 v34, v18
v_exp_f32_e64 v35, v19
v_fma_f32 v32, v32, v88, v88
v_fma_f32 v33, v33, v88, v88
v_fma_f32 v34, v34, v88, v88
v_fma_f32 v35, v35, v88, v88
v_rcp_f32 v32, v32
v_rcp_f32 v33, v33
v_rcp_f32 v34, v34
v_rcp_f32 v35, v35
v_mul_f32 v32, v32, v16
v_mul_f32 v33, v33, v17
v_mul_f32 v34, v34, v18
v_mul_f32 v35, v35, v19
ds_write_b128 v82, v[32:35] offset:0
s_waitcnt lgkmcnt(7)
v_add_f32 v20, v20, v116
v_add_f32 v132, v132, v148
v_add_f32 v21, v21, v117
v_add_f32 v133, v133, v149
v_add_f32 v22, v22, v118
v_add_f32 v134, v134, v150
v_add_f32 v23, v23, v119
v_add_f32 v135, v135, v151
v_add_f32 v20, v20, v132
v_add_f32 v21, v21, v133
v_add_f32 v22, v22, v134
v_add_f32 v23, v23, v135
v_exp_f32 v36, v20
v_exp_f32 v37, v21
v_exp_f32 v38, v22
v_exp_f32_e64 v39, v23
v_fma_f32 v36, v36, v88, v88
v_fma_f32 v37, v37, v88, v88
v_fma_f32 v38, v38, v88, v88
v_fma_f32 v39, v39, v88, v88
v_rcp_f32 v36, v36
v_rcp_f32 v37, v37
v_rcp_f32 v38, v38
v_rcp_f32 v39, v39
v_mul_f32 v36, v36, v20
v_mul_f32 v37, v37, v21
v_mul_f32 v38, v38, v22
v_mul_f32 v39, v39, v23
ds_write_b128 v82, v[36:39] offset:1024
s_waitcnt lgkmcnt(5)
v_add_f32 v24, v24, v120
v_add_f32 v136, v136, v152
v_add_f32 v25, v25, v121
v_add_f32 v137, v137, v153
v_add_f32 v26, v26, v122
v_add_f32 v138, v138, v154
v_add_f32 v27, v27, v123
v_add_f32 v139, v139, v155
v_add_f32 v24, v24, v136
v_add_f32 v25, v25, v137
v_add_f32 v26, v26, v138
v_add_f32 v27, v27, v139
v_exp_f32 v40, v24
v_exp_f32 v41, v25
v_exp_f32 v42, v26
v_exp_f32_e64 v43, v27
v_fma_f32 v40, v40, v88, v88
v_fma_f32 v41, v41, v88, v88
v_fma_f32 v42, v42, v88, v88
v_fma_f32 v43, v43, v88, v88
v_rcp_f32 v40, v40
v_rcp_f32 v41, v41
v_rcp_f32 v42, v42
v_rcp_f32 v43, v43
v_mul_f32 v40, v40, v24
v_mul_f32 v41, v41, v25
v_mul_f32 v42, v42, v26
v_mul_f32 v43, v43, v27
ds_write_b128 v82, v[40:43] offset:2048
s_waitcnt lgkmcnt(3)
v_add_f32 v28, v28, v124
v_add_f32 v140, v140, v156
v_add_f32 v29, v29, v125
v_add_f32 v141, v141, v157
v_add_f32 v30, v30, v126
v_add_f32 v142, v142, v158
v_add_f32 v31, v31, v127
v_add_f32 v143, v143, v159
v_add_f32 v28, v28, v140
v_add_f32 v29, v29, v141
v_add_f32 v30, v30, v142
v_add_f32 v31, v31, v143
v_exp_f32 v44, v28
v_exp_f32 v45, v29
v_exp_f32 v46, v30
v_exp_f32_e64 v47, v31
v_fma_f32 v44, v44, v88, v88
v_fma_f32 v45, v45, v88, v88
v_fma_f32 v46, v46, v88, v88
v_fma_f32 v47, v47, v88, v88
v_rcp_f32 v44, v44
v_rcp_f32 v45, v45
v_rcp_f32 v46, v46
v_rcp_f32 v47, v47
v_mul_f32 v44, v44, v28
v_mul_f32 v45, v45, v29
v_mul_f32 v46, v46, v30
v_mul_f32 v47, v47, v31
ds_write_b128 v82, v[44:47] offset:3072
s_waitcnt lgkmcnt(0)
s_setprio 0
s_barrier
s_branch K_end
K_CF:
s_load_dwordx2 s[28:29], s[0:1], 56
s_mov_b32 s30, 2097152
s_mov_b32 s31, 0x20000
v_and_b32 v232, 15, v1
v_lshrrev_b32 v233, 4, v1
v_lshrrev_b32 v234, 1, v232
v_xor_b32 v234, v234, v233
v_lshlrev_b32_e64 v234, 4, v234
v_lshl_add_u32 v234, v232, 7, v234
s_lshr_b32 s41, s39, 1
s_lshl_b32 s41, s41, 13
v_add_u32_e64 v234, s41, v234
v_add_u32 v4, 90112, v234
v_xor_b32_e64 v234, 64, v234
v_add_u32 v5, 90112, v234
v_lshrrev_b32 v236, 3, v232
v_and_b32 v234, 1, v233
v_lshl_or_b32 v236, v234, 1, v236
v_lshrrev_b32 v234, 2, v232
v_lshlrev_b32 v234, 7, v234
v_lshl_add_u32 v234, v233, 10, v234
v_and_b32_e64 v235, 3, v232
v_lshl_add_u32 v234, v235, 3, v234
v_add_u32 v234, 106496, v234
s_and_b32 s42, s39, 1
s_lshl_b32 s41, s42, 1
v_xor_b32_e64 v235, s41, v236
v_lshl_add_u32 v6, v235, 5, v234
v_xor_b32_e64 v235, 1, v235
v_lshl_add_u32 v7, v235, 5, v234
v_lshrrev_b32 v234, 2, v232
v_lshlrev_b32 v234, 6, v234
v_lshl_add_u32 v234, v233, 9, v234
v_and_b32_e64 v235, 3, v232
v_lshl_add_u32 v234, v235, 3, v234
v_add_u32 v234, 106496, v234
v_and_b32 v236, 1, v233
v_xor_b32 v235, s42, v236
v_lshl_add_u32 v8, v235, 5, v234
s_lshl_b32 s41, s36, 4
s_add_u32 s41, s41, s59
s_lshl2_add_u32 s41, s41, s39
s_lshl_b32 s41, s41, 8
s_add_u32 s41, s41, 524288
s_waitcnt lgkmcnt(0)
s_mul_i32 s50, s50, 0x9E3779B1
s_add_u32 s50, s50, 0x7F4A7C15
s_mov_b32 s51, s50
s_atomic_swap s51, s[16:17], s41 glc
s_mov_b32 s55, s50
s_atomic_swap s55, s[16:17], s41 offset:128 glc
s_and_b32 s4, s2, 7
s_lshr_b32 s5, s2, 3
s_and_b32 s6, s5, 15
s_lshr_b32 s6, 0x880, s6
s_and_b32 s6, s6, 1
s_mul_i32 s6, s6, 12
s_xor_b32 s5, s5, s6
s_lshl_b32 s4, s4, 2
s_lshr_b32 s6, s5, 3
s_add_u32 s52, s4, s6
s_and_b32 s53, s5, 7
s_lshr_b32 s61, s50, 8
s_lshr_b32 s62, s50, 16
s_lshr_b32 s63, s50, 24
s_mov_b32 s96, 0x0c0c0400
s_mov_b32 s97, 0x04000c0c
s_mov_b32 s60, 1
s_lshr_b32 s42, s39, 1
s_lshl_b32 s41, s42, 8
s_add_u32 s41, s41, 151552
v_and_b32 v9, 15, v1
v_lshl_add_u32 v9, v9, 2, s41
s_and_b32 s99, s39, 1
s_lshl_b32 s41, s99, 6
s_add_u32 s98, s41, 153088
v_and_b32 v11, 48, v1
v_add_u32 v11, s98, v11
v_add_u32 v10, s41, v11
v_mov_b32 v202, 0x3f800000
v_mov_b32 v203, v202
s_lshl1_add_u32 s41, s36, s42
s_lshr_b32 s100, s41, 1
s_lshl_b32 s100, s100, 14
s_and_b32 s4, s41, 1
s_lshl_b32 s4, s4, 11
s_add_u32 s100, s100, s4
s_add_u32 s100, s100, 525312
s_lshr_b32 s42, s37, 1
s_lshl_b32 s42, s42, 8
s_add_u32 s100, s100, s42
s_mul_i32 s41, s41, 72
s_mul_i32 s42, s37, 7
s_add_u32 s41, s41, s42
s_lshl_b32 s41, s41, 12
s_add_u32 s41, s41, 1048576
s_and_b32 s42, s37, 1
s_add_u32 s98, s42, s99
s_lshl_b32 s98, s98, 12
s_add_u32 s98, s98, s41
s_lshl_b32 s99, s99, 9
s_add_u32 s99, s99, s41
s_xor_b32 s42, s42, 1
s_mul_i32 s42, s42, 24576
s_add_u32 s99, s99, s42
s_lshl_b32 s41, s39, 4
s_add_u32 s41, s41, 154176
v_lshrrev_b32_e64 v253, 5, v1
v_lshl_add_u32 v253, v253, 3, s41
v_mov_b32 v254, 154112
v_mov_b32 v232, s50
v_mov_b32 v233, 0
v_mov_b32 v234, 0
v_mov_b32 v235, 0
ds_write_b128 v254, v[232:235]
s_waitcnt vmcnt(5)
v_lshlrev_b32 v216, 16, v240
v_and_b32 v217, 0xffff0000, v240
v_lshlrev_b32_e64 v218, 16, v241
v_and_b32 v219, 0xffff0000, v241
v_lshlrev_b32_e64 v220, 16, v242
v_and_b32 v221, 0xffff0000, v242
v_lshlrev_b32_e64 v222, 16, v243
v_and_b32 v223, 0xffff0000, v243
v_lshlrev_b32_e64 v224, 16, v244
v_and_b32 v225, 0xffff0000, v244
v_lshlrev_b32_e64 v226, 16, v245
v_and_b32 v227, 0xffff0000, v245
v_lshlrev_b32_e64 v228, 16, v246
v_and_b32 v229, 0xffff0000, v246
v_lshlrev_b32_e64 v230, 16, v247
v_and_b32 v231, 0xffff0000, v247
v_pk_add_f32 v[240:241], v[216:217], v[218:219]
v_pk_add_f32 v[242:243], v[220:221], v[222:223]
v_pk_add_f32 v[244:245], v[224:225], v[226:227]
v_pk_add_f32 v[246:247], v[228:229], v[230:231]
v_pk_add_f32 v[240:241], v[240:241], v[242:243]
v_pk_add_f32 v[244:245], v[244:245], v[246:247]
v_pk_add_f32 v[240:241], v[240:241], v[244:245]
v_add_f32 v248, v240, v241
s_nop 1
v_add_f32_dpp v248, v248, v248 quad_perm:[1,0,3,2] row_mask:0xf bank_mask:0xf
s_nop 0
s_nop 0
v_add_f32_dpp v248, v248, v248 quad_perm:[2,3,0,1] row_mask:0xf bank_mask:0xf
s_nop 0
s_nop 0
v_add_f32_dpp v248, v248, v248 row_half_mirror row_mask:0xf bank_mask:0xf
s_nop 0
s_nop 0
v_add_f32_dpp v248, v248, v248 row_mirror row_mask:0xf bank_mask:0xf
v_mov_b32 v252, v248
s_nop 1
v_permlane16_swap_b32 v248, v252
v_add_f32 v248, v248, v252
v_mul_f32 v248, 0x3b000000, v248
v_sub_f32 v216, v216, v248
v_sub_f32 v217, v217, v248
v_sub_f32 v218, v218, v248
v_sub_f32 v219, v219, v248
v_sub_f32 v220, v220, v248
v_sub_f32 v221, v221, v248
v_sub_f32 v222, v222, v248
v_sub_f32 v223, v223, v248
v_sub_f32 v224, v224, v248
v_sub_f32 v225, v225, v248
v_sub_f32 v226, v226, v248
v_sub_f32 v227, v227, v248
v_sub_f32 v228, v228, v248
v_sub_f32 v229, v229, v248
v_sub_f32 v230, v230, v248
v_sub_f32 v231, v231, v248
v_pk_mul_f32 v[240:241], v[216:217], v[216:217]
v_pk_mul_f32 v[242:243], v[218:219], v[218:219]
v_pk_fma_f32 v[240:241], v[220:221], v[220:221], v[240:241]
v_pk_fma_f32 v[242:243], v[222:223], v[222:223], v[242:243]
v_pk_fma_f32 v[240:241], v[224:225], v[224:225], v[240:241]
v_pk_fma_f32 v[242:243], v[226:227], v[226:227], v[242:243]
v_pk_fma_f32 v[240:241], v[228:229], v[228:229], v[240:241]
v_pk_fma_f32 v[242:243], v[230:231], v[230:231], v[242:243]
v_pk_add_f32 v[240:241], v[240:241], v[242:243]
v_add_f32 v250, v240, v241
s_nop 1
v_add_f32_dpp v250, v250, v250 quad_perm:[1,0,3,2] row_mask:0xf bank_mask:0xf
s_nop 0
s_nop 0
v_add_f32_dpp v250, v250, v250 quad_perm:[2,3,0,1] row_mask:0xf bank_mask:0xf
s_nop 0
s_nop 0
v_add_f32_dpp v250, v250, v250 row_half_mirror row_mask:0xf bank_mask:0xf
s_nop 0
s_nop 0
v_add_f32_dpp v250, v250, v250 row_mirror row_mask:0xf bank_mask:0xf
v_mov_b32 v252, v250
s_nop 1
v_permlane16_swap_b32 v250, v252
v_add_f32 v250, v250, v252
v_mov_b32 v249, 0x3727c5ac
v_fmac_f32 v249, 0x3b000000, v250
v_rsq_f32 v249, v249
s_nop 0
ds_write_b64 v253, v[248:249]
s_mov_b64 exec, 0
s_cmp_eq_u32 s39, 0
s_cbranch_scc1 WS_F0
s_cmp_eq_u32 s39, 1
s_cbranch_scc1 WS_F1
s_cmp_eq_u32 s39, 2
s_cbranch_scc1 WS_F2
s_branch WS_F3
WR_F:
s_mov_b64 exec, -1
s_waitcnt vmcnt(0) lgkmcnt(0)
s_barrier
ds_read_b128 v[152:155], v4 offset:0
ds_read_b128 v[156:159], v4 offset:2048
ds_read_b128 v[160:163], v4 offset:4096
ds_read_b128 v[164:167], v4 offset:6144
ds_read_b64_tr_b16 v[124:125], v6 offset:0
ds_read_b64_tr_b16 v[126:127], v6 offset:512
ds_read_b64_tr_b16 v[128:129], v7 offset:0
ds_read_b64_tr_b16 v[130:131], v7 offset:512
ds_read_b64_tr_b16 v[132:133], v6 offset:8192
ds_read_b64_tr_b16 v[134:135], v6 offset:8704
ds_read_b64_tr_b16 v[136:137], v7 offset:8192
ds_read_b64_tr_b16 v[138:139], v7 offset:8704
s_waitcnt lgkmcnt(6)
v_mfma_f32_16x16x32_bf16 v[12:15], v[124:127], v[152:155], 0
ds_read_b64_tr_b16 v[140:141], v6 offset:16384
ds_read_b64_tr_b16 v[142:143], v6 offset:16896
v_mfma_f32_16x16x32_bf16 v[40:43], v[124:127], v[156:159], 0
ds_read_b64_tr_b16 v[144:145], v7 offset:16384
ds_read_b64_tr_b16 v[146:147], v7 offset:16896
v_mfma_f32_16x16x32_bf16 v[68:71], v[124:127], v[160:163], 0
ds_read_b64_tr_b16 v[148:149], v8 offset:24576
ds_read_b64_tr_b16 v[150:151], v8 offset:24832
v_mfma_f32_16x16x32_bf16 v[96:99], v[124:127], v[164:167], 0
ds_read_b128 v[168:171], v5 offset:0
ds_read_b128 v[172:175], v5 offset:2048
s_waitcnt lgkmcnt(8)
v_mfma_f32_16x16x32_bf16 v[100:103], v[128:131], v[164:167], 0
ds_read_b128 v[176:179], v5 offset:4096
ds_read_b128 v[180:183], v5 offset:6144
v_mfma_f32_16x16x32_bf16 v[72:75], v[128:131], v[160:163], 0
ds_read_b64_tr_b16 v[124:125], v6 offset:4096
v_mfma_f32_16x16x32_bf16 v[44:47], v[128:131], v[156:159], 0
ds_read_b64_tr_b16 v[126:127], v6 offset:4608
v_mfma_f32_16x16x32_bf16 v[16:19], v[128:131], v[152:155], 0
v_mfma_f32_16x16x32_bf16 v[20:23], v[132:135], v[152:155], 0
ds_read_b64_tr_b16 v[128:129], v7 offset:4096
v_mfma_f32_16x16x32_bf16 v[48:51], v[132:135], v[156:159], 0
ds_read_b64_tr_b16 v[130:131], v7 offset:4608
v_mfma_f32_16x16x32_bf16 v[76:79], v[132:135], v[160:163], 0
v_mfma_f32_16x16x32_bf16 v[104:107], v[132:135], v[164:167], 0
v_mfma_f32_16x16x32_bf16 v[108:111], v[136:139], v[164:167], 0
ds_read_b64_tr_b16 v[132:133], v6 offset:12288
v_mfma_f32_16x16x32_bf16 v[80:83], v[136:139], v[160:163], 0
ds_read_b64_tr_b16 v[134:135], v6 offset:12800
v_mfma_f32_16x16x32_bf16 v[52:55], v[136:139], v[156:159], 0
v_mfma_f32_16x16x32_bf16 v[24:27], v[136:139], v[152:155], 0
s_waitcnt lgkmcnt(8)
v_mfma_f32_16x16x32_bf16 v[28:31], v[140:143], v[152:155], 0
ds_read_b64_tr_b16 v[136:137], v7 offset:12288
v_mfma_f32_16x16x32_bf16 v[56:59], v[140:143], v[156:159], 0
ds_read_b64_tr_b16 v[138:139], v7 offset:12800
v_mfma_f32_16x16x32_bf16 v[84:87], v[140:143], v[160:163], 0
v_mfma_f32_16x16x32_bf16 v[112:115], v[140:143], v[164:167], 0
v_mfma_f32_16x16x32_bf16 v[116:119], v[144:147], v[164:167], 0
ds_read_b64_tr_b16 v[140:141], v6 offset:20480
v_mfma_f32_16x16x32_bf16 v[88:91], v[144:147], v[160:163], 0
ds_read_b64_tr_b16 v[142:143], v6 offset:20992
v_mfma_f32_16x16x32_bf16 v[60:63], v[144:147], v[156:159], 0
v_mfma_f32_16x16x32_bf16 v[32:35], v[144:147], v[152:155], 0
v_mfma_f32_16x16x32_bf16 v[36:39], v[148:151], v[152:155], 0
ds_read_b64_tr_b16 v[144:145], v7 offset:20480
v_mfma_f32_16x16x32_bf16 v[64:67], v[148:151], v[156:159], 0
ds_read_b64_tr_b16 v[146:147], v7 offset:20992
v_mfma_f32_16x16x32_bf16 v[92:95], v[148:151], v[160:163], 0
v_mfma_f32_16x16x32_bf16 v[120:123], v[148:151], v[164:167], 0
s_waitcnt lgkmcnt(8)
v_mfma_f32_16x16x32_bf16 v[12:15], v[124:127], v[168:171], v[12:15]
ds_read_b64_tr_b16 v[148:149], v8 offset:26624
v_mfma_f32_16x16x32_bf16 v[40:43], v[124:127], v[172:175], v[40:43]
ds_read_b64_tr_b16 v[150:151], v8 offset:26880
v_mfma_f32_16x16x32_bf16 v[68:71], v[124:127], v[176:179], v[68:71]
v_add_u32 v4, 0xffff5000, v4
v_add_u32 v5, 0xffff5000, v5
v_mfma_f32_16x16x32_bf16 v[96:99], v[124:127], v[180:183], v[96:99]
v_add_u32 v6, 0xffff5000, v6
v_add_u32 v7, 0xffff5000, v7
v_mfma_f32_16x16x32_bf16 v[100:103], v[128:131], v[180:183], v[100:103]
v_add_u32 v8, 0xffff5000, v8
v_mfma_f32_16x16x32_bf16 v[72:75], v[128:131], v[176:179], v[72:75]
v_mfma_f32_16x16x32_bf16 v[44:47], v[128:131], v[172:175], v[44:47]
v_mfma_f32_16x16x32_bf16 v[16:19], v[128:131], v[168:171], v[16:19]
s_waitcnt lgkmcnt(0)
s_barrier
v_mfma_f32_16x16x32_bf16 v[20:23], v[132:135], v[168:171], v[20:23]
ds_read_b128 v[152:155], v4 offset:0
ds_read_b128 v[156:159], v4 offset:2048
v_mfma_f32_16x16x32_bf16 v[48:51], v[132:135], v[172:175], v[48:51]
ds_read_b128 v[160:163], v4 offset:4096
ds_read_b128 v[164:167], v4 offset:6144
v_mfma_f32_16x16x32_bf16 v[76:79], v[132:135], v[176:179], v[76:79]
ds_read_b64_tr_b16 v[124:125], v6 offset:0
ds_read_b64_tr_b16 v[126:127], v6 offset:512
v_mfma_f32_16x16x32_bf16 v[104:107], v[132:135], v[180:183], v[104:107]
ds_read_b64_tr_b16 v[128:129], v7 offset:0
v_mfma_f32_16x16x32_bf16 v[108:111], v[136:139], v[180:183], v[108:111]
ds_read_b64_tr_b16 v[130:131], v7 offset:512
v_mfma_f32_16x16x32_bf16 v[80:83], v[136:139], v[176:179], v[80:83]
ds_read_b64_tr_b16 v[132:133], v6 offset:8192
v_mfma_f32_16x16x32_bf16 v[52:55], v[136:139], v[172:175], v[52:55]
ds_read_b64_tr_b16 v[134:135], v6 offset:8704
v_mfma_f32_16x16x32_bf16 v[24:27], v[136:139], v[168:171], v[24:27]
v_mfma_f32_16x16x32_bf16 v[28:31], v[140:143], v[168:171], v[28:31]
ds_read_b64_tr_b16 v[136:137], v7 offset:8192
v_mfma_f32_16x16x32_bf16 v[56:59], v[140:143], v[172:175], v[56:59]
ds_read_b64_tr_b16 v[138:139], v7 offset:8704
v_mfma_f32_16x16x32_bf16 v[84:87], v[140:143], v[176:179], v[84:87]
v_mfma_f32_16x16x32_bf16 v[112:115], v[140:143], v[180:183], v[112:115]
v_mfma_f32_16x16x32_bf16 v[116:119], v[144:147], v[180:183], v[116:119]
ds_read_b64_tr_b16 v[140:141], v6 offset:16384
v_mfma_f32_16x16x32_bf16 v[88:91], v[144:147], v[176:179], v[88:91]
ds_read_b64_tr_b16 v[142:143], v6 offset:16896
v_mfma_f32_16x16x32_bf16 v[60:63], v[144:147], v[172:175], v[60:63]
v_mfma_f32_16x16x32_bf16 v[32:35], v[144:147], v[168:171], v[32:35]
v_mfma_f32_16x16x32_bf16 v[36:39], v[148:151], v[168:171], v[36:39]
ds_read_b64_tr_b16 v[144:145], v7 offset:16384
v_mfma_f32_16x16x32_bf16 v[64:67], v[148:151], v[172:175], v[64:67]
ds_read_b64_tr_b16 v[146:147], v7 offset:16896
v_mfma_f32_16x16x32_bf16 v[92:95], v[148:151], v[176:179], v[92:95]
v_mfma_f32_16x16x32_bf16 v[120:123], v[148:151], v[180:183], v[120:123]
s_waitcnt lgkmcnt(8)
v_mfma_f32_16x16x32_bf16 v[12:15], v[124:127], v[152:155], v[12:15]
ds_read_b64_tr_b16 v[148:149], v8 offset:24576
ds_read_b64_tr_b16 v[150:151], v8 offset:24832
v_mfma_f32_16x16x32_bf16 v[40:43], v[124:127], v[156:159], v[40:43]
ds_read_b128 v[168:171], v5 offset:0
ds_read_b128 v[172:175], v5 offset:2048
v_mfma_f32_16x16x32_bf16 v[68:71], v[124:127], v[160:163], v[68:71]
ds_read_b128 v[176:179], v5 offset:4096
v_mfma_f32_16x16x32_bf16 v[96:99], v[124:127], v[164:167], v[96:99]
ds_read_b128 v[180:183], v5 offset:6144
v_mfma_f32_16x16x32_bf16 v[100:103], v[128:131], v[164:167], v[100:103]
ds_read_b64_tr_b16 v[124:125], v6 offset:4096
v_mfma_f32_16x16x32_bf16 v[72:75], v[128:131], v[160:163], v[72:75]
ds_read_b64_tr_b16 v[126:127], v6 offset:4608
v_mfma_f32_16x16x32_bf16 v[44:47], v[128:131], v[156:159], v[44:47]
v_mfma_f32_16x16x32_bf16 v[16:19], v[128:131], v[152:155], v[16:19]
s_waitcnt lgkmcnt(8)
v_mfma_f32_16x16x32_bf16 v[20:23], v[132:135], v[152:155], v[20:23]
ds_read_b64_tr_b16 v[128:129], v7 offset:4096
v_mfma_f32_16x16x32_bf16 v[48:51], v[132:135], v[156:159], v[48:51]
ds_read_b64_tr_b16 v[130:131], v7 offset:4608
v_mfma_f32_16x16x32_bf16 v[76:79], v[132:135], v[160:163], v[76:79]
v_mfma_f32_16x16x32_bf16 v[104:107], v[132:135], v[164:167], v[104:107]
v_mfma_f32_16x16x32_bf16 v[108:111], v[136:139], v[164:167], v[108:111]
ds_read_b64_tr_b16 v[132:133], v6 offset:12288
v_mfma_f32_16x16x32_bf16 v[80:83], v[136:139], v[160:163], v[80:83]
ds_read_b64_tr_b16 v[134:135], v6 offset:12800
v_mfma_f32_16x16x32_bf16 v[52:55], v[136:139], v[156:159], v[52:55]
v_mfma_f32_16x16x32_bf16 v[24:27], v[136:139], v[152:155], v[24:27]
v_mfma_f32_16x16x32_bf16 v[28:31], v[140:143], v[152:155], v[28:31]
ds_read_b64_tr_b16 v[136:137], v7 offset:12288
v_mfma_f32_16x16x32_bf16 v[56:59], v[140:143], v[156:159], v[56:59]
ds_read_b64_tr_b16 v[138:139], v7 offset:12800
v_mfma_f32_16x16x32_bf16 v[84:87], v[140:143], v[160:163], v[84:87]
v_mfma_f32_16x16x32_bf16 v[112:115], v[140:143], v[164:167], v[112:115]
v_mfma_f32_16x16x32_bf16 v[116:119], v[144:147], v[164:167], v[116:119]
ds_read_b64_tr_b16 v[140:141], v6 offset:20480
v_mfma_f32_16x16x32_bf16 v[88:91], v[144:147], v[160:163], v[88:91]
ds_read_b64_tr_b16 v[142:143], v6 offset:20992
v_mfma_f32_16x16x32_bf16 v[60:63], v[144:147], v[156:159], v[60:63]
v_mfma_f32_16x16x32_bf16 v[32:35], v[144:147], v[152:155], v[32:35]
s_waitcnt lgkmcnt(8)
v_mfma_f32_16x16x32_bf16 v[36:39], v[148:151], v[152:155], v[36:39]
ds_read_b64_tr_b16 v[144:145], v7 offset:20480
v_mfma_f32_16x16x32_bf16 v[64:67], v[148:151], v[156:159], v[64:67]
ds_read_b64_tr_b16 v[146:147], v7 offset:20992
v_mfma_f32_16x16x32_bf16 v[92:95], v[148:151], v[160:163], v[92:95]
v_mfma_f32_16x16x32_bf16 v[120:123], v[148:151], v[164:167], v[120:123]
v_mfma_f32_16x16x32_bf16 v[12:15], v[124:127], v[168:171], v[12:15]
ds_read_b64_tr_b16 v[148:149], v8 offset:26624
v_mfma_f32_16x16x32_bf16 v[40:43], v[124:127], v[172:175], v[40:43]
ds_read_b64_tr_b16 v[150:151], v8 offset:26880
v_mfma_f32_16x16x32_bf16 v[68:71], v[124:127], v[176:179], v[68:71]
v_add_u32 v4, 0xffff5000, v4
v_add_u32 v5, 0xffff5000, v5
v_mfma_f32_16x16x32_bf16 v[96:99], v[124:127], v[180:183], v[96:99]
v_add_u32 v6, 0xffff5000, v6
v_add_u32 v7, 0xffff5000, v7
s_waitcnt lgkmcnt(8)
v_mfma_f32_16x16x32_bf16 v[100:103], v[128:131], v[180:183], v[100:103]
v_add_u32 v8, 0xffff5000, v8
v_mfma_f32_16x16x32_bf16 v[72:75], v[128:131], v[176:179], v[72:75]
v_mfma_f32_16x16x32_bf16 v[44:47], v[128:131], v[172:175], v[44:47]
v_mfma_f32_16x16x32_bf16 v[16:19], v[128:131], v[168:171], v[16:19]
s_waitcnt lgkmcnt(0)
s_barrier
v_mfma_f32_16x16x32_bf16 v[20:23], v[132:135], v[168:171], v[20:23]
ds_read_b128 v[152:155], v4 offset:0
ds_read_b128 v[156:159], v4 offset:2048
v_mfma_f32_16x16x32_bf16 v[48:51], v[132:135], v[172:175], v[48:51]
ds_read_b128 v[160:163], v4 offset:4096
ds_read_b128 v[164:167], v4 offset:6144
v_mfma_f32_16x16x32_bf16 v[76:79], v[132:135], v[176:179], v[76:79]
ds_read_b64_tr_b16 v[124:125], v6 offset:0
ds_read_b64_tr_b16 v[126:127], v6 offset:512
v_mfma_f32_16x16x32_bf16 v[104:107], v[132:135], v[180:183], v[104:107]
ds_read_b64_tr_b16 v[128:129], v7 offset:0
v_mfma_f32_16x16x32_bf16 v[108:111], v[136:139], v[180:183], v[108:111]
ds_read_b64_tr_b16 v[130:131], v7 offset:512
v_mfma_f32_16x16x32_bf16 v[80:83], v[136:139], v[176:179], v[80:83]
ds_read_b64_tr_b16 v[132:133], v6 offset:8192
v_mfma_f32_16x16x32_bf16 v[52:55], v[136:139], v[172:175], v[52:55]
ds_read_b64_tr_b16 v[134:135], v6 offset:8704
v_mfma_f32_16x16x32_bf16 v[24:27], v[136:139], v[168:171], v[24:27]
v_mfma_f32_16x16x32_bf16 v[28:31], v[140:143], v[168:171], v[28:31]
ds_read_b64_tr_b16 v[136:137], v7 offset:8192
v_mfma_f32_16x16x32_bf16 v[56:59], v[140:143], v[172:175], v[56:59]
ds_read_b64_tr_b16 v[138:139], v7 offset:8704
v_mfma_f32_16x16x32_bf16 v[84:87], v[140:143], v[176:179], v[84:87]
v_mfma_f32_16x16x32_bf16 v[112:115], v[140:143], v[180:183], v[112:115]
v_mfma_f32_16x16x32_bf16 v[116:119], v[144:147], v[180:183], v[116:119]
ds_read_b64_tr_b16 v[140:141], v6 offset:16384
v_mfma_f32_16x16x32_bf16 v[88:91], v[144:147], v[176:179], v[88:91]
ds_read_b64_tr_b16 v[142:143], v6 offset:16896
v_mfma_f32_16x16x32_bf16 v[60:63], v[144:147], v[172:175], v[60:63]
v_mfma_f32_16x16x32_bf16 v[32:35], v[144:147], v[168:171], v[32:35]
v_mfma_f32_16x16x32_bf16 v[36:39], v[148:151], v[168:171], v[36:39]
ds_read_b64_tr_b16 v[144:145], v7 offset:16384
v_mfma_f32_16x16x32_bf16 v[64:67], v[148:151], v[172:175], v[64:67]
ds_read_b64_tr_b16 v[146:147], v7 offset:16896
v_mfma_f32_16x16x32_bf16 v[92:95], v[148:151], v[176:179], v[92:95]
v_mfma_f32_16x16x32_bf16 v[120:123], v[148:151], v[180:183], v[120:123]
s_waitcnt lgkmcnt(8)
v_mfma_f32_16x16x32_bf16 v[12:15], v[124:127], v[152:155], v[12:15]
ds_read_b64_tr_b16 v[148:149], v8 offset:24576
ds_read_b64_tr_b16 v[150:151], v8 offset:24832
v_mfma_f32_16x16x32_bf16 v[40:43], v[124:127], v[156:159], v[40:43]
ds_read_b128 v[168:171], v5 offset:0
ds_read_b128 v[172:175], v5 offset:2048
v_mfma_f32_16x16x32_bf16 v[68:71], v[124:127], v[160:163], v[68:71]
ds_read_b128 v[176:179], v5 offset:4096
v_mfma_f32_16x16x32_bf16 v[96:99], v[124:127], v[164:167], v[96:99]
ds_read_b128 v[180:183], v5 offset:6144
v_mfma_f32_16x16x32_bf16 v[100:103], v[128:131], v[164:167], v[100:103]
ds_read_b64_tr_b16 v[124:125], v6 offset:4096
v_mfma_f32_16x16x32_bf16 v[72:75], v[128:131], v[160:163], v[72:75]
ds_read_b64_tr_b16 v[126:127], v6 offset:4608
v_mfma_f32_16x16x32_bf16 v[44:47], v[128:131], v[156:159], v[44:47]
v_mfma_f32_16x16x32_bf16 v[16:19], v[128:131], v[152:155], v[16:19]
s_waitcnt lgkmcnt(8)
v_mfma_f32_16x16x32_bf16 v[20:23], v[132:135], v[152:155], v[20:23]
ds_read_b64_tr_b16 v[128:129], v7 offset:4096
v_mfma_f32_16x16x32_bf16 v[48:51], v[132:135], v[156:159], v[48:51]
ds_read_b64_tr_b16 v[130:131], v7 offset:4608
v_mfma_f32_16x16x32_bf16 v[76:79], v[132:135], v[160:163], v[76:79]
v_mfma_f32_16x16x32_bf16 v[104:107], v[132:135], v[164:167], v[104:107]
v_mfma_f32_16x16x32_bf16 v[108:111], v[136:139], v[164:167], v[108:111]
ds_read_b64_tr_b16 v[132:133], v6 offset:12288
v_mfma_f32_16x16x32_bf16 v[80:83], v[136:139], v[160:163], v[80:83]
ds_read_b64_tr_b16 v[134:135], v6 offset:12800
v_mfma_f32_16x16x32_bf16 v[52:55], v[136:139], v[156:159], v[52:55]
v_mfma_f32_16x16x32_bf16 v[24:27], v[136:139], v[152:155], v[24:27]
v_mfma_f32_16x16x32_bf16 v[28:31], v[140:143], v[152:155], v[28:31]
ds_read_b64_tr_b16 v[136:137], v7 offset:12288
v_mfma_f32_16x16x32_bf16 v[56:59], v[140:143], v[156:159], v[56:59]
ds_read_b64_tr_b16 v[138:139], v7 offset:12800
v_mfma_f32_16x16x32_bf16 v[84:87], v[140:143], v[160:163], v[84:87]
v_mfma_f32_16x16x32_bf16 v[112:115], v[140:143], v[164:167], v[112:115]
v_mfma_f32_16x16x32_bf16 v[116:119], v[144:147], v[164:167], v[116:119]
ds_read_b64_tr_b16 v[140:141], v6 offset:20480
v_mfma_f32_16x16x32_bf16 v[88:91], v[144:147], v[160:163], v[88:91]
ds_read_b64_tr_b16 v[142:143], v6 offset:20992
v_mfma_f32_16x16x32_bf16 v[60:63], v[144:147], v[156:159], v[60:63]
v_mfma_f32_16x16x32_bf16 v[32:35], v[144:147], v[152:155], v[32:35]
s_waitcnt lgkmcnt(8)
v_mfma_f32_16x16x32_bf16 v[36:39], v[148:151], v[152:155], v[36:39]
ds_read_b64_tr_b16 v[144:145], v7 offset:20480
v_mfma_f32_16x16x32_bf16 v[64:67], v[148:151], v[156:159], v[64:67]
ds_read_b64_tr_b16 v[146:147], v7 offset:20992
v_mfma_f32_16x16x32_bf16 v[92:95], v[148:151], v[160:163], v[92:95]
v_mfma_f32_16x16x32_bf16 v[120:123], v[148:151], v[164:167], v[120:123]
v_mfma_f32_16x16x32_bf16 v[12:15], v[124:127], v[168:171], v[12:15]
ds_read_b64_tr_b16 v[148:149], v8 offset:26624
v_mfma_f32_16x16x32_bf16 v[40:43], v[124:127], v[172:175], v[40:43]
ds_read_b64_tr_b16 v[150:151], v8 offset:26880
v_mfma_f32_16x16x32_bf16 v[68:71], v[124:127], v[176:179], v[68:71]
v_add_u32 v4, 0x16000, v4
v_add_u32 v5, 0x16000, v5
v_mfma_f32_16x16x32_bf16 v[96:99], v[124:127], v[180:183], v[96:99]
v_add_u32 v6, 0x16000, v6
v_add_u32 v7, 0x16000, v7
s_waitcnt lgkmcnt(8)
v_mfma_f32_16x16x32_bf16 v[100:103], v[128:131], v[180:183], v[100:103]
v_add_u32 v8, 0x16000, v8
v_mfma_f32_16x16x32_bf16 v[72:75], v[128:131], v[176:179], v[72:75]
v_mfma_f32_16x16x32_bf16 v[44:47], v[128:131], v[172:175], v[44:47]
v_mfma_f32_16x16x32_bf16 v[16:19], v[128:131], v[168:171], v[16:19]
s_waitcnt lgkmcnt(0)
s_barrier
v_mfma_f32_16x16x32_bf16 v[20:23], v[132:135], v[168:171], v[20:23]
ds_read_b128 v[152:155], v4 offset:0
ds_read_b128 v[156:159], v4 offset:2048
v_mfma_f32_16x16x32_bf16 v[48:51], v[132:135], v[172:175], v[48:51]
ds_read_b128 v[160:163], v4 offset:4096
ds_read_b128 v[164:167], v4 offset:6144
v_mfma_f32_16x16x32_bf16 v[76:79], v[132:135], v[176:179], v[76:79]
ds_read_b64_tr_b16 v[124:125], v6 offset:0
ds_read_b64_tr_b16 v[126:127], v6 offset:512
v_mfma_f32_16x16x32_bf16 v[104:107], v[132:135], v[180:183], v[104:107]
ds_read_b64_tr_b16 v[128:129], v7 offset:0
v_mfma_f32_16x16x32_bf16 v[108:111], v[136:139], v[180:183], v[108:111]
ds_read_b64_tr_b16 v[130:131], v7 offset:512
v_mfma_f32_16x16x32_bf16 v[80:83], v[136:139], v[176:179], v[80:83]
ds_read_b64_tr_b16 v[132:133], v6 offset:8192
v_mfma_f32_16x16x32_bf16 v[52:55], v[136:139], v[172:175], v[52:55]
ds_read_b64_tr_b16 v[134:135], v6 offset:8704
v_mfma_f32_16x16x32_bf16 v[24:27], v[136:139], v[168:171], v[24:27]
v_mfma_f32_16x16x32_bf16 v[28:31], v[140:143], v[168:171], v[28:31]
ds_read_b64_tr_b16 v[136:137], v7 offset:8192
v_mfma_f32_16x16x32_bf16 v[56:59], v[140:143], v[172:175], v[56:59]
ds_read_b64_tr_b16 v[138:139], v7 offset:8704
v_mfma_f32_16x16x32_bf16 v[84:87], v[140:143], v[176:179], v[84:87]
v_mfma_f32_16x16x32_bf16 v[112:115], v[140:143], v[180:183], v[112:115]
v_mfma_f32_16x16x32_bf16 v[116:119], v[144:147], v[180:183], v[116:119]
ds_read_b64_tr_b16 v[140:141], v6 offset:16384
v_mfma_f32_16x16x32_bf16 v[88:91], v[144:147], v[176:179], v[88:91]
ds_read_b64_tr_b16 v[142:143], v6 offset:16896
v_mfma_f32_16x16x32_bf16 v[60:63], v[144:147], v[172:175], v[60:63]
v_mfma_f32_16x16x32_bf16 v[32:35], v[144:147], v[168:171], v[32:35]
v_mfma_f32_16x16x32_bf16 v[36:39], v[148:151], v[168:171], v[36:39]
ds_read_b64_tr_b16 v[144:145], v7 offset:16384
v_mfma_f32_16x16x32_bf16 v[64:67], v[148:151], v[172:175], v[64:67]
ds_read_b64_tr_b16 v[146:147], v7 offset:16896
v_mfma_f32_16x16x32_bf16 v[92:95], v[148:151], v[176:179], v[92:95]
v_mfma_f32_16x16x32_bf16 v[120:123], v[148:151], v[180:183], v[120:123]
s_waitcnt lgkmcnt(8)
v_mfma_f32_16x16x32_bf16 v[12:15], v[124:127], v[152:155], v[12:15]
ds_read_b64_tr_b16 v[148:149], v8 offset:24576
ds_read_b64_tr_b16 v[150:151], v8 offset:24832
v_mfma_f32_16x16x32_bf16 v[40:43], v[124:127], v[156:159], v[40:43]
ds_read_b128 v[168:171], v5 offset:0
ds_read_b128 v[172:175], v5 offset:2048
v_mfma_f32_16x16x32_bf16 v[68:71], v[124:127], v[160:163], v[68:71]
ds_read_b128 v[176:179], v5 offset:4096
v_mfma_f32_16x16x32_bf16 v[96:99], v[124:127], v[164:167], v[96:99]
ds_read_b128 v[180:183], v5 offset:6144
v_mfma_f32_16x16x32_bf16 v[100:103], v[128:131], v[164:167], v[100:103]
ds_read_b64_tr_b16 v[124:125], v6 offset:4096
v_mfma_f32_16x16x32_bf16 v[72:75], v[128:131], v[160:163], v[72:75]
ds_read_b64_tr_b16 v[126:127], v6 offset:4608
v_mfma_f32_16x16x32_bf16 v[44:47], v[128:131], v[156:159], v[44:47]
v_mfma_f32_16x16x32_bf16 v[16:19], v[128:131], v[152:155], v[16:19]
s_waitcnt lgkmcnt(8)
v_mfma_f32_16x16x32_bf16 v[20:23], v[132:135], v[152:155], v[20:23]
ds_read_b64_tr_b16 v[128:129], v7 offset:4096
v_mfma_f32_16x16x32_bf16 v[48:51], v[132:135], v[156:159], v[48:51]
ds_read_b64_tr_b16 v[130:131], v7 offset:4608
v_mfma_f32_16x16x32_bf16 v[76:79], v[132:135], v[160:163], v[76:79]
v_mfma_f32_16x16x32_bf16 v[104:107], v[132:135], v[164:167], v[104:107]
v_mfma_f32_16x16x32_bf16 v[108:111], v[136:139], v[164:167], v[108:111]
ds_read_b64_tr_b16 v[132:133], v6 offset:12288
v_mfma_f32_16x16x32_bf16 v[80:83], v[136:139], v[160:163], v[80:83]
ds_read_b64_tr_b16 v[134:135], v6 offset:12800
v_mfma_f32_16x16x32_bf16 v[52:55], v[136:139], v[156:159], v[52:55]
v_mfma_f32_16x16x32_bf16 v[24:27], v[136:139], v[152:155], v[24:27]
v_mfma_f32_16x16x32_bf16 v[28:31], v[140:143], v[152:155], v[28:31]
ds_read_b64_tr_b16 v[136:137], v7 offset:12288
v_mfma_f32_16x16x32_bf16 v[56:59], v[140:143], v[156:159], v[56:59]
ds_read_b64_tr_b16 v[138:139], v7 offset:12800
v_mfma_f32_16x16x32_bf16 v[84:87], v[140:143], v[160:163], v[84:87]
v_mfma_f32_16x16x32_bf16 v[112:115], v[140:143], v[164:167], v[112:115]
v_mfma_f32_16x16x32_bf16 v[116:119], v[144:147], v[164:167], v[116:119]
ds_read_b64_tr_b16 v[140:141], v6 offset:20480
v_mfma_f32_16x16x32_bf16 v[88:91], v[144:147], v[160:163], v[88:91]
ds_read_b64_tr_b16 v[142:143], v6 offset:20992
v_mfma_f32_16x16x32_bf16 v[60:63], v[144:147], v[156:159], v[60:63]
v_mfma_f32_16x16x32_bf16 v[32:35], v[144:147], v[152:155], v[32:35]
s_waitcnt lgkmcnt(8)
v_mfma_f32_16x16x32_bf16 v[36:39], v[148:151], v[152:155], v[36:39]
ds_read_b64_tr_b16 v[144:145], v7 offset:20480
v_mfma_f32_16x16x32_bf16 v[64:67], v[148:151], v[156:159], v[64:67]
ds_read_b64_tr_b16 v[146:147], v7 offset:20992
v_mfma_f32_16x16x32_bf16 v[92:95], v[148:151], v[160:163], v[92:95]
v_mfma_f32_16x16x32_bf16 v[120:123], v[148:151], v[164:167], v[120:123]
v_mfma_f32_16x16x32_bf16 v[12:15], v[124:127], v[168:171], v[12:15]
ds_read_b64_tr_b16 v[148:149], v8 offset:26624
v_mfma_f32_16x16x32_bf16 v[40:43], v[124:127], v[172:175], v[40:43]
ds_read_b64_tr_b16 v[150:151], v8 offset:26880
v_mfma_f32_16x16x32_bf16 v[68:71], v[124:127], v[176:179], v[68:71]
v_add_u32 v4, 0xffff5000, v4
v_add_u32 v5, 0xffff5000, v5
v_mfma_f32_16x16x32_bf16 v[96:99], v[124:127], v[180:183], v[96:99]
v_add_u32 v6, 0xffff5000, v6
v_add_u32 v7, 0xffff5000, v7
s_waitcnt lgkmcnt(8)
v_mfma_f32_16x16x32_bf16 v[100:103], v[128:131], v[180:183], v[100:103]
v_add_u32 v8, 0xffff5000, v8
v_mfma_f32_16x16x32_bf16 v[72:75], v[128:131], v[176:179], v[72:75]
v_mfma_f32_16x16x32_bf16 v[44:47], v[128:131], v[172:175], v[44:47]
v_mfma_f32_16x16x32_bf16 v[16:19], v[128:131], v[168:171], v[16:19]
s_waitcnt lgkmcnt(0)
s_barrier
v_mfma_f32_16x16x32_bf16 v[20:23], v[132:135], v[168:171], v[20:23]
ds_read_b128 v[152:155], v4 offset:0
ds_read_b128 v[156:159], v4 offset:2048
v_mfma_f32_16x16x32_bf16 v[48:51], v[132:135], v[172:175], v[48:51]
ds_read_b128 v[160:163], v4 offset:4096
ds_read_b128 v[164:167], v4 offset:6144
v_mfma_f32_16x16x32_bf16 v[76:79], v[132:135], v[176:179], v[76:79]
ds_read_b64_tr_b16 v[124:125], v6 offset:0
ds_read_b64_tr_b16 v[126:127], v6 offset:512
v_mfma_f32_16x16x32_bf16 v[104:107], v[132:135], v[180:183], v[104:107]
ds_read_b64_tr_b16 v[128:129], v7 offset:0
v_mfma_f32_16x16x32_bf16 v[108:111], v[136:139], v[180:183], v[108:111]
ds_read_b64_tr_b16 v[130:131], v7 offset:512
v_mfma_f32_16x16x32_bf16 v[80:83], v[136:139], v[176:179], v[80:83]
ds_read_b64_tr_b16 v[132:133], v6 offset:8192
v_mfma_f32_16x16x32_bf16 v[52:55], v[136:139], v[172:175], v[52:55]
ds_read_b64_tr_b16 v[134:135], v6 offset:8704
v_mfma_f32_16x16x32_bf16 v[24:27], v[136:139], v[168:171], v[24:27]
v_mfma_f32_16x16x32_bf16 v[28:31], v[140:143], v[168:171], v[28:31]
ds_read_b64_tr_b16 v[136:137], v7 offset:8192
v_mfma_f32_16x16x32_bf16 v[56:59], v[140:143], v[172:175], v[56:59]
ds_read_b64_tr_b16 v[138:139], v7 offset:8704
v_mfma_f32_16x16x32_bf16 v[84:87], v[140:143], v[176:179], v[84:87]
v_mfma_f32_16x16x32_bf16 v[112:115], v[140:143], v[180:183], v[112:115]
v_mfma_f32_16x16x32_bf16 v[116:119], v[144:147], v[180:183], v[116:119]
ds_read_b64_tr_b16 v[140:141], v6 offset:16384
v_mfma_f32_16x16x32_bf16 v[88:91], v[144:147], v[176:179], v[88:91]
ds_read_b64_tr_b16 v[142:143], v6 offset:16896
v_mfma_f32_16x16x32_bf16 v[60:63], v[144:147], v[172:175], v[60:63]
v_mfma_f32_16x16x32_bf16 v[32:35], v[144:147], v[168:171], v[32:35]
v_mfma_f32_16x16x32_bf16 v[36:39], v[148:151], v[168:171], v[36:39]
ds_read_b64_tr_b16 v[144:145], v7 offset:16384
v_mfma_f32_16x16x32_bf16 v[64:67], v[148:151], v[172:175], v[64:67]
ds_read_b64_tr_b16 v[146:147], v7 offset:16896
v_mfma_f32_16x16x32_bf16 v[92:95], v[148:151], v[176:179], v[92:95]
v_mfma_f32_16x16x32_bf16 v[120:123], v[148:151], v[180:183], v[120:123]
s_waitcnt lgkmcnt(8)
v_mfma_f32_16x16x32_bf16 v[12:15], v[124:127], v[152:155], v[12:15]
ds_read_b64_tr_b16 v[148:149], v8 offset:24576
ds_read_b64_tr_b16 v[150:151], v8 offset:24832
v_mfma_f32_16x16x32_bf16 v[40:43], v[124:127], v[156:159], v[40:43]
ds_read_b128 v[168:171], v5 offset:0
ds_read_b128 v[172:175], v5 offset:2048
v_mfma_f32_16x16x32_bf16 v[68:71], v[124:127], v[160:163], v[68:71]
ds_read_b128 v[176:179], v5 offset:4096
v_mfma_f32_16x16x32_bf16 v[96:99], v[124:127], v[164:167], v[96:99]
ds_read_b128 v[180:183], v5 offset:6144
v_mfma_f32_16x16x32_bf16 v[100:103], v[128:131], v[164:167], v[100:103]
ds_read_b64_tr_b16 v[124:125], v6 offset:4096
v_mfma_f32_16x16x32_bf16 v[72:75], v[128:131], v[160:163], v[72:75]
ds_read_b64_tr_b16 v[126:127], v6 offset:4608
v_mfma_f32_16x16x32_bf16 v[44:47], v[128:131], v[156:159], v[44:47]
v_mfma_f32_16x16x32_bf16 v[16:19], v[128:131], v[152:155], v[16:19]
s_waitcnt lgkmcnt(8)
v_mfma_f32_16x16x32_bf16 v[20:23], v[132:135], v[152:155], v[20:23]
ds_read_b64_tr_b16 v[128:129], v7 offset:4096
v_mfma_f32_16x16x32_bf16 v[48:51], v[132:135], v[156:159], v[48:51]
ds_read_b64_tr_b16 v[130:131], v7 offset:4608
v_mfma_f32_16x16x32_bf16 v[76:79], v[132:135], v[160:163], v[76:79]
v_mfma_f32_16x16x32_bf16 v[104:107], v[132:135], v[164:167], v[104:107]
v_mfma_f32_16x16x32_bf16 v[108:111], v[136:139], v[164:167], v[108:111]
ds_read_b64_tr_b16 v[132:133], v6 offset:12288
v_mfma_f32_16x16x32_bf16 v[80:83], v[136:139], v[160:163], v[80:83]
ds_read_b64_tr_b16 v[134:135], v6 offset:12800
v_mfma_f32_16x16x32_bf16 v[52:55], v[136:139], v[156:159], v[52:55]
v_mfma_f32_16x16x32_bf16 v[24:27], v[136:139], v[152:155], v[24:27]
v_mfma_f32_16x16x32_bf16 v[28:31], v[140:143], v[152:155], v[28:31]
ds_read_b64_tr_b16 v[136:137], v7 offset:12288
v_mfma_f32_16x16x32_bf16 v[56:59], v[140:143], v[156:159], v[56:59]
ds_read_b64_tr_b16 v[138:139], v7 offset:12800
v_mfma_f32_16x16x32_bf16 v[84:87], v[140:143], v[160:163], v[84:87]
v_mfma_f32_16x16x32_bf16 v[112:115], v[140:143], v[164:167], v[112:115]
v_mfma_f32_16x16x32_bf16 v[116:119], v[144:147], v[164:167], v[116:119]
ds_read_b64_tr_b16 v[140:141], v6 offset:20480
v_mfma_f32_16x16x32_bf16 v[88:91], v[144:147], v[160:163], v[88:91]
ds_read_b64_tr_b16 v[142:143], v6 offset:20992
v_mfma_f32_16x16x32_bf16 v[60:63], v[144:147], v[156:159], v[60:63]
v_mfma_f32_16x16x32_bf16 v[32:35], v[144:147], v[152:155], v[32:35]
s_waitcnt lgkmcnt(8)
v_mfma_f32_16x16x32_bf16 v[36:39], v[148:151], v[152:155], v[36:39]
ds_read_b64_tr_b16 v[144:145], v7 offset:20480
v_mfma_f32_16x16x32_bf16 v[64:67], v[148:151], v[156:159], v[64:67]
ds_read_b64_tr_b16 v[146:147], v7 offset:20992
v_mfma_f32_16x16x32_bf16 v[92:95], v[148:151], v[160:163], v[92:95]
v_mfma_f32_16x16x32_bf16 v[120:123], v[148:151], v[164:167], v[120:123]
v_mfma_f32_16x16x32_bf16 v[12:15], v[124:127], v[168:171], v[12:15]
ds_read_b64_tr_b16 v[148:149], v8 offset:26624
v_mfma_f32_16x16x32_bf16 v[40:43], v[124:127], v[172:175], v[40:43]
ds_read_b64_tr_b16 v[150:151], v8 offset:26880
v_mfma_f32_16x16x32_bf16 v[68:71], v[124:127], v[176:179], v[68:71]
v_add_u32 v4, 0xffff5000, v4
v_add_u32 v5, 0xffff5000, v5
v_mfma_f32_16x16x32_bf16 v[96:99], v[124:127], v[180:183], v[96:99]
v_add_u32 v6, 0xffff5000, v6
v_add_u32 v7, 0xffff5000, v7
s_waitcnt lgkmcnt(8)
v_mfma_f32_16x16x32_bf16 v[100:103], v[128:131], v[180:183], v[100:103]
v_add_u32 v8, 0xffff5000, v8
v_mfma_f32_16x16x32_bf16 v[72:75], v[128:131], v[176:179], v[72:75]
v_mfma_f32_16x16x32_bf16 v[44:47], v[128:131], v[172:175], v[44:47]
v_mfma_f32_16x16x32_bf16 v[16:19], v[128:131], v[168:171], v[16:19]
s_waitcnt lgkmcnt(0)
s_barrier
v_mfma_f32_16x16x32_bf16 v[20:23], v[132:135], v[168:171], v[20:23]
ds_read_b128 v[152:155], v4 offset:0
ds_read_b128 v[156:159], v4 offset:2048
v_mfma_f32_16x16x32_bf16 v[48:51], v[132:135], v[172:175], v[48:51]
ds_read_b128 v[160:163], v4 offset:4096
ds_read_b128 v[164:167], v4 offset:6144
v_mfma_f32_16x16x32_bf16 v[76:79], v[132:135], v[176:179], v[76:79]
ds_read_b64_tr_b16 v[124:125], v6 offset:0
ds_read_b64_tr_b16 v[126:127], v6 offset:512
v_mfma_f32_16x16x32_bf16 v[104:107], v[132:135], v[180:183], v[104:107]
ds_read_b64_tr_b16 v[128:129], v7 offset:0
v_mfma_f32_16x16x32_bf16 v[108:111], v[136:139], v[180:183], v[108:111]
ds_read_b64_tr_b16 v[130:131], v7 offset:512
v_mfma_f32_16x16x32_bf16 v[80:83], v[136:139], v[176:179], v[80:83]
WS_F0:
WS_4438:
s_cbranch_execz WS_1875
s_nop 0
ds_read_b64_tr_b16 v[132:133], v6 offset:8192
v_mfma_f32_16x16x32_bf16 v[52:55], v[136:139], v[172:175], v[52:55]
ds_read_b64_tr_b16 v[134:135], v6 offset:8704
v_mfma_f32_16x16x32_bf16 v[24:27], v[136:139], v[168:171], v[24:27]
v_mfma_f32_16x16x32_bf16 v[28:31], v[140:143], v[168:171], v[28:31]
ds_read_b64_tr_b16 v[136:137], v7 offset:8192
v_mfma_f32_16x16x32_bf16 v[56:59], v[140:143], v[172:175], v[56:59]
ds_read_b64_tr_b16 v[138:139], v7 offset:8704
v_mfma_f32_16x16x32_bf16 v[84:87], v[140:143], v[176:179], v[84:87]
v_mfma_f32_16x16x32_bf16 v[112:115], v[140:143], v[180:183], v[112:115]
v_mfma_f32_16x16x32_bf16 v[116:119], v[144:147], v[180:183], v[116:119]
ds_read_b64_tr_b16 v[140:141], v6 offset:16384
v_mfma_f32_16x16x32_bf16 v[88:91], v[144:147], v[176:179], v[88:91]
ds_read_b64_tr_b16 v[142:143], v6 offset:16896
v_mfma_f32_16x16x32_bf16 v[60:63], v[144:147], v[172:175], v[60:63]
v_mfma_f32_16x16x32_bf16 v[32:35], v[144:147], v[168:171], v[32:35]
v_mfma_f32_16x16x32_bf16 v[36:39], v[148:151], v[168:171], v[36:39]
ds_read_b64_tr_b16 v[144:145], v7 offset:16384
v_mfma_f32_16x16x32_bf16 v[64:67], v[148:151], v[172:175], v[64:67]
ds_read_b64_tr_b16 v[146:147], v7 offset:16896
v_mfma_f32_16x16x32_bf16 v[92:95], v[148:151], v[176:179], v[92:95]
v_mfma_f32_16x16x32_bf16 v[120:123], v[148:151], v[180:183], v[120:123]
s_waitcnt lgkmcnt(8)
v_mfma_f32_16x16x32_bf16 v[12:15], v[124:127], v[152:155], v[12:15]
ds_read_b64_tr_b16 v[148:149], v8 offset:24576
ds_read_b64_tr_b16 v[150:151], v8 offset:24832
v_mfma_f32_16x16x32_bf16 v[40:43], v[124:127], v[156:159], v[40:43]
ds_read_b128 v[168:171], v5 offset:0
ds_read_b128 v[172:175], v5 offset:2048
v_mfma_f32_16x16x32_bf16 v[68:71], v[124:127], v[160:163], v[68:71]
ds_read_b128 v[176:179], v5 offset:4096
v_mfma_f32_16x16x32_bf16 v[96:99], v[124:127], v[164:167], v[96:99]
ds_read_b128 v[180:183], v5 offset:6144
v_mfma_f32_16x16x32_bf16 v[100:103], v[128:131], v[164:167], v[100:103]
ds_read_b64_tr_b16 v[124:125], v6 offset:4096
v_mfma_f32_16x16x32_bf16 v[72:75], v[128:131], v[160:163], v[72:75]
ds_read_b64_tr_b16 v[126:127], v6 offset:4608
v_mfma_f32_16x16x32_bf16 v[44:47], v[128:131], v[156:159], v[44:47]
v_mfma_f32_16x16x32_bf16 v[16:19], v[128:131], v[152:155], v[16:19]
s_waitcnt lgkmcnt(8)
v_mfma_f32_16x16x32_bf16 v[20:23], v[132:135], v[152:155], v[20:23]
ds_read_b64_tr_b16 v[128:129], v7 offset:4096
v_mfma_f32_16x16x32_bf16 v[48:51], v[132:135], v[156:159], v[48:51]
ds_read_b64_tr_b16 v[130:131], v7 offset:4608
v_mfma_f32_16x16x32_bf16 v[76:79], v[132:135], v[160:163], v[76:79]
v_mfma_f32_16x16x32_bf16 v[104:107], v[132:135], v[164:167], v[104:107]
v_mfma_f32_16x16x32_bf16 v[108:111], v[136:139], v[164:167], v[108:111]
ds_read_b64_tr_b16 v[132:133], v6 offset:12288
v_mfma_f32_16x16x32_bf16 v[80:83], v[136:139], v[160:163], v[80:83]
ds_read_b64_tr_b16 v[134:135], v6 offset:12800
v_mfma_f32_16x16x32_bf16 v[52:55], v[136:139], v[156:159], v[52:55]
v_mfma_f32_16x16x32_bf16 v[24:27], v[136:139], v[152:155], v[24:27]
v_mfma_f32_16x16x32_bf16 v[28:31], v[140:143], v[152:155], v[28:31]
ds_read_b64_tr_b16 v[136:137], v7 offset:12288
v_mfma_f32_16x16x32_bf16 v[56:59], v[140:143], v[156:159], v[56:59]
ds_read_b64_tr_b16 v[138:139], v7 offset:12800
v_mfma_f32_16x16x32_bf16 v[84:87], v[140:143], v[160:163], v[84:87]
v_mfma_f32_16x16x32_bf16 v[112:115], v[140:143], v[164:167], v[112:115]
v_mfma_f32_16x16x32_bf16 v[116:119], v[144:147], v[164:167], v[116:119]
ds_read_b64_tr_b16 v[140:141], v6 offset:20480
v_mfma_f32_16x16x32_bf16 v[88:91], v[144:147], v[160:163], v[88:91]
ds_read_b64_tr_b16 v[142:143], v6 offset:20992
v_mfma_f32_16x16x32_bf16 v[60:63], v[144:147], v[156:159], v[60:63]
v_mfma_f32_16x16x32_bf16 v[32:35], v[144:147], v[152:155], v[32:35]
s_waitcnt lgkmcnt(8)
v_mfma_f32_16x16x32_bf16 v[36:39], v[148:151], v[152:155], v[36:39]
ds_read_b64_tr_b16 v[144:145], v7 offset:20480
v_mfma_f32_16x16x32_bf16 v[64:67], v[148:151], v[156:159], v[64:67]
ds_read_b64_tr_b16 v[146:147], v7 offset:20992
v_mfma_f32_16x16x32_bf16 v[92:95], v[148:151], v[160:163], v[92:95]
v_mfma_f32_16x16x32_bf16 v[120:123], v[148:151], v[164:167], v[120:123]
v_mfma_f32_16x16x32_bf16 v[12:15], v[124:127], v[168:171], v[12:15]
ds_read_b64_tr_b16 v[148:149], v8 offset:26624
v_mfma_f32_16x16x32_bf16 v[40:43], v[124:127], v[172:175], v[40:43]
ds_read_b64_tr_b16 v[150:151], v8 offset:26880
v_mfma_f32_16x16x32_bf16 v[68:71], v[124:127], v[176:179], v[68:71]
v_add_u32 v4, 0x16000, v4
v_add_u32 v5, 0x16000, v5
v_mfma_f32_16x16x32_bf16 v[96:99], v[124:127], v[180:183], v[96:99]
v_add_u32 v6, 0x16000, v6
v_add_u32 v7, 0x16000, v7
s_waitcnt lgkmcnt(8)
v_mfma_f32_16x16x32_bf16 v[100:103], v[128:131], v[180:183], v[100:103]
v_add_u32 v8, 0x16000, v8
v_mfma_f32_16x16x32_bf16 v[72:75], v[128:131], v[176:179], v[72:75]
v_mfma_f32_16x16x32_bf16 v[44:47], v[128:131], v[172:175], v[44:47]
v_mfma_f32_16x16x32_bf16 v[16:19], v[128:131], v[168:171], v[16:19]
s_waitcnt lgkmcnt(0)
s_barrier
v_mfma_f32_16x16x32_bf16 v[20:23], v[132:135], v[168:171], v[20:23]
ds_read_b128 v[152:155], v4 offset:0
ds_read_b128 v[156:159], v4 offset:2048
v_mfma_f32_16x16x32_bf16 v[48:51], v[132:135], v[172:175], v[48:51]
ds_read_b128 v[160:163], v4 offset:4096
ds_read_b128 v[164:167], v4 offset:6144
v_mfma_f32_16x16x32_bf16 v[76:79], v[132:135], v[176:179], v[76:79]
ds_read_b64_tr_b16 v[124:125], v6 offset:0
ds_read_b64_tr_b16 v[126:127], v6 offset:512
v_mfma_f32_16x16x32_bf16 v[104:107], v[132:135], v[180:183], v[104:107]
ds_read_b64_tr_b16 v[128:129], v7 offset:0
v_mfma_f32_16x16x32_bf16 v[108:111], v[136:139], v[180:183], v[108:111]
ds_read_b64_tr_b16 v[130:131], v7 offset:512
v_mfma_f32_16x16x32_bf16 v[80:83], v[136:139], v[176:179], v[80:83]
ds_read_b64_tr_b16 v[132:133], v6 offset:8192
v_mfma_f32_16x16x32_bf16 v[52:55], v[136:139], v[172:175], v[52:55]
ds_read_b64_tr_b16 v[134:135], v6 offset:8704
v_mfma_f32_16x16x32_bf16 v[24:27], v[136:139], v[168:171], v[24:27]
v_mfma_f32_16x16x32_bf16 v[28:31], v[140:143], v[168:171], v[28:31]
ds_read_b64_tr_b16 v[136:137], v7 offset:8192
v_mfma_f32_16x16x32_bf16 v[56:59], v[140:143], v[172:175], v[56:59]
ds_read_b64_tr_b16 v[138:139], v7 offset:8704
v_mfma_f32_16x16x32_bf16 v[84:87], v[140:143], v[176:179], v[84:87]
v_mfma_f32_16x16x32_bf16 v[112:115], v[140:143], v[180:183], v[112:115]
v_mfma_f32_16x16x32_bf16 v[116:119], v[144:147], v[180:183], v[116:119]
ds_read_b64_tr_b16 v[140:141], v6 offset:16384
v_mfma_f32_16x16x32_bf16 v[88:91], v[144:147], v[176:179], v[88:91]
ds_read_b64_tr_b16 v[142:143], v6 offset:16896
v_mfma_f32_16x16x32_bf16 v[60:63], v[144:147], v[172:175], v[60:63]
v_mfma_f32_16x16x32_bf16 v[32:35], v[144:147], v[168:171], v[32:35]
v_mfma_f32_16x16x32_bf16 v[36:39], v[148:151], v[168:171], v[36:39]
ds_read_b64_tr_b16 v[144:145], v7 offset:16384
v_mfma_f32_16x16x32_bf16 v[64:67], v[148:151], v[172:175], v[64:67]
ds_read_b64_tr_b16 v[146:147], v7 offset:16896
v_mfma_f32_16x16x32_bf16 v[92:95], v[148:151], v[176:179], v[92:95]
v_mfma_f32_16x16x32_bf16 v[120:123], v[148:151], v[180:183], v[120:123]
s_waitcnt lgkmcnt(8)
v_mfma_f32_16x16x32_bf16 v[12:15], v[124:127], v[152:155], v[12:15]
ds_read_b64_tr_b16 v[148:149], v8 offset:24576
ds_read_b64_tr_b16 v[150:151], v8 offset:24832
v_mfma_f32_16x16x32_bf16 v[40:43], v[124:127], v[156:159], v[40:43]
ds_read_b128 v[168:171], v5 offset:0
ds_read_b128 v[172:175], v5 offset:2048
v_mfma_f32_16x16x32_bf16 v[68:71], v[124:127], v[160:163], v[68:71]
ds_read_b128 v[176:179], v5 offset:4096
v_mfma_f32_16x16x32_bf16 v[96:99], v[124:127], v[164:167], v[96:99]
ds_read_b128 v[180:183], v5 offset:6144
v_mfma_f32_16x16x32_bf16 v[100:103], v[128:131], v[164:167], v[100:103]
ds_read_b64_tr_b16 v[124:125], v6 offset:4096
v_mfma_f32_16x16x32_bf16 v[72:75], v[128:131], v[160:163], v[72:75]
ds_read_b64_tr_b16 v[126:127], v6 offset:4608
v_mfma_f32_16x16x32_bf16 v[44:47], v[128:131], v[156:159], v[44:47]
v_mfma_f32_16x16x32_bf16 v[16:19], v[128:131], v[152:155], v[16:19]
s_waitcnt lgkmcnt(8)
v_mfma_f32_16x16x32_bf16 v[20:23], v[132:135], v[152:155], v[20:23]
ds_read_b64_tr_b16 v[128:129], v7 offset:4096
v_mfma_f32_16x16x32_bf16 v[48:51], v[132:135], v[156:159], v[48:51]
ds_read_b64_tr_b16 v[130:131], v7 offset:4608
v_mfma_f32_16x16x32_bf16 v[76:79], v[132:135], v[160:163], v[76:79]
v_mfma_f32_16x16x32_bf16 v[104:107], v[132:135], v[164:167], v[104:107]
v_mfma_f32_16x16x32_bf16 v[108:111], v[136:139], v[164:167], v[108:111]
ds_read_b64_tr_b16 v[132:133], v6 offset:12288
v_mfma_f32_16x16x32_bf16 v[80:83], v[136:139], v[160:163], v[80:83]
ds_read_b64_tr_b16 v[134:135], v6 offset:12800
v_mfma_f32_16x16x32_bf16 v[52:55], v[136:139], v[156:159], v[52:55]
v_mfma_f32_16x16x32_bf16 v[24:27], v[136:139], v[152:155], v[24:27]
v_mfma_f32_16x16x32_bf16 v[28:31], v[140:143], v[152:155], v[28:31]
ds_read_b64_tr_b16 v[136:137], v7 offset:12288
v_mfma_f32_16x16x32_bf16 v[56:59], v[140:143], v[156:159], v[56:59]
ds_read_b64_tr_b16 v[138:139], v7 offset:12800
v_mfma_f32_16x16x32_bf16 v[84:87], v[140:143], v[160:163], v[84:87]
v_mfma_f32_16x16x32_bf16 v[112:115], v[140:143], v[164:167], v[112:115]
v_mfma_f32_16x16x32_bf16 v[116:119], v[144:147], v[164:167], v[116:119]
ds_read_b64_tr_b16 v[140:141], v6 offset:20480
v_mfma_f32_16x16x32_bf16 v[88:91], v[144:147], v[160:163], v[88:91]
ds_read_b64_tr_b16 v[142:143], v6 offset:20992
v_mfma_f32_16x16x32_bf16 v[60:63], v[144:147], v[156:159], v[60:63]
v_mfma_f32_16x16x32_bf16 v[32:35], v[144:147], v[152:155], v[32:35]
s_waitcnt lgkmcnt(8)
v_mfma_f32_16x16x32_bf16 v[36:39], v[148:151], v[152:155], v[36:39]
ds_read_b64_tr_b16 v[144:145], v7 offset:20480
v_mfma_f32_16x16x32_bf16 v[64:67], v[148:151], v[156:159], v[64:67]
ds_read_b64_tr_b16 v[146:147], v7 offset:20992
v_mfma_f32_16x16x32_bf16 v[92:95], v[148:151], v[160:163], v[92:95]
v_mfma_f32_16x16x32_bf16 v[120:123], v[148:151], v[164:167], v[120:123]
v_mfma_f32_16x16x32_bf16 v[12:15], v[124:127], v[168:171], v[12:15]
ds_read_b64_tr_b16 v[148:149], v8 offset:26624
v_mfma_f32_16x16x32_bf16 v[40:43], v[124:127], v[172:175], v[40:43]
ds_read_b64_tr_b16 v[150:151], v8 offset:26880
v_mfma_f32_16x16x32_bf16 v[68:71], v[124:127], v[176:179], v[68:71]
v_add_u32 v4, 0xffff5000, v4
v_add_u32 v5, 0xffff5000, v5
v_mfma_f32_16x16x32_bf16 v[96:99], v[124:127], v[180:183], v[96:99]
v_add_u32 v6, 0xffff5000, v6
v_add_u32 v7, 0xffff5000, v7
s_waitcnt lgkmcnt(8)
v_mfma_f32_16x16x32_bf16 v[100:103], v[128:131], v[180:183], v[100:103]
v_add_u32 v8, 0xffff5000, v8
v_mfma_f32_16x16x32_bf16 v[72:75], v[128:131], v[176:179], v[72:75]
v_mfma_f32_16x16x32_bf16 v[44:47], v[128:131], v[172:175], v[44:47]
v_mfma_f32_16x16x32_bf16 v[16:19], v[128:131], v[168:171], v[16:19]
s_waitcnt lgkmcnt(0)
s_barrier
v_mfma_f32_16x16x32_bf16 v[20:23], v[132:135], v[168:171], v[20:23]
ds_read_b128 v[152:155], v4 offset:0
ds_read_b128 v[156:159], v4 offset:2048
v_mfma_f32_16x16x32_bf16 v[48:51], v[132:135], v[172:175], v[48:51]
ds_read_b128 v[160:163], v4 offset:4096
ds_read_b128 v[164:167], v4 offset:6144
v_mfma_f32_16x16x32_bf16 v[76:79], v[132:135], v[176:179], v[76:79]
ds_read_b64_tr_b16 v[124:125], v6 offset:0
ds_read_b64_tr_b16 v[126:127], v6 offset:512
v_mfma_f32_16x16x32_bf16 v[104:107], v[132:135], v[180:183], v[104:107]
ds_read_b64_tr_b16 v[128:129], v7 offset:0
v_mfma_f32_16x16x32_bf16 v[108:111], v[136:139], v[180:183], v[108:111]
ds_read_b64_tr_b16 v[130:131], v7 offset:512
v_mfma_f32_16x16x32_bf16 v[80:83], v[136:139], v[176:179], v[80:83]
ds_read_b64_tr_b16 v[132:133], v6 offset:8192
v_mfma_f32_16x16x32_bf16 v[52:55], v[136:139], v[172:175], v[52:55]
ds_read_b64_tr_b16 v[134:135], v6 offset:8704
v_mfma_f32_16x16x32_bf16 v[24:27], v[136:139], v[168:171], v[24:27]
v_mfma_f32_16x16x32_bf16 v[28:31], v[140:143], v[168:171], v[28:31]
ds_read_b64_tr_b16 v[136:137], v7 offset:8192
v_mfma_f32_16x16x32_bf16 v[56:59], v[140:143], v[172:175], v[56:59]
ds_read_b64_tr_b16 v[138:139], v7 offset:8704
v_mfma_f32_16x16x32_bf16 v[84:87], v[140:143], v[176:179], v[84:87]
v_mfma_f32_16x16x32_bf16 v[112:115], v[140:143], v[180:183], v[112:115]
v_mfma_f32_16x16x32_bf16 v[116:119], v[144:147], v[180:183], v[116:119]
ds_read_b64_tr_b16 v[140:141], v6 offset:16384
v_mfma_f32_16x16x32_bf16 v[88:91], v[144:147], v[176:179], v[88:91]
ds_read_b64_tr_b16 v[142:143], v6 offset:16896
v_mfma_f32_16x16x32_bf16 v[60:63], v[144:147], v[172:175], v[60:63]
v_mfma_f32_16x16x32_bf16 v[32:35], v[144:147], v[168:171], v[32:35]
v_mfma_f32_16x16x32_bf16 v[36:39], v[148:151], v[168:171], v[36:39]
ds_read_b64_tr_b16 v[144:145], v7 offset:16384
v_mfma_f32_16x16x32_bf16 v[64:67], v[148:151], v[172:175], v[64:67]
ds_read_b64_tr_b16 v[146:147], v7 offset:16896
v_mfma_f32_16x16x32_bf16 v[92:95], v[148:151], v[176:179], v[92:95]
v_mfma_f32_16x16x32_bf16 v[120:123], v[148:151], v[180:183], v[120:123]
s_waitcnt lgkmcnt(8)
v_mfma_f32_16x16x32_bf16 v[12:15], v[124:127], v[152:155], v[12:15]
ds_read_b64_tr_b16 v[148:149], v8 offset:24576
ds_read_b64_tr_b16 v[150:151], v8 offset:24832
v_mfma_f32_16x16x32_bf16 v[40:43], v[124:127], v[156:159], v[40:43]
ds_read_b128 v[168:171], v5 offset:0
ds_read_b128 v[172:175], v5 offset:2048
v_mfma_f32_16x16x32_bf16 v[68:71], v[124:127], v[160:163], v[68:71]
ds_read_b128 v[176:179], v5 offset:4096
v_mfma_f32_16x16x32_bf16 v[96:99], v[124:127], v[164:167], v[96:99]
ds_read_b128 v[180:183], v5 offset:6144
v_mfma_f32_16x16x32_bf16 v[100:103], v[128:131], v[164:167], v[100:103]
ds_read_b64_tr_b16 v[124:125], v6 offset:4096
v_mfma_f32_16x16x32_bf16 v[72:75], v[128:131], v[160:163], v[72:75]
ds_read_b64_tr_b16 v[126:127], v6 offset:4608
v_mfma_f32_16x16x32_bf16 v[44:47], v[128:131], v[156:159], v[44:47]
v_mfma_f32_16x16x32_bf16 v[16:19], v[128:131], v[152:155], v[16:19]
s_waitcnt lgkmcnt(8)
v_mfma_f32_16x16x32_bf16 v[20:23], v[132:135], v[152:155], v[20:23]
ds_read_b64_tr_b16 v[128:129], v7 offset:4096
v_mfma_f32_16x16x32_bf16 v[48:51], v[132:135], v[156:159], v[48:51]
ds_read_b64_tr_b16 v[130:131], v7 offset:4608
v_mfma_f32_16x16x32_bf16 v[76:79], v[132:135], v[160:163], v[76:79]
v_mfma_f32_16x16x32_bf16 v[104:107], v[132:135], v[164:167], v[104:107]
v_mfma_f32_16x16x32_bf16 v[108:111], v[136:139], v[164:167], v[108:111]
ds_read_b64_tr_b16 v[132:133], v6 offset:12288
v_mfma_f32_16x16x32_bf16 v[80:83], v[136:139], v[160:163], v[80:83]
ds_read_b64_tr_b16 v[134:135], v6 offset:12800
v_mfma_f32_16x16x32_bf16 v[52:55], v[136:139], v[156:159], v[52:55]
v_mfma_f32_16x16x32_bf16 v[24:27], v[136:139], v[152:155], v[24:27]
v_mfma_f32_16x16x32_bf16 v[28:31], v[140:143], v[152:155], v[28:31]
ds_read_b64_tr_b16 v[136:137], v7 offset:12288
v_mfma_f32_16x16x32_bf16 v[56:59], v[140:143], v[156:159], v[56:59]
ds_read_b64_tr_b16 v[138:139], v7 offset:12800
v_mfma_f32_16x16x32_bf16 v[84:87], v[140:143], v[160:163], v[84:87]
v_mfma_f32_16x16x32_bf16 v[112:115], v[140:143], v[164:167], v[112:115]
v_mfma_f32_16x16x32_bf16 v[116:119], v[144:147], v[164:167], v[116:119]
ds_read_b64_tr_b16 v[140:141], v6 offset:20480
v_mfma_f32_16x16x32_bf16 v[88:91], v[144:147], v[160:163], v[88:91]
ds_read_b64_tr_b16 v[142:143], v6 offset:20992
v_mfma_f32_16x16x32_bf16 v[60:63], v[144:147], v[156:159], v[60:63]
v_mfma_f32_16x16x32_bf16 v[32:35], v[144:147], v[152:155], v[32:35]
s_waitcnt lgkmcnt(8)
v_mfma_f32_16x16x32_bf16 v[36:39], v[148:151], v[152:155], v[36:39]
ds_read_b64_tr_b16 v[144:145], v7 offset:20480
v_mfma_f32_16x16x32_bf16 v[64:67], v[148:151], v[156:159], v[64:67]
ds_read_b64_tr_b16 v[146:147], v7 offset:20992
v_mfma_f32_16x16x32_bf16 v[92:95], v[148:151], v[160:163], v[92:95]
v_mfma_f32_16x16x32_bf16 v[120:123], v[148:151], v[164:167], v[120:123]
v_mfma_f32_16x16x32_bf16 v[12:15], v[124:127], v[168:171], v[12:15]
ds_read_b64_tr_b16 v[148:149], v8 offset:26624
v_mfma_f32_16x16x32_bf16 v[40:43], v[124:127], v[172:175], v[40:43]
ds_read_b64_tr_b16 v[150:151], v8 offset:26880
v_mfma_f32_16x16x32_bf16 v[68:71], v[124:127], v[176:179], v[68:71]
v_and_b32 v184, 0xf0, v3
v_bfe_u32 v152, v1, 4, 1
v_mfma_f32_16x16x32_bf16 v[96:99], v[124:127], v[180:183], v[96:99]
v_lshl_add_u32 v184, v152, 10, v184
v_lshrrev_b32 v152, 5, v1
s_waitcnt lgkmcnt(8)
v_mfma_f32_16x16x32_bf16 v[100:103], v[128:131], v[180:183], v[100:103]
v_lshl_add_u32 v184, v152, 8, v184
v_mfma_f32_16x16x32_bf16 v[72:75], v[128:131], v[176:179], v[72:75]
v_mfma_f32_16x16x32_bf16 v[44:47], v[128:131], v[172:175], v[44:47]
v_mfma_f32_16x16x32_bf16 v[16:19], v[128:131], v[168:171], v[16:19]
s_waitcnt lgkmcnt(0)
s_barrier
v_mfma_f32_16x16x32_bf16 v[20:23], v[132:135], v[168:171], v[20:23]
ds_read2_b32 v[186:187], v9 offset0:0 offset1:0
ds_read2_b32 v[194:195], v9 offset0:128 offset1:128
v_mfma_f32_16x16x32_bf16 v[48:51], v[132:135], v[172:175], v[48:51]
ds_read2_b32 v[188:189], v9 offset0:16 offset1:16
ds_read2_b32 v[196:197], v9 offset0:144 offset1:144
v_mfma_f32_16x16x32_bf16 v[76:79], v[132:135], v[176:179], v[76:79]
ds_read2_b32 v[190:191], v9 offset0:32 offset1:32
ds_read2_b32 v[198:199], v9 offset0:160 offset1:160
v_mfma_f32_16x16x32_bf16 v[104:107], v[132:135], v[180:183], v[104:107]
ds_read2_b32 v[192:193], v9 offset0:48 offset1:48
ds_read2_b32 v[200:201], v9 offset0:176 offset1:176
v_mfma_f32_16x16x32_bf16 v[108:111], v[136:139], v[180:183], v[108:111]
ds_read_b128 v[124:127], v10 offset:0
v_mfma_f32_16x16x32_bf16 v[80:83], v[136:139], v[176:179], v[80:83]
ds_read_b128 v[128:131], v10 offset:64
v_mfma_f32_16x16x32_bf16 v[52:55], v[136:139], v[172:175], v[52:55]
ds_read_b128 v[132:135], v10 offset:256
v_mfma_f32_16x16x32_bf16 v[24:27], v[136:139], v[168:171], v[24:27]
v_mfma_f32_16x16x32_bf16 v[28:31], v[140:143], v[168:171], v[28:31]
ds_read_b128 v[136:139], v10 offset:320
v_mfma_f32_16x16x32_bf16 v[56:59], v[140:143], v[172:175], v[56:59]
v_mfma_f32_16x16x32_bf16 v[84:87], v[140:143], v[176:179], v[84:87]
v_mfma_f32_16x16x32_bf16 v[112:115], v[140:143], v[180:183], v[112:115]
v_mfma_f32_16x16x32_bf16 v[116:119], v[144:147], v[180:183], v[116:119]
ds_read_b128 v[140:143], v10 offset:512
v_mfma_f32_16x16x32_bf16 v[88:91], v[144:147], v[176:179], v[88:91]
v_mfma_f32_16x16x32_bf16 v[60:63], v[144:147], v[172:175], v[60:63]
v_mfma_f32_16x16x32_bf16 v[32:35], v[144:147], v[168:171], v[32:35]
v_mfma_f32_16x16x32_bf16 v[36:39], v[148:151], v[168:171], v[36:39]
ds_read_b128 v[144:147], v10 offset:576
v_mfma_f32_16x16x32_bf16 v[64:67], v[148:151], v[172:175], v[64:67]
v_mfma_f32_16x16x32_bf16 v[92:95], v[148:151], v[176:179], v[92:95]
v_mfma_f32_16x16x32_bf16 v[120:123], v[148:151], v[180:183], v[120:123]
ds_read_b128 v[148:151], v11 offset:768
s_add_u32 s67, s98, 8192
s_add_u32 s68, s98, 16384
s_waitcnt lgkmcnt(0)
s_nop 0
v_pk_fma_f32 v[12:13], v[124:125], v[186:187], v[12:13]
v_pk_fma_f32 v[14:15], v[126:127], v[186:187], v[14:15]
v_pk_fma_f32 v[16:17], v[128:129], v[186:187], v[16:17]
v_pk_fma_f32 v[18:19], v[130:131], v[186:187], v[18:19]
v_pk_mul_f32 v[12:13], v[12:13], v[194:195]
v_pk_mul_f32 v[14:15], v[14:15], v[194:195]
v_pk_mul_f32 v[16:17], v[16:17], v[194:195]
v_pk_mul_f32 v[18:19], v[18:19], v[194:195]
v_exp_f32 v204, v12
v_exp_f32 v205, v13
v_exp_f32 v206, v14
v_exp_f32 v207, v15
v_exp_f32 v208, v16
v_exp_f32 v209, v17
v_exp_f32 v210, v18
v_exp_f32 v211, v19
v_pk_add_f32 v[204:205], v[204:205], v[202:203]
v_pk_add_f32 v[206:207], v[206:207], v[202:203]
v_pk_add_f32 v[208:209], v[208:209], v[202:203]
v_pk_add_f32 v[210:211], v[210:211], v[202:203]
v_rcp_f32 v204, v204
v_rcp_f32 v205, v205
v_rcp_f32 v206, v206
v_rcp_f32 v207, v207
v_rcp_f32 v208, v208
v_rcp_f32 v209, v209
v_rcp_f32 v210, v210
v_rcp_f32 v211, v211
v_pk_mul_f32 v[204:205], v[12:13], v[204:205]
v_pk_mul_f32 v[206:207], v[14:15], v[206:207]
v_pk_mul_f32 v[208:209], v[16:17], v[208:209]
v_pk_mul_f32 v[210:211], v[18:19], v[210:211]
v_cvt_pk_bf16_f32 v4, v204, v205
v_cvt_pk_bf16_f32 v5, v206, v207
v_cvt_pk_bf16_f32 v6, v208, v209
v_cvt_pk_bf16_f32 v7, v210, v211
buffer_store_dwordx4 v[4:7], v3, s[16:19], s98 offen offset:0 sc1
v_pk_fma_f32 v[40:41], v[124:125], v[188:189], v[40:41]
v_pk_fma_f32 v[42:43], v[126:127], v[188:189], v[42:43]
v_pk_fma_f32 v[44:45], v[128:129], v[188:189], v[44:45]
v_pk_fma_f32 v[46:47], v[130:131], v[188:189], v[46:47]
v_pk_mul_f32 v[40:41], v[40:41], v[196:197]
v_pk_mul_f32 v[42:43], v[42:43], v[196:197]
v_pk_mul_f32 v[44:45], v[44:45], v[196:197]
v_pk_mul_f32 v[46:47], v[46:47], v[196:197]
v_exp_f32 v212, v40
v_exp_f32 v213, v41
v_exp_f32 v214, v42
v_exp_f32 v215, v43
v_exp_f32 v216, v44
v_exp_f32 v217, v45
v_exp_f32 v218, v46
v_exp_f32 v219, v47
v_pk_add_f32 v[212:213], v[212:213], v[202:203]
v_pk_add_f32 v[214:215], v[214:215], v[202:203]
v_pk_add_f32 v[216:217], v[216:217], v[202:203]
v_pk_add_f32 v[218:219], v[218:219], v[202:203]
v_rcp_f32 v212, v212
v_rcp_f32 v213, v213
v_rcp_f32 v214, v214
v_rcp_f32 v215, v215
v_rcp_f32 v216, v216
v_rcp_f32 v217, v217
v_rcp_f32 v218, v218
v_rcp_f32 v219, v219
v_pk_mul_f32 v[212:213], v[40:41], v[212:213]
v_pk_mul_f32 v[214:215], v[42:43], v[214:215]
v_pk_mul_f32 v[216:217], v[44:45], v[216:217]
v_pk_mul_f32 v[218:219], v[46:47], v[218:219]
v_cvt_pk_bf16_f32 v228, v212, v213
v_cvt_pk_bf16_f32 v229, v214, v215
v_cvt_pk_bf16_f32 v230, v216, v217
v_cvt_pk_bf16_f32 v231, v218, v219
buffer_store_dwordx4 v[228:231], v3, s[16:19], s98 offen offset:1024 sc1
v_pk_fma_f32 v[68:69], v[124:125], v[190:191], v[68:69]
v_pk_fma_f32 v[70:71], v[126:127], v[190:191], v[70:71]
v_pk_fma_f32 v[72:73], v[128:129], v[190:191], v[72:73]
v_pk_fma_f32 v[74:75], v[130:131], v[190:191], v[74:75]
v_pk_mul_f32 v[68:69], v[68:69], v[198:199]
v_pk_mul_f32 v[70:71], v[70:71], v[198:199]
v_pk_mul_f32 v[72:73], v[72:73], v[198:199]
v_pk_mul_f32 v[74:75], v[74:75], v[198:199]
v_exp_f32 v220, v68
v_exp_f32 v221, v69
v_exp_f32 v222, v70
v_exp_f32 v223, v71
v_exp_f32 v224, v72
v_exp_f32 v225, v73
v_exp_f32 v226, v74
v_exp_f32 v227, v75
v_pk_add_f32 v[220:221], v[220:221], v[202:203]
v_pk_add_f32 v[222:223], v[222:223], v[202:203]
v_pk_add_f32 v[224:225], v[224:225], v[202:203]
v_pk_add_f32 v[226:227], v[226:227], v[202:203]
v_rcp_f32 v220, v220
v_rcp_f32 v221, v221
v_rcp_f32 v222, v222
v_rcp_f32 v223, v223
v_rcp_f32 v224, v224
v_rcp_f32 v225, v225
v_rcp_f32 v226, v226
v_rcp_f32 v227, v227
v_pk_mul_f32 v[220:221], v[68:69], v[220:221]
v_pk_mul_f32 v[222:223], v[70:71], v[222:223]
v_pk_mul_f32 v[224:225], v[72:73], v[224:225]
v_pk_mul_f32 v[226:227], v[74:75], v[226:227]
v_cvt_pk_bf16_f32 v232, v220, v221
v_cvt_pk_bf16_f32 v233, v222, v223
v_cvt_pk_bf16_f32 v234, v224, v225
v_cvt_pk_bf16_f32 v235, v226, v227
buffer_store_dwordx4 v[232:235], v3, s[16:19], s98 offen offset:2048 sc1
v_pk_fma_f32 v[96:97], v[124:125], v[192:193], v[96:97]
v_pk_fma_f32 v[98:99], v[126:127], v[192:193], v[98:99]
v_pk_fma_f32 v[100:101], v[128:129], v[192:193], v[100:101]
v_pk_fma_f32 v[102:103], v[130:131], v[192:193], v[102:103]
v_pk_mul_f32 v[96:97], v[96:97], v[200:201]
v_pk_mul_f32 v[98:99], v[98:99], v[200:201]
v_pk_mul_f32 v[100:101], v[100:101], v[200:201]
v_pk_mul_f32 v[102:103], v[102:103], v[200:201]
v_exp_f32 v204, v96
v_exp_f32 v205, v97
v_exp_f32 v206, v98
v_exp_f32 v207, v99
v_exp_f32 v208, v100
v_exp_f32 v209, v101
v_exp_f32 v210, v102
v_exp_f32 v211, v103
v_pk_add_f32 v[204:205], v[204:205], v[202:203]
v_pk_add_f32 v[206:207], v[206:207], v[202:203]
v_pk_add_f32 v[208:209], v[208:209], v[202:203]
v_pk_add_f32 v[210:211], v[210:211], v[202:203]
v_rcp_f32 v204, v204
v_rcp_f32 v205, v205
v_rcp_f32 v206, v206
v_rcp_f32 v207, v207
v_rcp_f32 v208, v208
v_rcp_f32 v209, v209
v_rcp_f32 v210, v210
v_rcp_f32 v211, v211
v_pk_mul_f32 v[204:205], v[96:97], v[204:205]
v_pk_mul_f32 v[206:207], v[98:99], v[206:207]
v_pk_mul_f32 v[208:209], v[100:101], v[208:209]
v_pk_mul_f32 v[210:211], v[102:103], v[210:211]
v_cvt_pk_bf16_f32 v4, v204, v205
v_cvt_pk_bf16_f32 v5, v206, v207
v_cvt_pk_bf16_f32 v6, v208, v209
v_cvt_pk_bf16_f32 v7, v210, v211
buffer_store_dwordx4 v[4:7], v3, s[16:19], s98 offen offset:3072 sc1
v_pk_fma_f32 v[20:21], v[132:133], v[186:187], v[20:21]
v_pk_fma_f32 v[22:23], v[134:135], v[186:187], v[22:23]
v_pk_fma_f32 v[24:25], v[136:137], v[186:187], v[24:25]
v_pk_fma_f32 v[26:27], v[138:139], v[186:187], v[26:27]
v_pk_mul_f32 v[20:21], v[20:21], v[194:195]
v_pk_mul_f32 v[22:23], v[22:23], v[194:195]
v_pk_mul_f32 v[24:25], v[24:25], v[194:195]
v_pk_mul_f32 v[26:27], v[26:27], v[194:195]
v_exp_f32 v212, v20
v_exp_f32 v213, v21
v_exp_f32 v214, v22
v_exp_f32 v215, v23
v_exp_f32 v216, v24
v_exp_f32 v217, v25
v_exp_f32 v218, v26
v_exp_f32 v219, v27
v_pk_add_f32 v[212:213], v[212:213], v[202:203]
v_pk_add_f32 v[214:215], v[214:215], v[202:203]
v_pk_add_f32 v[216:217], v[216:217], v[202:203]
v_pk_add_f32 v[218:219], v[218:219], v[202:203]
v_rcp_f32 v212, v212
v_rcp_f32 v213, v213
v_rcp_f32 v214, v214
v_rcp_f32 v215, v215
v_rcp_f32 v216, v216
v_rcp_f32 v217, v217
v_rcp_f32 v218, v218
v_rcp_f32 v219, v219
v_pk_mul_f32 v[212:213], v[20:21], v[212:213]
v_pk_mul_f32 v[214:215], v[22:23], v[214:215]
v_pk_mul_f32 v[216:217], v[24:25], v[216:217]
v_pk_mul_f32 v[218:219], v[26:27], v[218:219]
v_cvt_pk_bf16_f32 v228, v212, v213
v_cvt_pk_bf16_f32 v229, v214, v215
v_cvt_pk_bf16_f32 v230, v216, v217
v_cvt_pk_bf16_f32 v231, v218, v219
buffer_store_dwordx4 v[228:231], v3, s[16:19], s67 offen offset:0 sc1
v_pk_fma_f32 v[48:49], v[132:133], v[188:189], v[48:49]
v_pk_fma_f32 v[50:51], v[134:135], v[188:189], v[50:51]
v_pk_fma_f32 v[52:53], v[136:137], v[188:189], v[52:53]
v_pk_fma_f32 v[54:55], v[138:139], v[188:189], v[54:55]
v_pk_mul_f32 v[48:49], v[48:49], v[196:197]
v_pk_mul_f32 v[50:51], v[50:51], v[196:197]
v_pk_mul_f32 v[52:53], v[52:53], v[196:197]
v_pk_mul_f32 v[54:55], v[54:55], v[196:197]
v_exp_f32 v220, v48
v_exp_f32 v221, v49
v_exp_f32 v222, v50
v_exp_f32 v223, v51
v_exp_f32 v224, v52
v_exp_f32 v225, v53
v_exp_f32 v226, v54
v_exp_f32 v227, v55
v_pk_add_f32 v[220:221], v[220:221], v[202:203]
v_pk_add_f32 v[222:223], v[222:223], v[202:203]
v_pk_add_f32 v[224:225], v[224:225], v[202:203]
v_pk_add_f32 v[226:227], v[226:227], v[202:203]
v_rcp_f32 v220, v220
v_rcp_f32 v221, v221
v_rcp_f32 v222, v222
v_rcp_f32 v223, v223
v_rcp_f32 v224, v224
v_rcp_f32 v225, v225
v_rcp_f32 v226, v226
v_rcp_f32 v227, v227
v_pk_mul_f32 v[220:221], v[48:49], v[220:221]
v_pk_mul_f32 v[222:223], v[50:51], v[222:223]
v_pk_mul_f32 v[224:225], v[52:53], v[224:225]
v_pk_mul_f32 v[226:227], v[54:55], v[226:227]
v_cvt_pk_bf16_f32 v232, v220, v221
v_cvt_pk_bf16_f32 v233, v222, v223
v_cvt_pk_bf16_f32 v234, v224, v225
v_cvt_pk_bf16_f32 v235, v226, v227
buffer_store_dwordx4 v[232:235], v3, s[16:19], s67 offen offset:1024 sc1
v_pk_fma_f32 v[76:77], v[132:133], v[190:191], v[76:77]
v_pk_fma_f32 v[78:79], v[134:135], v[190:191], v[78:79]
v_pk_fma_f32 v[80:81], v[136:137], v[190:191], v[80:81]
v_pk_fma_f32 v[82:83], v[138:139], v[190:191], v[82:83]
v_pk_mul_f32 v[76:77], v[76:77], v[198:199]
v_pk_mul_f32 v[78:79], v[78:79], v[198:199]
v_pk_mul_f32 v[80:81], v[80:81], v[198:199]
v_pk_mul_f32 v[82:83], v[82:83], v[198:199]
v_exp_f32 v204, v76
v_exp_f32 v205, v77
v_exp_f32 v206, v78
v_exp_f32 v207, v79
v_exp_f32 v208, v80
v_exp_f32 v209, v81
v_exp_f32 v210, v82
v_exp_f32 v211, v83
v_pk_add_f32 v[204:205], v[204:205], v[202:203]
WS_F1:
WS_5011:
s_cbranch_execz WR_F
s_nop 0
v_pk_add_f32 v[206:207], v[206:207], v[202:203]
v_pk_add_f32 v[208:209], v[208:209], v[202:203]
v_pk_add_f32 v[210:211], v[210:211], v[202:203]
v_rcp_f32 v204, v204
v_rcp_f32 v205, v205
v_rcp_f32 v206, v206
v_rcp_f32 v207, v207
v_rcp_f32 v208, v208
v_rcp_f32 v209, v209
v_rcp_f32 v210, v210
v_rcp_f32 v211, v211
v_pk_mul_f32 v[204:205], v[76:77], v[204:205]
v_pk_mul_f32 v[206:207], v[78:79], v[206:207]
v_pk_mul_f32 v[208:209], v[80:81], v[208:209]
v_pk_mul_f32 v[210:211], v[82:83], v[210:211]
v_cvt_pk_bf16_f32 v4, v204, v205
v_cvt_pk_bf16_f32 v5, v206, v207
v_cvt_pk_bf16_f32 v6, v208, v209
v_cvt_pk_bf16_f32 v7, v210, v211
buffer_store_dwordx4 v[4:7], v3, s[16:19], s67 offen offset:2048 sc1
s_waitcnt vmcnt(3)
s_nop 0
s_atomic_add s60, s[16:17], s100 offset:0
v_pk_fma_f32 v[104:105], v[132:133], v[192:193], v[104:105]
v_pk_fma_f32 v[106:107], v[134:135], v[192:193], v[106:107]
v_pk_fma_f32 v[108:109], v[136:137], v[192:193], v[108:109]
v_pk_fma_f32 v[110:111], v[138:139], v[192:193], v[110:111]
v_pk_mul_f32 v[104:105], v[104:105], v[200:201]
v_pk_mul_f32 v[106:107], v[106:107], v[200:201]
v_pk_mul_f32 v[108:109], v[108:109], v[200:201]
v_pk_mul_f32 v[110:111], v[110:111], v[200:201]
v_exp_f32 v212, v104
v_exp_f32 v213, v105
v_exp_f32 v214, v106
v_exp_f32 v215, v107
v_exp_f32 v216, v108
v_exp_f32 v217, v109
v_exp_f32 v218, v110
v_exp_f32 v219, v111
v_pk_add_f32 v[212:213], v[212:213], v[202:203]
v_pk_add_f32 v[214:215], v[214:215], v[202:203]
v_pk_add_f32 v[216:217], v[216:217], v[202:203]
v_pk_add_f32 v[218:219], v[218:219], v[202:203]
v_rcp_f32 v212, v212
v_rcp_f32 v213, v213
v_rcp_f32 v214, v214
v_rcp_f32 v215, v215
v_rcp_f32 v216, v216
v_rcp_f32 v217, v217
v_rcp_f32 v218, v218
v_rcp_f32 v219, v219
v_pk_mul_f32 v[212:213], v[104:105], v[212:213]
v_pk_mul_f32 v[214:215], v[106:107], v[214:215]
v_pk_mul_f32 v[216:217], v[108:109], v[216:217]
v_pk_mul_f32 v[218:219], v[110:111], v[218:219]
v_cvt_pk_bf16_f32 v228, v212, v213
v_cvt_pk_bf16_f32 v229, v214, v215
v_cvt_pk_bf16_f32 v230, v216, v217
v_cvt_pk_bf16_f32 v231, v218, v219
buffer_store_dwordx4 v[228:231], v3, s[16:19], s67 offen offset:3072 sc1
v_pk_fma_f32 v[28:29], v[140:141], v[186:187], v[28:29]
v_pk_fma_f32 v[30:31], v[142:143], v[186:187], v[30:31]
v_pk_fma_f32 v[32:33], v[144:145], v[186:187], v[32:33]
v_pk_fma_f32 v[34:35], v[146:147], v[186:187], v[34:35]
v_pk_mul_f32 v[28:29], v[28:29], v[194:195]
v_pk_mul_f32 v[30:31], v[30:31], v[194:195]
v_pk_mul_f32 v[32:33], v[32:33], v[194:195]
v_pk_mul_f32 v[34:35], v[34:35], v[194:195]
v_exp_f32 v220, v28
v_exp_f32 v221, v29
v_exp_f32 v222, v30
v_exp_f32 v223, v31
v_exp_f32 v224, v32
v_exp_f32 v225, v33
v_exp_f32 v226, v34
v_exp_f32 v227, v35
v_pk_add_f32 v[220:221], v[220:221], v[202:203]
v_pk_add_f32 v[222:223], v[222:223], v[202:203]
v_pk_add_f32 v[224:225], v[224:225], v[202:203]
v_pk_add_f32 v[226:227], v[226:227], v[202:203]
v_rcp_f32 v220, v220
v_rcp_f32 v221, v221
v_rcp_f32 v222, v222
v_rcp_f32 v223, v223
v_rcp_f32 v224, v224
v_rcp_f32 v225, v225
v_rcp_f32 v226, v226
v_rcp_f32 v227, v227
v_pk_mul_f32 v[220:221], v[28:29], v[220:221]
v_pk_mul_f32 v[222:223], v[30:31], v[222:223]
v_pk_mul_f32 v[224:225], v[32:33], v[224:225]
v_pk_mul_f32 v[226:227], v[34:35], v[226:227]
v_cvt_pk_bf16_f32 v232, v220, v221
v_cvt_pk_bf16_f32 v233, v222, v223
v_cvt_pk_bf16_f32 v234, v224, v225
v_cvt_pk_bf16_f32 v235, v226, v227
buffer_store_dwordx4 v[232:235], v3, s[16:19], s68 offen offset:0 sc1
v_pk_fma_f32 v[56:57], v[140:141], v[188:189], v[56:57]
v_pk_fma_f32 v[58:59], v[142:143], v[188:189], v[58:59]
v_pk_fma_f32 v[60:61], v[144:145], v[188:189], v[60:61]
v_pk_fma_f32 v[62:63], v[146:147], v[188:189], v[62:63]
v_pk_mul_f32 v[56:57], v[56:57], v[196:197]
v_pk_mul_f32 v[58:59], v[58:59], v[196:197]
v_pk_mul_f32 v[60:61], v[60:61], v[196:197]
v_pk_mul_f32 v[62:63], v[62:63], v[196:197]
v_exp_f32 v204, v56
v_exp_f32 v205, v57
v_exp_f32 v206, v58
v_exp_f32 v207, v59
v_exp_f32 v208, v60
v_exp_f32 v209, v61
v_exp_f32 v210, v62
v_exp_f32 v211, v63
v_pk_add_f32 v[204:205], v[204:205], v[202:203]
v_pk_add_f32 v[206:207], v[206:207], v[202:203]
v_pk_add_f32 v[208:209], v[208:209], v[202:203]
v_pk_add_f32 v[210:211], v[210:211], v[202:203]
v_rcp_f32 v204, v204
v_rcp_f32 v205, v205
v_rcp_f32 v206, v206
v_rcp_f32 v207, v207
v_rcp_f32 v208, v208
v_rcp_f32 v209, v209
v_rcp_f32 v210, v210
v_rcp_f32 v211, v211
v_pk_mul_f32 v[204:205], v[56:57], v[204:205]
v_pk_mul_f32 v[206:207], v[58:59], v[206:207]
v_pk_mul_f32 v[208:209], v[60:61], v[208:209]
v_pk_mul_f32 v[210:211], v[62:63], v[210:211]
v_cvt_pk_bf16_f32 v4, v204, v205
v_cvt_pk_bf16_f32 v5, v206, v207
v_cvt_pk_bf16_f32 v6, v208, v209
v_cvt_pk_bf16_f32 v7, v210, v211
buffer_store_dwordx4 v[4:7], v3, s[16:19], s68 offen offset:1024 sc1
v_pk_fma_f32 v[84:85], v[140:141], v[190:191], v[84:85]
v_pk_fma_f32 v[86:87], v[142:143], v[190:191], v[86:87]
v_pk_fma_f32 v[88:89], v[144:145], v[190:191], v[88:89]
v_pk_fma_f32 v[90:91], v[146:147], v[190:191], v[90:91]
v_pk_mul_f32 v[84:85], v[84:85], v[198:199]
v_pk_mul_f32 v[86:87], v[86:87], v[198:199]
v_pk_mul_f32 v[88:89], v[88:89], v[198:199]
v_pk_mul_f32 v[90:91], v[90:91], v[198:199]
v_exp_f32 v212, v84
v_exp_f32 v213, v85
v_exp_f32 v214, v86
v_exp_f32 v215, v87
v_exp_f32 v216, v88
v_exp_f32 v217, v89
v_exp_f32 v218, v90
v_exp_f32 v219, v91
v_pk_add_f32 v[212:213], v[212:213], v[202:203]
v_pk_add_f32 v[214:215], v[214:215], v[202:203]
v_pk_add_f32 v[216:217], v[216:217], v[202:203]
v_pk_add_f32 v[218:219], v[218:219], v[202:203]
v_rcp_f32 v212, v212
v_rcp_f32 v213, v213
v_rcp_f32 v214, v214
v_rcp_f32 v215, v215
v_rcp_f32 v216, v216
v_rcp_f32 v217, v217
v_rcp_f32 v218, v218
v_rcp_f32 v219, v219
v_pk_mul_f32 v[212:213], v[84:85], v[212:213]
v_pk_mul_f32 v[214:215], v[86:87], v[214:215]
v_pk_mul_f32 v[216:217], v[88:89], v[216:217]
v_pk_mul_f32 v[218:219], v[90:91], v[218:219]
v_cvt_pk_bf16_f32 v228, v212, v213
v_cvt_pk_bf16_f32 v229, v214, v215
v_cvt_pk_bf16_f32 v230, v216, v217
v_cvt_pk_bf16_f32 v231, v218, v219
buffer_store_dwordx4 v[228:231], v3, s[16:19], s68 offen offset:2048 sc1
s_waitcnt vmcnt(3)
s_nop 0
s_atomic_add s60, s[16:17], s100 offset:8192
v_pk_fma_f32 v[112:113], v[140:141], v[192:193], v[112:113]
v_pk_fma_f32 v[114:115], v[142:143], v[192:193], v[114:115]
v_pk_fma_f32 v[116:117], v[144:145], v[192:193], v[116:117]
v_pk_fma_f32 v[118:119], v[146:147], v[192:193], v[118:119]
v_pk_mul_f32 v[112:113], v[112:113], v[200:201]
v_pk_mul_f32 v[114:115], v[114:115], v[200:201]
v_pk_mul_f32 v[116:117], v[116:117], v[200:201]
v_pk_mul_f32 v[118:119], v[118:119], v[200:201]
v_exp_f32 v220, v112
v_exp_f32 v221, v113
v_exp_f32 v222, v114
v_exp_f32 v223, v115
v_exp_f32 v224, v116
v_exp_f32 v225, v117
v_exp_f32 v226, v118
v_exp_f32 v227, v119
v_pk_add_f32 v[220:221], v[220:221], v[202:203]
v_pk_add_f32 v[222:223], v[222:223], v[202:203]
v_pk_add_f32 v[224:225], v[224:225], v[202:203]
v_pk_add_f32 v[226:227], v[226:227], v[202:203]
v_rcp_f32 v220, v220
v_rcp_f32 v221, v221
v_rcp_f32 v222, v222
v_rcp_f32 v223, v223
v_rcp_f32 v224, v224
v_rcp_f32 v225, v225
v_rcp_f32 v226, v226
v_rcp_f32 v227, v227
v_pk_mul_f32 v[220:221], v[112:113], v[220:221]
v_pk_mul_f32 v[222:223], v[114:115], v[222:223]
v_pk_mul_f32 v[224:225], v[116:117], v[224:225]
v_pk_mul_f32 v[226:227], v[118:119], v[226:227]
v_cvt_pk_bf16_f32 v232, v220, v221
v_cvt_pk_bf16_f32 v233, v222, v223
v_cvt_pk_bf16_f32 v234, v224, v225
v_cvt_pk_bf16_f32 v235, v226, v227
buffer_store_dwordx4 v[232:235], v3, s[16:19], s68 offen offset:3072 sc1
v_pk_fma_f32 v[36:37], v[148:149], v[186:187], v[36:37]
v_pk_fma_f32 v[38:39], v[150:151], v[186:187], v[38:39]
v_pk_fma_f32 v[64:65], v[148:149], v[188:189], v[64:65]
v_pk_fma_f32 v[66:67], v[150:151], v[188:189], v[66:67]
v_pk_mul_f32 v[36:37], v[36:37], v[194:195]
v_pk_mul_f32 v[38:39], v[38:39], v[194:195]
v_pk_mul_f32 v[64:65], v[64:65], v[196:197]
v_pk_mul_f32 v[66:67], v[66:67], v[196:197]
v_exp_f32 v204, v36
v_exp_f32 v205, v37
v_exp_f32 v206, v38
v_exp_f32 v207, v39
v_exp_f32 v208, v64
v_exp_f32 v209, v65
v_exp_f32 v210, v66
v_exp_f32 v211, v67
v_pk_add_f32 v[204:205], v[204:205], v[202:203]
v_pk_add_f32 v[206:207], v[206:207], v[202:203]
v_pk_add_f32 v[208:209], v[208:209], v[202:203]
v_pk_add_f32 v[210:211], v[210:211], v[202:203]
v_rcp_f32 v204, v204
v_rcp_f32 v205, v205
v_rcp_f32 v206, v206
v_rcp_f32 v207, v207
v_rcp_f32 v208, v208
v_rcp_f32 v209, v209
v_rcp_f32 v210, v210
v_rcp_f32 v211, v211
v_pk_mul_f32 v[204:205], v[36:37], v[204:205]
v_pk_mul_f32 v[206:207], v[38:39], v[206:207]
v_pk_mul_f32 v[208:209], v[64:65], v[208:209]
v_pk_mul_f32 v[210:211], v[66:67], v[210:211]
v_cvt_pk_bf16_f32 v4, v204, v205
v_cvt_pk_bf16_f32 v5, v206, v207
v_cvt_pk_bf16_f32 v6, v208, v209
v_cvt_pk_bf16_f32 v7, v210, v211
s_nop 0
v_permlane16_swap_b32 v4, v6
v_permlane16_swap_b32_e64 v5, v7
buffer_store_dwordx4 v[4:7], v184, s[16:19], s99 offen offset:0 sc1
v_pk_fma_f32 v[92:93], v[148:149], v[190:191], v[92:93]
v_pk_fma_f32 v[94:95], v[150:151], v[190:191], v[94:95]
v_pk_fma_f32 v[120:121], v[148:149], v[192:193], v[120:121]
v_pk_fma_f32 v[122:123], v[150:151], v[192:193], v[122:123]
v_pk_mul_f32 v[92:93], v[92:93], v[198:199]
v_pk_mul_f32 v[94:95], v[94:95], v[198:199]
v_pk_mul_f32 v[120:121], v[120:121], v[200:201]
v_pk_mul_f32 v[122:123], v[122:123], v[200:201]
v_exp_f32 v212, v92
v_exp_f32 v213, v93
v_exp_f32 v214, v94
v_exp_f32 v215, v95
v_exp_f32 v216, v120
v_exp_f32 v217, v121
v_exp_f32 v218, v122
v_exp_f32 v219, v123
v_pk_add_f32 v[212:213], v[212:213], v[202:203]
v_pk_add_f32 v[214:215], v[214:215], v[202:203]
v_pk_add_f32 v[216:217], v[216:217], v[202:203]
v_pk_add_f32 v[218:219], v[218:219], v[202:203]
v_rcp_f32 v212, v212
v_rcp_f32 v213, v213
v_rcp_f32 v214, v214
v_rcp_f32 v215, v215
v_rcp_f32 v216, v216
v_rcp_f32 v217, v217
v_rcp_f32 v218, v218
v_rcp_f32 v219, v219
v_pk_mul_f32 v[212:213], v[92:93], v[212:213]
v_pk_mul_f32 v[214:215], v[94:95], v[214:215]
v_pk_mul_f32 v[216:217], v[120:121], v[216:217]
v_pk_mul_f32 v[218:219], v[122:123], v[218:219]
v_cvt_pk_bf16_f32 v228, v212, v213
v_cvt_pk_bf16_f32 v229, v214, v215
v_cvt_pk_bf16_f32 v230, v216, v217
v_cvt_pk_bf16_f32 v231, v218, v219
s_nop 0
v_permlane16_swap_b32 v228, v230
v_permlane16_swap_b32 v229, v231
buffer_store_dwordx4 v[228:231], v184, s[16:19], s99 offen offset:2048 sc1
s_waitcnt vmcnt(2)
s_atomic_add s60, s[16:17], s100 offset:128
s_waitcnt vmcnt(0)
s_atomic_add s60, s[16:17], s100 offset:8320
s_branch K_C2
K_CA:
s_load_dwordx2 s[28:29], s[0:1], 56
s_mov_b32 s30, 2097152
s_mov_b32 s31, 0x20000
v_and_b32 v232, 15, v1
v_lshrrev_b32 v233, 4, v1
v_lshrrev_b32 v234, 1, v232
v_xor_b32 v234, v234, v233
v_lshlrev_b32_e64 v234, 4, v234
v_lshl_add_u32 v234, v232, 7, v234
v_add_u32 v8, 90112, v234
v_xor_b32_e64 v234, 64, v234
v_add_u32 v13, 90112, v234
v_lshrrev_b32 v236, 3, v232
v_and_b32 v234, 1, v233
v_lshl_or_b32 v236, v234, 1, v236
v_lshrrev_b32 v234, 2, v232
v_lshlrev_b32 v234, 7, v234
v_lshl_add_u32 v234, v233, 10, v234
v_and_b32_e64 v235, 3, v232
v_lshl_add_u32 v234, v235, 3, v234
v_add_u32 v234, 106496, v234
v_xor_b32_e64 v235, s39, v236
v_lshl_add_u32 v14, v235, 5, v234
s_lshl_b32 s41, s36, 4
s_add_u32 s41, s41, s59
s_lshl2_add_u32 s41, s41, s39
s_lshl_b32 s41, s41, 8
s_add_u32 s41, s41, 524288
s_waitcnt lgkmcnt(0)
s_mul_i32 s50, s50, 0x9E3779B1
s_add_u32 s50, s50, 0x7F4A7C15
s_mov_b32 s51, s50
s_atomic_swap s51, s[16:17], s41 glc
s_mov_b32 s55, s50
s_atomic_swap s55, s[16:17], s41 offset:128 glc
s_and_b32 s4, s2, 7
s_lshr_b32 s5, s2, 3
s_and_b32 s6, s5, 15
s_lshr_b32 s6, 0x880, s6
s_and_b32 s6, s6, 1
s_mul_i32 s6, s6, 12
s_xor_b32 s5, s5, s6
s_lshl_b32 s4, s4, 2
s_lshr_b32 s6, s5, 3
s_add_u32 s52, s4, s6
s_and_b32 s53, s5, 7
v_and_b32 v233, 1, v1
v_lshlrev_b32_e64 v233, 4, v233
v_mov_b32 v234, 0x3f80
v_lshlrev_b32_e64 v234, v233, v234
v_bfe_u32 v235, v1, 1, 2
v_bfe_u32 v233, v1, 4, 1
v_lshl_or_b32 v235, v233, 2, v235
v_lshrrev_b32 v233, 2, v1
v_xor_b32 v233, v233, v1
v_and_b32 v233, 8, v233
v_or_b32 v235, v235, v233
v_cmp_eq_u32 vcc, 0, v235
s_nop 1
v_cndmask_b32 v16, 0, v234, vcc
v_cmp_eq_u32 vcc, 1, v235
s_nop 1
v_cndmask_b32 v17, 0, v234, vcc
v_cmp_eq_u32 vcc, 2, v235
s_nop 1
v_cndmask_b32 v18, 0, v234, vcc
v_cmp_eq_u32 vcc, 3, v235
s_nop 1
v_cndmask_b32 v19, 0, v234, vcc
v_cmp_eq_u32 vcc, 4, v235
s_nop 1
v_cndmask_b32 v20, 0, v234, vcc
v_cmp_eq_u32 vcc, 5, v235
s_nop 1
v_cndmask_b32 v21, 0, v234, vcc
v_cmp_eq_u32 vcc, 6, v235
s_nop 1
v_cndmask_b32 v22, 0, v234, vcc
v_cmp_eq_u32 vcc, 7, v235
s_nop 1
v_cndmask_b32 v23, 0, v234, vcc
v_and_b32_e64 v235, 15, v1
v_mov_b32 v234, 0x3f803f80
v_cmp_eq_u32 vcc, 0, v235
s_nop 1
v_cndmask_b32 v24, 0, v234, vcc
v_mov_b32 v25, v24
v_mov_b32 v26, v24
v_mov_b32 v27, v24
v_cmp_eq_u32 vcc, 4, v235
s_nop 1
v_cndmask_b32 v28, 0, v234, vcc
v_mov_b32 v29, v28
v_mov_b32 v30, v28
v_mov_b32 v31, v28
s_lshr_b32 s61, s50, 8
s_lshr_b32 s62, s50, 16
s_lshr_b32 s63, s50, 24
s_mov_b32 s96, 0x0c0c0400
s_mov_b32 s97, 0x04000c0c
s_mov_b32 s60, 1
s_lshl_b32 s101, s39, 6
s_add_u32 s101, s101, 153088
s_lshl_b32 s45, s39, 10
s_add_u32 s45, s45, 155648
s_lshl_b32 s68, s37, 2
s_add_u32 s68, s68, s39
s_mul_i32 s69, s68, 34816
s_add_u32 s69, s69, 11534336
s_mul_i32 s66, s36, 2176
s_add_u32 s66, s66, s69
s_lshl2_add_u32 s46, s59, s39
s_lshl_b32 s46, s46, 8
s_add_u32 s46, s46, 524288
s_add_u32 s47, s46, 65536
s_and_b32 s43, s36, 0
s_lshl_b32 s43, s43, 14
s_add_u32 s44, s43, s47
s_add_u32 s43, s43, s46
s_lshl_b32 s41, s36, 6
s_add_u32 s67, s69, s41
s_mul_i32 s68, s68, 2176
s_add_u32 s68, s68, 65536
s_add_u32 s69, s68, s41
s_cmp_eq_u32 s36, 0
s_cselect_b32 s70, s67, 1073741824
s_cselect_b32 s71, s69, 1073741824
s_cselect_b64 s[64:65], -1, 0
s_mul_i32 s98, s36, 589824
s_lshl_b32 s41, s37, 11
s_add_u32 s98, s98, s41
s_lshl_b32 s41, s39, 9
s_add_u32 s98, s98, s41
s_add_u32 s98, s98, 1277952
s_lshl_b32 s99, s36, 14
s_add_u32 s99, s99, 529408
s_add_u32 s48, s99, 2048
s_or_b32 s41, s39, s37
s_or_b32 s41, s41, s36
s_cselect_b32 s100, 1073741824, 0
s_lshl_b32 s41, s39, 4
s_add_u32 s41, s41, 154176
v_lshrrev_b32 v253, 5, v1
v_lshl_add_u32 v253, v253, 3, s41
v_mov_b32 v254, 154112
v_mov_b32 v232, s50
v_mov_b32 v233, 0
v_mov_b32 v234, 0
v_mov_b32 v235, 0
ds_write_b128 v254, v[232:235]
s_waitcnt vmcnt(5)
v_lshlrev_b32 v216, 16, v240
v_and_b32 v217, 0xffff0000, v240
v_lshlrev_b32_e64 v218, 16, v241
v_and_b32 v219, 0xffff0000, v241
v_lshlrev_b32_e64 v220, 16, v242
v_and_b32 v221, 0xffff0000, v242
v_lshlrev_b32_e64 v222, 16, v243
v_and_b32 v223, 0xffff0000, v243
v_lshlrev_b32_e64 v224, 16, v244
v_and_b32 v225, 0xffff0000, v244
v_lshlrev_b32_e64 v226, 16, v245
v_and_b32 v227, 0xffff0000, v245
v_lshlrev_b32_e64 v228, 16, v246
v_and_b32 v229, 0xffff0000, v246
v_lshlrev_b32_e64 v230, 16, v247
v_and_b32 v231, 0xffff0000, v247
v_pk_add_f32 v[240:241], v[216:217], v[218:219]
v_pk_add_f32 v[242:243], v[220:221], v[222:223]
v_pk_add_f32 v[244:245], v[224:225], v[226:227]
v_pk_add_f32 v[246:247], v[228:229], v[230:231]
v_pk_add_f32 v[240:241], v[240:241], v[242:243]
v_pk_add_f32 v[244:245], v[244:245], v[246:247]
v_pk_add_f32 v[240:241], v[240:241], v[244:245]
v_add_f32 v248, v240, v241
s_nop 1
v_add_f32_dpp v248, v248, v248 quad_perm:[1,0,3,2] row_mask:0xf bank_mask:0xf
s_nop 0
s_nop 0
v_add_f32_dpp v248, v248, v248 quad_perm:[2,3,0,1] row_mask:0xf bank_mask:0xf
s_nop 0
s_nop 0
v_add_f32_dpp v248, v248, v248 row_half_mirror row_mask:0xf bank_mask:0xf
s_nop 0
s_nop 0
v_add_f32_dpp v248, v248, v248 row_mirror row_mask:0xf bank_mask:0xf
v_mov_b32 v252, v248
s_nop 1
v_permlane16_swap_b32 v248, v252
v_add_f32 v248, v248, v252
v_mul_f32 v248, 0x3b000000, v248
v_sub_f32 v216, v216, v248
v_sub_f32 v217, v217, v248
v_sub_f32 v218, v218, v248
v_sub_f32 v219, v219, v248
v_sub_f32 v220, v220, v248
v_sub_f32 v221, v221, v248
v_sub_f32 v222, v222, v248
v_sub_f32 v223, v223, v248
v_sub_f32 v224, v224, v248
v_sub_f32 v225, v225, v248
v_sub_f32 v226, v226, v248
v_sub_f32 v227, v227, v248
v_sub_f32 v228, v228, v248
v_sub_f32 v229, v229, v248
v_sub_f32 v230, v230, v248
v_sub_f32 v231, v231, v248
v_pk_mul_f32 v[240:241], v[216:217], v[216:217]
v_pk_mul_f32 v[242:243], v[218:219], v[218:219]
v_pk_fma_f32 v[240:241], v[220:221], v[220:221], v[240:241]
v_pk_fma_f32 v[242:243], v[222:223], v[222:223], v[242:243]
v_pk_fma_f32 v[240:241], v[224:225], v[224:225], v[240:241]
v_pk_fma_f32 v[242:243], v[226:227], v[226:227], v[242:243]
v_pk_fma_f32 v[240:241], v[228:229], v[228:229], v[240:241]
v_pk_fma_f32 v[242:243], v[230:231], v[230:231], v[242:243]
v_pk_add_f32 v[240:241], v[240:241], v[242:243]
v_add_f32 v250, v240, v241
s_nop 1
v_add_f32_dpp v250, v250, v250 quad_perm:[1,0,3,2] row_mask:0xf bank_mask:0xf
s_nop 0
s_nop 0
v_add_f32_dpp v250, v250, v250 quad_perm:[2,3,0,1] row_mask:0xf bank_mask:0xf
s_nop 0
s_nop 0
v_add_f32_dpp v250, v250, v250 row_half_mirror row_mask:0xf bank_mask:0xf
s_nop 0
s_nop 0
v_add_f32_dpp v250, v250, v250 row_mirror row_mask:0xf bank_mask:0xf
v_mov_b32 v252, v250
s_nop 1
v_permlane16_swap_b32 v250, v252
v_add_f32 v250, v250, v252
v_mov_b32 v249, 0x3727c5ac
v_fmac_f32 v249, 0x3b000000, v250
v_rsq_f32 v249, v249
s_nop 0
ds_write_b64 v253, v[248:249]
s_mov_b64 exec, 0
s_cmp_eq_u32 s39, 0
s_cbranch_scc1 WS_A0
s_cmp_eq_u32 s39, 1
s_cbranch_scc1 WS_A1
s_cmp_eq_u32 s39, 2
s_cbranch_scc1 WS_A2
s_branch WS_A3
K_wret:
s_cmp_lg_u32 s3, 0
s_cbranch_scc1 WR_F
WR_A:
s_mov_b64 exec, -1
s_waitcnt vmcnt(0) lgkmcnt(0)
s_barrier
ds_read_b64_tr_b16 v[160:161], v14 offset:0
ds_read_b64_tr_b16 v[162:163], v14 offset:512
ds_read_b64_tr_b16 v[164:165], v14 offset:8192
ds_read_b64_tr_b16 v[166:167], v14 offset:8704
ds_read_b64_tr_b16 v[168:169], v14 offset:16384
ds_read_b64_tr_b16 v[170:171], v14 offset:16896
ds_read_b128 v[128:131], v8 offset:0
ds_read_b128 v[132:135], v8 offset:2048
ds_read_b128 v[136:139], v8 offset:4096
ds_read_b128 v[140:143], v8 offset:6144
ds_read_b128 v[144:147], v8 offset:8192
ds_read_b128 v[148:151], v8 offset:10240
s_waitcnt lgkmcnt(5)
v_mfma_f32_16x16x32_bf16 v[32:35], v[160:163], v[128:131], 0
ds_read_b128 v[152:155], v8 offset:12288
ds_read_b128 v[156:159], v8 offset:14336
v_mfma_f32_16x16x32_bf16 v[36:39], v[164:167], v[128:131], 0
ds_read_b64_tr_b16 v[172:173], v14 offset:4096
ds_read_b64_tr_b16 v[174:175], v14 offset:4608
v_mfma_f32_16x16x32_bf16 v[40:43], v[128:131], v[168:171], 0
ds_read_b64_tr_b16 v[176:177], v14 offset:12288
ds_read_b64_tr_b16 v[178:179], v14 offset:12800
s_waitcnt lgkmcnt(8)
v_mfma_f32_16x16x32_bf16 v[52:55], v[132:135], v[168:171], 0
ds_read_b64_tr_b16 v[180:181], v14 offset:20480
v_mfma_f32_16x16x32_bf16 v[48:51], v[164:167], v[132:135], 0
ds_read_b64_tr_b16 v[182:183], v14 offset:20992
v_mfma_f32_16x16x32_bf16 v[44:47], v[160:163], v[132:135], 0
ds_read_b128 v[128:131], v13 offset:0
v_mfma_f32_16x16x32_bf16 v[56:59], v[160:163], v[136:139], 0
ds_read_b128 v[132:135], v13 offset:2048
v_mfma_f32_16x16x32_bf16 v[60:63], v[164:167], v[136:139], 0
v_mfma_f32_16x16x32_bf16 v[64:67], v[136:139], v[168:171], 0
v_mfma_f32_16x16x32_bf16 v[76:79], v[140:143], v[168:171], 0
ds_read_b128 v[136:139], v13 offset:4096
v_mfma_f32_16x16x32_bf16 v[72:75], v[164:167], v[140:143], 0
v_mfma_f32_16x16x32_bf16 v[68:71], v[160:163], v[140:143], 0
s_waitcnt lgkmcnt(8)
v_mfma_f32_16x16x32_bf16 v[80:83], v[160:163], v[144:147], 0
ds_read_b128 v[140:143], v13 offset:6144
v_mfma_f32_16x16x32_bf16 v[84:87], v[164:167], v[144:147], 0
v_mfma_f32_16x16x32_bf16 v[88:91], v[144:147], v[168:171], 0
v_mfma_f32_16x16x32_bf16 v[100:103], v[148:151], v[168:171], 0
ds_read_b128 v[144:147], v13 offset:8192
v_mfma_f32_16x16x32_bf16 v[96:99], v[164:167], v[148:151], 0
v_mfma_f32_16x16x32_bf16 v[92:95], v[160:163], v[148:151], 0
v_mfma_f32_16x16x32_bf16 v[104:107], v[160:163], v[152:155], 0
ds_read_b128 v[148:151], v13 offset:10240
v_mfma_f32_16x16x32_bf16 v[108:111], v[164:167], v[152:155], 0
v_mfma_f32_16x16x32_bf16 v[112:115], v[152:155], v[168:171], 0
v_mfma_f32_16x16x32_bf16 v[124:127], v[156:159], v[168:171], 0
ds_read_b128 v[152:155], v13 offset:12288
v_mfma_f32_16x16x32_bf16 v[120:123], v[164:167], v[156:159], 0
v_mfma_f32_16x16x32_bf16 v[116:119], v[160:163], v[156:159], 0
s_waitcnt lgkmcnt(6)
v_mfma_f32_16x16x32_bf16 v[32:35], v[172:175], v[128:131], v[32:35]
ds_read_b128 v[156:159], v13 offset:14336
v_mfma_f32_16x16x32_bf16 v[36:39], v[176:179], v[128:131], v[36:39]
v_add_u32 v8, 0xffff5000, v8
v_add_u32 v13, 0xffff5000, v13
v_mfma_f32_16x16x32_bf16 v[40:43], v[128:131], v[180:183], v[40:43]
v_add_u32 v14, 0xffff5000, v14
s_waitcnt lgkmcnt(6)
v_mfma_f32_16x16x32_bf16 v[52:55], v[132:135], v[180:183], v[52:55]
v_mfma_f32_16x16x32_bf16 v[48:51], v[176:179], v[132:135], v[48:51]
v_mfma_f32_16x16x32_bf16 v[44:47], v[172:175], v[132:135], v[44:47]
s_waitcnt lgkmcnt(5)
v_mfma_f32_16x16x32_bf16 v[56:59], v[172:175], v[136:139], v[56:59]
v_mfma_f32_16x16x32_bf16 v[60:63], v[176:179], v[136:139], v[60:63]
v_mfma_f32_16x16x32_bf16 v[64:67], v[136:139], v[180:183], v[64:67]
s_waitcnt lgkmcnt(0)
s_barrier
v_mfma_f32_16x16x32_bf16 v[76:79], v[140:143], v[180:183], v[76:79]
ds_read_b64_tr_b16 v[160:161], v14 offset:0
ds_read_b64_tr_b16 v[162:163], v14 offset:512
v_mfma_f32_16x16x32_bf16 v[72:75], v[176:179], v[140:143], v[72:75]
ds_read_b64_tr_b16 v[164:165], v14 offset:8192
ds_read_b64_tr_b16 v[166:167], v14 offset:8704
v_mfma_f32_16x16x32_bf16 v[68:71], v[172:175], v[140:143], v[68:71]
ds_read_b64_tr_b16 v[168:169], v14 offset:16384
ds_read_b64_tr_b16 v[170:171], v14 offset:16896
v_mfma_f32_16x16x32_bf16 v[80:83], v[172:175], v[144:147], v[80:83]
ds_read_b128 v[128:131], v8 offset:0
ds_read_b128 v[132:135], v8 offset:2048
v_mfma_f32_16x16x32_bf16 v[84:87], v[176:179], v[144:147], v[84:87]
ds_read_b128 v[136:139], v8 offset:4096
v_mfma_f32_16x16x32_bf16 v[88:91], v[144:147], v[180:183], v[88:91]
ds_read_b128 v[140:143], v8 offset:6144
v_mfma_f32_16x16x32_bf16 v[100:103], v[148:151], v[180:183], v[100:103]
ds_read_b128 v[144:147], v8 offset:8192
v_mfma_f32_16x16x32_bf16 v[96:99], v[176:179], v[148:151], v[96:99]
v_mfma_f32_16x16x32_bf16 v[92:95], v[172:175], v[148:151], v[92:95]
v_mfma_f32_16x16x32_bf16 v[104:107], v[172:175], v[152:155], v[104:107]
ds_read_b128 v[148:151], v8 offset:10240
v_mfma_f32_16x16x32_bf16 v[108:111], v[176:179], v[152:155], v[108:111]
v_mfma_f32_16x16x32_bf16 v[112:115], v[152:155], v[180:183], v[112:115]
v_mfma_f32_16x16x32_bf16 v[124:127], v[156:159], v[180:183], v[124:127]
ds_read_b128 v[152:155], v8 offset:12288
v_mfma_f32_16x16x32_bf16 v[120:123], v[176:179], v[156:159], v[120:123]
v_mfma_f32_16x16x32_bf16 v[116:119], v[172:175], v[156:159], v[116:119]
s_waitcnt lgkmcnt(6)
v_mfma_f32_16x16x32_bf16 v[32:35], v[160:163], v[128:131], v[32:35]
ds_read_b128 v[156:159], v8 offset:14336
ds_read_b64_tr_b16 v[172:173], v14 offset:4096
v_mfma_f32_16x16x32_bf16 v[36:39], v[164:167], v[128:131], v[36:39]
ds_read_b64_tr_b16 v[174:175], v14 offset:4608
ds_read_b64_tr_b16 v[176:177], v14 offset:12288
v_mfma_f32_16x16x32_bf16 v[40:43], v[128:131], v[168:171], v[40:43]
ds_read_b64_tr_b16 v[178:179], v14 offset:12800
s_waitcnt lgkmcnt(8)
v_mfma_f32_16x16x32_bf16 v[52:55], v[132:135], v[168:171], v[52:55]
ds_read_b64_tr_b16 v[180:181], v14 offset:20480
v_mfma_f32_16x16x32_bf16 v[48:51], v[164:167], v[132:135], v[48:51]
ds_read_b64_tr_b16 v[182:183], v14 offset:20992
v_mfma_f32_16x16x32_bf16 v[44:47], v[160:163], v[132:135], v[44:47]
ds_read_b128 v[128:131], v13 offset:0
WS_A0:
WS_5676:
s_cbranch_execz WS_3220
s_nop 0
v_mfma_f32_16x16x32_bf16 v[56:59], v[160:163], v[136:139], v[56:59]
ds_read_b128 v[132:135], v13 offset:2048
v_mfma_f32_16x16x32_bf16 v[60:63], v[164:167], v[136:139], v[60:63]
v_mfma_f32_16x16x32_bf16 v[64:67], v[136:139], v[168:171], v[64:67]
v_mfma_f32_16x16x32_bf16 v[76:79], v[140:143], v[168:171], v[76:79]
ds_read_b128 v[136:139], v13 offset:4096
v_mfma_f32_16x16x32_bf16 v[72:75], v[164:167], v[140:143], v[72:75]
v_mfma_f32_16x16x32_bf16 v[68:71], v[160:163], v[140:143], v[68:71]
s_waitcnt lgkmcnt(8)
v_mfma_f32_16x16x32_bf16 v[80:83], v[160:163], v[144:147], v[80:83]
ds_read_b128 v[140:143], v13 offset:6144
v_mfma_f32_16x16x32_bf16 v[84:87], v[164:167], v[144:147], v[84:87]
v_mfma_f32_16x16x32_bf16 v[88:91], v[144:147], v[168:171], v[88:91]
v_mfma_f32_16x16x32_bf16 v[100:103], v[148:151], v[168:171], v[100:103]
ds_read_b128 v[144:147], v13 offset:8192
v_mfma_f32_16x16x32_bf16 v[96:99], v[164:167], v[148:151], v[96:99]
v_mfma_f32_16x16x32_bf16 v[92:95], v[160:163], v[148:151], v[92:95]
v_mfma_f32_16x16x32_bf16 v[104:107], v[160:163], v[152:155], v[104:107]
ds_read_b128 v[148:151], v13 offset:10240
v_mfma_f32_16x16x32_bf16 v[108:111], v[164:167], v[152:155], v[108:111]
v_mfma_f32_16x16x32_bf16 v[112:115], v[152:155], v[168:171], v[112:115]
v_mfma_f32_16x16x32_bf16 v[124:127], v[156:159], v[168:171], v[124:127]
ds_read_b128 v[152:155], v13 offset:12288
v_mfma_f32_16x16x32_bf16 v[120:123], v[164:167], v[156:159], v[120:123]
v_mfma_f32_16x16x32_bf16 v[116:119], v[160:163], v[156:159], v[116:119]
s_waitcnt lgkmcnt(6)
v_mfma_f32_16x16x32_bf16 v[32:35], v[172:175], v[128:131], v[32:35]
ds_read_b128 v[156:159], v13 offset:14336
v_mfma_f32_16x16x32_bf16 v[36:39], v[176:179], v[128:131], v[36:39]
v_add_u32 v8, 0xffff5000, v8
v_add_u32 v13, 0xffff5000, v13
v_mfma_f32_16x16x32_bf16 v[40:43], v[128:131], v[180:183], v[40:43]
v_add_u32 v14, 0xffff5000, v14
s_waitcnt lgkmcnt(6)
v_mfma_f32_16x16x32_bf16 v[52:55], v[132:135], v[180:183], v[52:55]
v_mfma_f32_16x16x32_bf16 v[48:51], v[176:179], v[132:135], v[48:51]
v_mfma_f32_16x16x32_bf16 v[44:47], v[172:175], v[132:135], v[44:47]
s_waitcnt lgkmcnt(5)
v_mfma_f32_16x16x32_bf16 v[56:59], v[172:175], v[136:139], v[56:59]
v_mfma_f32_16x16x32_bf16 v[60:63], v[176:179], v[136:139], v[60:63]
v_mfma_f32_16x16x32_bf16 v[64:67], v[136:139], v[180:183], v[64:67]
s_waitcnt lgkmcnt(0)
s_barrier
v_mfma_f32_16x16x32_bf16 v[76:79], v[140:143], v[180:183], v[76:79]
ds_read_b64_tr_b16 v[160:161], v14 offset:0
ds_read_b64_tr_b16 v[162:163], v14 offset:512
v_mfma_f32_16x16x32_bf16 v[72:75], v[176:179], v[140:143], v[72:75]
ds_read_b64_tr_b16 v[164:165], v14 offset:8192
ds_read_b64_tr_b16 v[166:167], v14 offset:8704
v_mfma_f32_16x16x32_bf16 v[68:71], v[172:175], v[140:143], v[68:71]
ds_read_b64_tr_b16 v[168:169], v14 offset:16384
ds_read_b64_tr_b16 v[170:171], v14 offset:16896
v_mfma_f32_16x16x32_bf16 v[80:83], v[172:175], v[144:147], v[80:83]
ds_read_b128 v[128:131], v8 offset:0
ds_read_b128 v[132:135], v8 offset:2048
v_mfma_f32_16x16x32_bf16 v[84:87], v[176:179], v[144:147], v[84:87]
ds_read_b128 v[136:139], v8 offset:4096
v_mfma_f32_16x16x32_bf16 v[88:91], v[144:147], v[180:183], v[88:91]
ds_read_b128 v[140:143], v8 offset:6144
v_mfma_f32_16x16x32_bf16 v[100:103], v[148:151], v[180:183], v[100:103]
ds_read_b128 v[144:147], v8 offset:8192
v_mfma_f32_16x16x32_bf16 v[96:99], v[176:179], v[148:151], v[96:99]
v_mfma_f32_16x16x32_bf16 v[92:95], v[172:175], v[148:151], v[92:95]
v_mfma_f32_16x16x32_bf16 v[104:107], v[172:175], v[152:155], v[104:107]
ds_read_b128 v[148:151], v8 offset:10240
v_mfma_f32_16x16x32_bf16 v[108:111], v[176:179], v[152:155], v[108:111]
v_mfma_f32_16x16x32_bf16 v[112:115], v[152:155], v[180:183], v[112:115]
v_mfma_f32_16x16x32_bf16 v[124:127], v[156:159], v[180:183], v[124:127]
ds_read_b128 v[152:155], v8 offset:12288
v_mfma_f32_16x16x32_bf16 v[120:123], v[176:179], v[156:159], v[120:123]
v_mfma_f32_16x16x32_bf16 v[116:119], v[172:175], v[156:159], v[116:119]
s_waitcnt lgkmcnt(6)
v_mfma_f32_16x16x32_bf16 v[32:35], v[160:163], v[128:131], v[32:35]
ds_read_b128 v[156:159], v8 offset:14336
ds_read_b64_tr_b16 v[172:173], v14 offset:4096
v_mfma_f32_16x16x32_bf16 v[36:39], v[164:167], v[128:131], v[36:39]
ds_read_b64_tr_b16 v[174:175], v14 offset:4608
ds_read_b64_tr_b16 v[176:177], v14 offset:12288
v_mfma_f32_16x16x32_bf16 v[40:43], v[128:131], v[168:171], v[40:43]
ds_read_b64_tr_b16 v[178:179], v14 offset:12800
s_waitcnt lgkmcnt(8)
v_mfma_f32_16x16x32_bf16 v[52:55], v[132:135], v[168:171], v[52:55]
ds_read_b64_tr_b16 v[180:181], v14 offset:20480
v_mfma_f32_16x16x32_bf16 v[48:51], v[164:167], v[132:135], v[48:51]
ds_read_b64_tr_b16 v[182:183], v14 offset:20992
v_mfma_f32_16x16x32_bf16 v[44:47], v[160:163], v[132:135], v[44:47]
ds_read_b128 v[128:131], v13 offset:0
v_mfma_f32_16x16x32_bf16 v[56:59], v[160:163], v[136:139], v[56:59]
ds_read_b128 v[132:135], v13 offset:2048
v_mfma_f32_16x16x32_bf16 v[60:63], v[164:167], v[136:139], v[60:63]
v_mfma_f32_16x16x32_bf16 v[64:67], v[136:139], v[168:171], v[64:67]
v_mfma_f32_16x16x32_bf16 v[76:79], v[140:143], v[168:171], v[76:79]
ds_read_b128 v[136:139], v13 offset:4096
v_mfma_f32_16x16x32_bf16 v[72:75], v[164:167], v[140:143], v[72:75]
v_mfma_f32_16x16x32_bf16 v[68:71], v[160:163], v[140:143], v[68:71]
s_waitcnt lgkmcnt(8)
v_mfma_f32_16x16x32_bf16 v[80:83], v[160:163], v[144:147], v[80:83]
ds_read_b128 v[140:143], v13 offset:6144
v_mfma_f32_16x16x32_bf16 v[84:87], v[164:167], v[144:147], v[84:87]
v_mfma_f32_16x16x32_bf16 v[88:91], v[144:147], v[168:171], v[88:91]
v_mfma_f32_16x16x32_bf16 v[100:103], v[148:151], v[168:171], v[100:103]
ds_read_b128 v[144:147], v13 offset:8192
v_mfma_f32_16x16x32_bf16 v[96:99], v[164:167], v[148:151], v[96:99]
v_mfma_f32_16x16x32_bf16 v[92:95], v[160:163], v[148:151], v[92:95]
v_mfma_f32_16x16x32_bf16 v[104:107], v[160:163], v[152:155], v[104:107]
ds_read_b128 v[148:151], v13 offset:10240
v_mfma_f32_16x16x32_bf16 v[108:111], v[164:167], v[152:155], v[108:111]
v_mfma_f32_16x16x32_bf16 v[112:115], v[152:155], v[168:171], v[112:115]
v_mfma_f32_16x16x32_bf16 v[124:127], v[156:159], v[168:171], v[124:127]
ds_read_b128 v[152:155], v13 offset:12288
v_mfma_f32_16x16x32_bf16 v[120:123], v[164:167], v[156:159], v[120:123]
v_mfma_f32_16x16x32_bf16 v[116:119], v[160:163], v[156:159], v[116:119]
s_waitcnt lgkmcnt(6)
v_mfma_f32_16x16x32_bf16 v[32:35], v[172:175], v[128:131], v[32:35]
ds_read_b128 v[156:159], v13 offset:14336
v_mfma_f32_16x16x32_bf16 v[36:39], v[176:179], v[128:131], v[36:39]
v_add_u32 v8, 0x16000, v8
v_add_u32 v13, 0x16000, v13
v_mfma_f32_16x16x32_bf16 v[40:43], v[128:131], v[180:183], v[40:43]
v_add_u32 v14, 0x16000, v14
s_waitcnt lgkmcnt(6)
v_mfma_f32_16x16x32_bf16 v[52:55], v[132:135], v[180:183], v[52:55]
v_mfma_f32_16x16x32_bf16 v[48:51], v[176:179], v[132:135], v[48:51]
v_mfma_f32_16x16x32_bf16 v[44:47], v[172:175], v[132:135], v[44:47]
s_waitcnt lgkmcnt(5)
v_mfma_f32_16x16x32_bf16 v[56:59], v[172:175], v[136:139], v[56:59]
v_mfma_f32_16x16x32_bf16 v[60:63], v[176:179], v[136:139], v[60:63]
v_mfma_f32_16x16x32_bf16 v[64:67], v[136:139], v[180:183], v[64:67]
s_waitcnt lgkmcnt(0)
s_barrier
v_mfma_f32_16x16x32_bf16 v[76:79], v[140:143], v[180:183], v[76:79]
ds_read_b64_tr_b16 v[160:161], v14 offset:0
ds_read_b64_tr_b16 v[162:163], v14 offset:512
v_mfma_f32_16x16x32_bf16 v[72:75], v[176:179], v[140:143], v[72:75]
ds_read_b64_tr_b16 v[164:165], v14 offset:8192
ds_read_b64_tr_b16 v[166:167], v14 offset:8704
v_mfma_f32_16x16x32_bf16 v[68:71], v[172:175], v[140:143], v[68:71]
ds_read_b64_tr_b16 v[168:169], v14 offset:16384
ds_read_b64_tr_b16 v[170:171], v14 offset:16896
v_mfma_f32_16x16x32_bf16 v[80:83], v[172:175], v[144:147], v[80:83]
ds_read_b128 v[128:131], v8 offset:0
ds_read_b128 v[132:135], v8 offset:2048
v_mfma_f32_16x16x32_bf16 v[84:87], v[176:179], v[144:147], v[84:87]
ds_read_b128 v[136:139], v8 offset:4096
v_mfma_f32_16x16x32_bf16 v[88:91], v[144:147], v[180:183], v[88:91]
ds_read_b128 v[140:143], v8 offset:6144
v_mfma_f32_16x16x32_bf16 v[100:103], v[148:151], v[180:183], v[100:103]
ds_read_b128 v[144:147], v8 offset:8192
v_mfma_f32_16x16x32_bf16 v[96:99], v[176:179], v[148:151], v[96:99]
v_mfma_f32_16x16x32_bf16 v[92:95], v[172:175], v[148:151], v[92:95]
v_mfma_f32_16x16x32_bf16 v[104:107], v[172:175], v[152:155], v[104:107]
ds_read_b128 v[148:151], v8 offset:10240
v_mfma_f32_16x16x32_bf16 v[108:111], v[176:179], v[152:155], v[108:111]
v_mfma_f32_16x16x32_bf16 v[112:115], v[152:155], v[180:183], v[112:115]
v_mfma_f32_16x16x32_bf16 v[124:127], v[156:159], v[180:183], v[124:127]
ds_read_b128 v[152:155], v8 offset:12288
v_mfma_f32_16x16x32_bf16 v[120:123], v[176:179], v[156:159], v[120:123]
v_mfma_f32_16x16x32_bf16 v[116:119], v[172:175], v[156:159], v[116:119]
s_waitcnt lgkmcnt(6)
v_mfma_f32_16x16x32_bf16 v[32:35], v[160:163], v[128:131], v[32:35]
ds_read_b128 v[156:159], v8 offset:14336
ds_read_b64_tr_b16 v[172:173], v14 offset:4096
v_mfma_f32_16x16x32_bf16 v[36:39], v[164:167], v[128:131], v[36:39]
ds_read_b64_tr_b16 v[174:175], v14 offset:4608
ds_read_b64_tr_b16 v[176:177], v14 offset:12288
v_mfma_f32_16x16x32_bf16 v[40:43], v[128:131], v[168:171], v[40:43]
ds_read_b64_tr_b16 v[178:179], v14 offset:12800
s_waitcnt lgkmcnt(8)
v_mfma_f32_16x16x32_bf16 v[52:55], v[132:135], v[168:171], v[52:55]
ds_read_b64_tr_b16 v[180:181], v14 offset:20480
v_mfma_f32_16x16x32_bf16 v[48:51], v[164:167], v[132:135], v[48:51]
ds_read_b64_tr_b16 v[182:183], v14 offset:20992
v_mfma_f32_16x16x32_bf16 v[44:47], v[160:163], v[132:135], v[44:47]
ds_read_b128 v[128:131], v13 offset:0
v_mfma_f32_16x16x32_bf16 v[56:59], v[160:163], v[136:139], v[56:59]
ds_read_b128 v[132:135], v13 offset:2048
v_mfma_f32_16x16x32_bf16 v[60:63], v[164:167], v[136:139], v[60:63]
v_mfma_f32_16x16x32_bf16 v[64:67], v[136:139], v[168:171], v[64:67]
v_mfma_f32_16x16x32_bf16 v[76:79], v[140:143], v[168:171], v[76:79]
ds_read_b128 v[136:139], v13 offset:4096
v_mfma_f32_16x16x32_bf16 v[72:75], v[164:167], v[140:143], v[72:75]
v_mfma_f32_16x16x32_bf16 v[68:71], v[160:163], v[140:143], v[68:71]
s_waitcnt lgkmcnt(8)
v_mfma_f32_16x16x32_bf16 v[80:83], v[160:163], v[144:147], v[80:83]
ds_read_b128 v[140:143], v13 offset:6144
v_mfma_f32_16x16x32_bf16 v[84:87], v[164:167], v[144:147], v[84:87]
v_mfma_f32_16x16x32_bf16 v[88:91], v[144:147], v[168:171], v[88:91]
v_mfma_f32_16x16x32_bf16 v[100:103], v[148:151], v[168:171], v[100:103]
ds_read_b128 v[144:147], v13 offset:8192
v_mfma_f32_16x16x32_bf16 v[96:99], v[164:167], v[148:151], v[96:99]
v_mfma_f32_16x16x32_bf16 v[92:95], v[160:163], v[148:151], v[92:95]
v_mfma_f32_16x16x32_bf16 v[104:107], v[160:163], v[152:155], v[104:107]
ds_read_b128 v[148:151], v13 offset:10240
v_mfma_f32_16x16x32_bf16 v[108:111], v[164:167], v[152:155], v[108:111]
v_mfma_f32_16x16x32_bf16 v[112:115], v[152:155], v[168:171], v[112:115]
v_mfma_f32_16x16x32_bf16 v[124:127], v[156:159], v[168:171], v[124:127]
ds_read_b128 v[152:155], v13 offset:12288
v_mfma_f32_16x16x32_bf16 v[120:123], v[164:167], v[156:159], v[120:123]
v_mfma_f32_16x16x32_bf16 v[116:119], v[160:163], v[156:159], v[116:119]
s_waitcnt lgkmcnt(6)
v_mfma_f32_16x16x32_bf16 v[32:35], v[172:175], v[128:131], v[32:35]
ds_read_b128 v[156:159], v13 offset:14336
v_mfma_f32_16x16x32_bf16 v[36:39], v[176:179], v[128:131], v[36:39]
v_add_u32 v8, 0xffff5000, v8
v_add_u32 v13, 0xffff5000, v13
v_mfma_f32_16x16x32_bf16 v[40:43], v[128:131], v[180:183], v[40:43]
v_add_u32 v14, 0xffff5000, v14
s_waitcnt lgkmcnt(6)
v_mfma_f32_16x16x32_bf16 v[52:55], v[132:135], v[180:183], v[52:55]
v_mfma_f32_16x16x32_bf16 v[48:51], v[176:179], v[132:135], v[48:51]
v_mfma_f32_16x16x32_bf16 v[44:47], v[172:175], v[132:135], v[44:47]
s_waitcnt lgkmcnt(5)
v_mfma_f32_16x16x32_bf16 v[56:59], v[172:175], v[136:139], v[56:59]
v_mfma_f32_16x16x32_bf16 v[60:63], v[176:179], v[136:139], v[60:63]
v_mfma_f32_16x16x32_bf16 v[64:67], v[136:139], v[180:183], v[64:67]
s_waitcnt lgkmcnt(0)
s_barrier
v_mfma_f32_16x16x32_bf16 v[76:79], v[140:143], v[180:183], v[76:79]
ds_read_b64_tr_b16 v[160:161], v14 offset:0
ds_read_b64_tr_b16 v[162:163], v14 offset:512
v_mfma_f32_16x16x32_bf16 v[72:75], v[176:179], v[140:143], v[72:75]
ds_read_b64_tr_b16 v[164:165], v14 offset:8192
ds_read_b64_tr_b16 v[166:167], v14 offset:8704
v_mfma_f32_16x16x32_bf16 v[68:71], v[172:175], v[140:143], v[68:71]
ds_read_b64_tr_b16 v[168:169], v14 offset:16384
ds_read_b64_tr_b16 v[170:171], v14 offset:16896
v_mfma_f32_16x16x32_bf16 v[80:83], v[172:175], v[144:147], v[80:83]
ds_read_b128 v[128:131], v8 offset:0
ds_read_b128 v[132:135], v8 offset:2048
v_mfma_f32_16x16x32_bf16 v[84:87], v[176:179], v[144:147], v[84:87]
ds_read_b128 v[136:139], v8 offset:4096
v_mfma_f32_16x16x32_bf16 v[88:91], v[144:147], v[180:183], v[88:91]
ds_read_b128 v[140:143], v8 offset:6144
v_mfma_f32_16x16x32_bf16 v[100:103], v[148:151], v[180:183], v[100:103]
ds_read_b128 v[144:147], v8 offset:8192
v_mfma_f32_16x16x32_bf16 v[96:99], v[176:179], v[148:151], v[96:99]
v_mfma_f32_16x16x32_bf16 v[92:95], v[172:175], v[148:151], v[92:95]
v_mfma_f32_16x16x32_bf16 v[104:107], v[172:175], v[152:155], v[104:107]
ds_read_b128 v[148:151], v8 offset:10240
v_mfma_f32_16x16x32_bf16 v[108:111], v[176:179], v[152:155], v[108:111]
v_mfma_f32_16x16x32_bf16 v[112:115], v[152:155], v[180:183], v[112:115]
v_mfma_f32_16x16x32_bf16 v[124:127], v[156:159], v[180:183], v[124:127]
ds_read_b128 v[152:155], v8 offset:12288
v_mfma_f32_16x16x32_bf16 v[120:123], v[176:179], v[156:159], v[120:123]
v_mfma_f32_16x16x32_bf16 v[116:119], v[172:175], v[156:159], v[116:119]
s_waitcnt lgkmcnt(6)
v_mfma_f32_16x16x32_bf16 v[32:35], v[160:163], v[128:131], v[32:35]
ds_read_b128 v[156:159], v8 offset:14336
ds_read_b64_tr_b16 v[172:173], v14 offset:4096
v_mfma_f32_16x16x32_bf16 v[36:39], v[164:167], v[128:131], v[36:39]
ds_read_b64_tr_b16 v[174:175], v14 offset:4608
ds_read_b64_tr_b16 v[176:177], v14 offset:12288
v_mfma_f32_16x16x32_bf16 v[40:43], v[128:131], v[168:171], v[40:43]
ds_read_b64_tr_b16 v[178:179], v14 offset:12800
s_waitcnt lgkmcnt(8)
v_mfma_f32_16x16x32_bf16 v[52:55], v[132:135], v[168:171], v[52:55]
ds_read_b64_tr_b16 v[180:181], v14 offset:20480
v_mfma_f32_16x16x32_bf16 v[48:51], v[164:167], v[132:135], v[48:51]
ds_read_b64_tr_b16 v[182:183], v14 offset:20992
v_mfma_f32_16x16x32_bf16 v[44:47], v[160:163], v[132:135], v[44:47]
ds_read_b128 v[128:131], v13 offset:0
v_mfma_f32_16x16x32_bf16 v[56:59], v[160:163], v[136:139], v[56:59]
ds_read_b128 v[132:135], v13 offset:2048
v_mfma_f32_16x16x32_bf16 v[60:63], v[164:167], v[136:139], v[60:63]
v_mfma_f32_16x16x32_bf16 v[64:67], v[136:139], v[168:171], v[64:67]
v_mfma_f32_16x16x32_bf16 v[76:79], v[140:143], v[168:171], v[76:79]
ds_read_b128 v[136:139], v13 offset:4096
v_mfma_f32_16x16x32_bf16 v[72:75], v[164:167], v[140:143], v[72:75]
v_mfma_f32_16x16x32_bf16 v[68:71], v[160:163], v[140:143], v[68:71]
s_waitcnt lgkmcnt(8)
v_mfma_f32_16x16x32_bf16 v[80:83], v[160:163], v[144:147], v[80:83]
ds_read_b128 v[140:143], v13 offset:6144
v_mfma_f32_16x16x32_bf16 v[84:87], v[164:167], v[144:147], v[84:87]
v_mfma_f32_16x16x32_bf16 v[88:91], v[144:147], v[168:171], v[88:91]
v_mfma_f32_16x16x32_bf16 v[100:103], v[148:151], v[168:171], v[100:103]
ds_read_b128 v[144:147], v13 offset:8192
v_mfma_f32_16x16x32_bf16 v[96:99], v[164:167], v[148:151], v[96:99]
v_mfma_f32_16x16x32_bf16 v[92:95], v[160:163], v[148:151], v[92:95]
v_mfma_f32_16x16x32_bf16 v[104:107], v[160:163], v[152:155], v[104:107]
ds_read_b128 v[148:151], v13 offset:10240
v_mfma_f32_16x16x32_bf16 v[108:111], v[164:167], v[152:155], v[108:111]
v_mfma_f32_16x16x32_bf16 v[112:115], v[152:155], v[168:171], v[112:115]
v_mfma_f32_16x16x32_bf16 v[124:127], v[156:159], v[168:171], v[124:127]
ds_read_b128 v[152:155], v13 offset:12288
v_mfma_f32_16x16x32_bf16 v[120:123], v[164:167], v[156:159], v[120:123]
v_mfma_f32_16x16x32_bf16 v[116:119], v[160:163], v[156:159], v[116:119]
s_waitcnt lgkmcnt(6)
v_mfma_f32_16x16x32_bf16 v[32:35], v[172:175], v[128:131], v[32:35]
ds_read_b128 v[156:159], v13 offset:14336
v_mfma_f32_16x16x32_bf16 v[36:39], v[176:179], v[128:131], v[36:39]
v_add_u32 v8, 0xffff5000, v8
v_add_u32 v13, 0xffff5000, v13
v_mfma_f32_16x16x32_bf16 v[40:43], v[128:131], v[180:183], v[40:43]
v_add_u32 v14, 0xffff5000, v14
s_waitcnt lgkmcnt(6)
v_mfma_f32_16x16x32_bf16 v[52:55], v[132:135], v[180:183], v[52:55]
v_mfma_f32_16x16x32_bf16 v[48:51], v[176:179], v[132:135], v[48:51]
v_mfma_f32_16x16x32_bf16 v[44:47], v[172:175], v[132:135], v[44:47]
s_waitcnt lgkmcnt(5)
v_mfma_f32_16x16x32_bf16 v[56:59], v[172:175], v[136:139], v[56:59]
v_mfma_f32_16x16x32_bf16 v[60:63], v[176:179], v[136:139], v[60:63]
v_mfma_f32_16x16x32_bf16 v[64:67], v[136:139], v[180:183], v[64:67]
s_waitcnt lgkmcnt(0)
s_barrier
v_mfma_f32_16x16x32_bf16 v[76:79], v[140:143], v[180:183], v[76:79]
ds_read_b64_tr_b16 v[160:161], v14 offset:0
ds_read_b64_tr_b16 v[162:163], v14 offset:512
v_mfma_f32_16x16x32_bf16 v[72:75], v[176:179], v[140:143], v[72:75]
ds_read_b64_tr_b16 v[164:165], v14 offset:8192
ds_read_b64_tr_b16 v[166:167], v14 offset:8704
v_mfma_f32_16x16x32_bf16 v[68:71], v[172:175], v[140:143], v[68:71]
ds_read_b64_tr_b16 v[168:169], v14 offset:16384
ds_read_b64_tr_b16 v[170:171], v14 offset:16896
v_mfma_f32_16x16x32_bf16 v[80:83], v[172:175], v[144:147], v[80:83]
ds_read_b128 v[128:131], v8 offset:0
ds_read_b128 v[132:135], v8 offset:2048
v_mfma_f32_16x16x32_bf16 v[84:87], v[176:179], v[144:147], v[84:87]
ds_read_b128 v[136:139], v8 offset:4096
v_mfma_f32_16x16x32_bf16 v[88:91], v[144:147], v[180:183], v[88:91]
ds_read_b128 v[140:143], v8 offset:6144
v_mfma_f32_16x16x32_bf16 v[100:103], v[148:151], v[180:183], v[100:103]
ds_read_b128 v[144:147], v8 offset:8192
v_mfma_f32_16x16x32_bf16 v[96:99], v[176:179], v[148:151], v[96:99]
v_mfma_f32_16x16x32_bf16 v[92:95], v[172:175], v[148:151], v[92:95]
v_mfma_f32_16x16x32_bf16 v[104:107], v[172:175], v[152:155], v[104:107]
ds_read_b128 v[148:151], v8 offset:10240
v_mfma_f32_16x16x32_bf16 v[108:111], v[176:179], v[152:155], v[108:111]
v_mfma_f32_16x16x32_bf16 v[112:115], v[152:155], v[180:183], v[112:115]
v_mfma_f32_16x16x32_bf16 v[124:127], v[156:159], v[180:183], v[124:127]
ds_read_b128 v[152:155], v8 offset:12288
v_mfma_f32_16x16x32_bf16 v[120:123], v[176:179], v[156:159], v[120:123]
v_mfma_f32_16x16x32_bf16 v[116:119], v[172:175], v[156:159], v[116:119]
s_waitcnt lgkmcnt(6)
v_mfma_f32_16x16x32_bf16 v[32:35], v[160:163], v[128:131], v[32:35]
ds_read_b128 v[156:159], v8 offset:14336
ds_read_b64_tr_b16 v[172:173], v14 offset:4096
v_mfma_f32_16x16x32_bf16 v[36:39], v[164:167], v[128:131], v[36:39]
ds_read_b64_tr_b16 v[174:175], v14 offset:4608
ds_read_b64_tr_b16 v[176:177], v14 offset:12288
v_mfma_f32_16x16x32_bf16 v[40:43], v[128:131], v[168:171], v[40:43]
ds_read_b64_tr_b16 v[178:179], v14 offset:12800
s_waitcnt lgkmcnt(8)
v_mfma_f32_16x16x32_bf16 v[52:55], v[132:135], v[168:171], v[52:55]
ds_read_b64_tr_b16 v[180:181], v14 offset:20480
v_mfma_f32_16x16x32_bf16 v[48:51], v[164:167], v[132:135], v[48:51]
ds_read_b64_tr_b16 v[182:183], v14 offset:20992
v_mfma_f32_16x16x32_bf16 v[44:47], v[160:163], v[132:135], v[44:47]
ds_read_b128 v[128:131], v13 offset:0
v_mfma_f32_16x16x32_bf16 v[56:59], v[160:163], v[136:139], v[56:59]
ds_read_b128 v[132:135], v13 offset:2048
v_mfma_f32_16x16x32_bf16 v[60:63], v[164:167], v[136:139], v[60:63]
v_mfma_f32_16x16x32_bf16 v[64:67], v[136:139], v[168:171], v[64:67]
v_mfma_f32_16x16x32_bf16 v[76:79], v[140:143], v[168:171], v[76:79]
ds_read_b128 v[136:139], v13 offset:4096
v_mfma_f32_16x16x32_bf16 v[72:75], v[164:167], v[140:143], v[72:75]
v_mfma_f32_16x16x32_bf16 v[68:71], v[160:163], v[140:143], v[68:71]
s_waitcnt lgkmcnt(8)
v_mfma_f32_16x16x32_bf16 v[80:83], v[160:163], v[144:147], v[80:83]
ds_read_b128 v[140:143], v13 offset:6144
v_mfma_f32_16x16x32_bf16 v[84:87], v[164:167], v[144:147], v[84:87]
v_mfma_f32_16x16x32_bf16 v[88:91], v[144:147], v[168:171], v[88:91]
v_mfma_f32_16x16x32_bf16 v[100:103], v[148:151], v[168:171], v[100:103]
ds_read_b128 v[144:147], v13 offset:8192
v_mfma_f32_16x16x32_bf16 v[96:99], v[164:167], v[148:151], v[96:99]
v_mfma_f32_16x16x32_bf16 v[92:95], v[160:163], v[148:151], v[92:95]
v_mfma_f32_16x16x32_bf16 v[104:107], v[160:163], v[152:155], v[104:107]
ds_read_b128 v[148:151], v13 offset:10240
v_mfma_f32_16x16x32_bf16 v[108:111], v[164:167], v[152:155], v[108:111]
v_mfma_f32_16x16x32_bf16 v[112:115], v[152:155], v[168:171], v[112:115]
v_mfma_f32_16x16x32_bf16 v[124:127], v[156:159], v[168:171], v[124:127]
ds_read_b128 v[152:155], v13 offset:12288
v_mfma_f32_16x16x32_bf16 v[120:123], v[164:167], v[156:159], v[120:123]
v_mfma_f32_16x16x32_bf16 v[116:119], v[160:163], v[156:159], v[116:119]
s_waitcnt lgkmcnt(6)
v_mfma_f32_16x16x32_bf16 v[32:35], v[172:175], v[128:131], v[32:35]
ds_read_b128 v[156:159], v13 offset:14336
v_mfma_f32_16x16x32_bf16 v[36:39], v[176:179], v[128:131], v[36:39]
v_add_u32 v8, 0x16000, v8
v_add_u32 v13, 0x16000, v13
v_mfma_f32_16x16x32_bf16 v[40:43], v[128:131], v[180:183], v[40:43]
v_add_u32 v14, 0x16000, v14
s_waitcnt lgkmcnt(6)
v_mfma_f32_16x16x32_bf16 v[52:55], v[132:135], v[180:183], v[52:55]
v_mfma_f32_16x16x32_bf16 v[48:51], v[176:179], v[132:135], v[48:51]
v_mfma_f32_16x16x32_bf16 v[44:47], v[172:175], v[132:135], v[44:47]
s_waitcnt lgkmcnt(5)
v_mfma_f32_16x16x32_bf16 v[56:59], v[172:175], v[136:139], v[56:59]
v_mfma_f32_16x16x32_bf16 v[60:63], v[176:179], v[136:139], v[60:63]
v_mfma_f32_16x16x32_bf16 v[64:67], v[136:139], v[180:183], v[64:67]
s_waitcnt lgkmcnt(0)
s_barrier
v_mfma_f32_16x16x32_bf16 v[76:79], v[140:143], v[180:183], v[76:79]
ds_read_b64_tr_b16 v[160:161], v14 offset:0
ds_read_b64_tr_b16 v[162:163], v14 offset:512
v_mfma_f32_16x16x32_bf16 v[72:75], v[176:179], v[140:143], v[72:75]
ds_read_b64_tr_b16 v[164:165], v14 offset:8192
ds_read_b64_tr_b16 v[166:167], v14 offset:8704
v_mfma_f32_16x16x32_bf16 v[68:71], v[172:175], v[140:143], v[68:71]
ds_read_b64_tr_b16 v[168:169], v14 offset:16384
ds_read_b64_tr_b16 v[170:171], v14 offset:16896
v_mfma_f32_16x16x32_bf16 v[80:83], v[172:175], v[144:147], v[80:83]
ds_read_b128 v[128:131], v8 offset:0
ds_read_b128 v[132:135], v8 offset:2048
v_mfma_f32_16x16x32_bf16 v[84:87], v[176:179], v[144:147], v[84:87]
ds_read_b128 v[136:139], v8 offset:4096
v_mfma_f32_16x16x32_bf16 v[88:91], v[144:147], v[180:183], v[88:91]
ds_read_b128 v[140:143], v8 offset:6144
v_mfma_f32_16x16x32_bf16 v[100:103], v[148:151], v[180:183], v[100:103]
ds_read_b128 v[144:147], v8 offset:8192
v_mfma_f32_16x16x32_bf16 v[96:99], v[176:179], v[148:151], v[96:99]
v_mfma_f32_16x16x32_bf16 v[92:95], v[172:175], v[148:151], v[92:95]
v_mfma_f32_16x16x32_bf16 v[104:107], v[172:175], v[152:155], v[104:107]
ds_read_b128 v[148:151], v8 offset:10240
v_mfma_f32_16x16x32_bf16 v[108:111], v[176:179], v[152:155], v[108:111]
v_mfma_f32_16x16x32_bf16 v[112:115], v[152:155], v[180:183], v[112:115]
v_mfma_f32_16x16x32_bf16 v[124:127], v[156:159], v[180:183], v[124:127]
ds_read_b128 v[152:155], v8 offset:12288
v_mfma_f32_16x16x32_bf16 v[120:123], v[176:179], v[156:159], v[120:123]
v_mfma_f32_16x16x32_bf16 v[116:119], v[172:175], v[156:159], v[116:119]
s_waitcnt lgkmcnt(6)
v_mfma_f32_16x16x32_bf16 v[32:35], v[160:163], v[128:131], v[32:35]
ds_read_b128 v[156:159], v8 offset:14336
ds_read_b64_tr_b16 v[172:173], v14 offset:4096
v_mfma_f32_16x16x32_bf16 v[36:39], v[164:167], v[128:131], v[36:39]
ds_read_b64_tr_b16 v[174:175], v14 offset:4608
ds_read_b64_tr_b16 v[176:177], v14 offset:12288
v_mfma_f32_16x16x32_bf16 v[40:43], v[128:131], v[168:171], v[40:43]
ds_read_b64_tr_b16 v[178:179], v14 offset:12800
s_waitcnt lgkmcnt(8)
v_mfma_f32_16x16x32_bf16 v[52:55], v[132:135], v[168:171], v[52:55]
ds_read_b64_tr_b16 v[180:181], v14 offset:20480
v_mfma_f32_16x16x32_bf16 v[48:51], v[164:167], v[132:135], v[48:51]
ds_read_b64_tr_b16 v[182:183], v14 offset:20992
v_mfma_f32_16x16x32_bf16 v[44:47], v[160:163], v[132:135], v[44:47]
ds_read_b128 v[128:131], v13 offset:0
v_mfma_f32_16x16x32_bf16 v[56:59], v[160:163], v[136:139], v[56:59]
ds_read_b128 v[132:135], v13 offset:2048
v_mfma_f32_16x16x32_bf16 v[60:63], v[164:167], v[136:139], v[60:63]
v_mfma_f32_16x16x32_bf16 v[64:67], v[136:139], v[168:171], v[64:67]
v_mfma_f32_16x16x32_bf16 v[76:79], v[140:143], v[168:171], v[76:79]
ds_read_b128 v[136:139], v13 offset:4096
v_mfma_f32_16x16x32_bf16 v[72:75], v[164:167], v[140:143], v[72:75]
v_mfma_f32_16x16x32_bf16 v[68:71], v[160:163], v[140:143], v[68:71]
s_waitcnt lgkmcnt(8)
v_mfma_f32_16x16x32_bf16 v[80:83], v[160:163], v[144:147], v[80:83]
ds_read_b128 v[140:143], v13 offset:6144
v_mfma_f32_16x16x32_bf16 v[84:87], v[164:167], v[144:147], v[84:87]
v_mfma_f32_16x16x32_bf16 v[88:91], v[144:147], v[168:171], v[88:91]
v_mfma_f32_16x16x32_bf16 v[100:103], v[148:151], v[168:171], v[100:103]
ds_read_b128 v[144:147], v13 offset:8192
v_mfma_f32_16x16x32_bf16 v[96:99], v[164:167], v[148:151], v[96:99]
v_mfma_f32_16x16x32_bf16 v[92:95], v[160:163], v[148:151], v[92:95]
v_mfma_f32_16x16x32_bf16 v[104:107], v[160:163], v[152:155], v[104:107]
ds_read_b128 v[148:151], v13 offset:10240
v_mfma_f32_16x16x32_bf16 v[108:111], v[164:167], v[152:155], v[108:111]
v_mfma_f32_16x16x32_bf16 v[112:115], v[152:155], v[168:171], v[112:115]
v_mfma_f32_16x16x32_bf16 v[124:127], v[156:159], v[168:171], v[124:127]
ds_read_b128 v[152:155], v13 offset:12288
v_mfma_f32_16x16x32_bf16 v[120:123], v[164:167], v[156:159], v[120:123]
v_mfma_f32_16x16x32_bf16 v[116:119], v[160:163], v[156:159], v[116:119]
s_waitcnt lgkmcnt(6)
v_mfma_f32_16x16x32_bf16 v[32:35], v[172:175], v[128:131], v[32:35]
ds_read_b128 v[156:159], v13 offset:14336
v_mfma_f32_16x16x32_bf16 v[36:39], v[176:179], v[128:131], v[36:39]
v_add_u32 v8, 0xffff5000, v8
v_add_u32 v13, 0xffff5000, v13
v_mfma_f32_16x16x32_bf16 v[40:43], v[128:131], v[180:183], v[40:43]
v_add_u32 v14, 0xffff5000, v14
s_waitcnt lgkmcnt(6)
v_mfma_f32_16x16x32_bf16 v[52:55], v[132:135], v[180:183], v[52:55]
v_mfma_f32_16x16x32_bf16 v[48:51], v[176:179], v[132:135], v[48:51]
v_mfma_f32_16x16x32_bf16 v[44:47], v[172:175], v[132:135], v[44:47]
s_waitcnt lgkmcnt(5)
v_mfma_f32_16x16x32_bf16 v[56:59], v[172:175], v[136:139], v[56:59]
v_mfma_f32_16x16x32_bf16 v[60:63], v[176:179], v[136:139], v[60:63]
v_mfma_f32_16x16x32_bf16 v[64:67], v[136:139], v[180:183], v[64:67]
s_waitcnt lgkmcnt(0)
s_barrier
v_mfma_f32_16x16x32_bf16 v[76:79], v[140:143], v[180:183], v[76:79]
ds_read_b64_tr_b16 v[160:161], v14 offset:0
ds_read_b64_tr_b16 v[162:163], v14 offset:512
v_mfma_f32_16x16x32_bf16 v[72:75], v[176:179], v[140:143], v[72:75]
ds_read_b64_tr_b16 v[164:165], v14 offset:8192
ds_read_b64_tr_b16 v[166:167], v14 offset:8704
v_mfma_f32_16x16x32_bf16 v[68:71], v[172:175], v[140:143], v[68:71]
ds_read_b64_tr_b16 v[168:169], v14 offset:16384
ds_read_b64_tr_b16 v[170:171], v14 offset:16896
v_mfma_f32_16x16x32_bf16 v[80:83], v[172:175], v[144:147], v[80:83]
ds_read_b128 v[128:131], v8 offset:0
ds_read_b128 v[132:135], v8 offset:2048
v_mfma_f32_16x16x32_bf16 v[84:87], v[176:179], v[144:147], v[84:87]
ds_read_b128 v[136:139], v8 offset:4096
v_mfma_f32_16x16x32_bf16 v[88:91], v[144:147], v[180:183], v[88:91]
ds_read_b128 v[140:143], v8 offset:6144
v_mfma_f32_16x16x32_bf16 v[100:103], v[148:151], v[180:183], v[100:103]
ds_read_b128 v[144:147], v8 offset:8192
v_mfma_f32_16x16x32_bf16 v[96:99], v[176:179], v[148:151], v[96:99]
v_mfma_f32_16x16x32_bf16 v[92:95], v[172:175], v[148:151], v[92:95]
v_mfma_f32_16x16x32_bf16 v[104:107], v[172:175], v[152:155], v[104:107]
ds_read_b128 v[148:151], v8 offset:10240
v_mfma_f32_16x16x32_bf16 v[108:111], v[176:179], v[152:155], v[108:111]
v_mfma_f32_16x16x32_bf16 v[112:115], v[152:155], v[180:183], v[112:115]
v_mfma_f32_16x16x32_bf16 v[124:127], v[156:159], v[180:183], v[124:127]
ds_read_b128 v[152:155], v8 offset:12288
v_mfma_f32_16x16x32_bf16 v[120:123], v[176:179], v[156:159], v[120:123]
v_mfma_f32_16x16x32_bf16 v[116:119], v[172:175], v[156:159], v[116:119]
s_waitcnt lgkmcnt(6)
v_mfma_f32_16x16x32_bf16 v[32:35], v[160:163], v[128:131], v[32:35]
ds_read_b128 v[156:159], v8 offset:14336
ds_read_b64_tr_b16 v[172:173], v14 offset:4096
v_mfma_f32_16x16x32_bf16 v[36:39], v[164:167], v[128:131], v[36:39]
ds_read_b64_tr_b16 v[174:175], v14 offset:4608
ds_read_b64_tr_b16 v[176:177], v14 offset:12288
v_mfma_f32_16x16x32_bf16 v[40:43], v[128:131], v[168:171], v[40:43]
ds_read_b64_tr_b16 v[178:179], v14 offset:12800
s_waitcnt lgkmcnt(8)
v_mfma_f32_16x16x32_bf16 v[52:55], v[132:135], v[168:171], v[52:55]
ds_read_b64_tr_b16 v[180:181], v14 offset:20480
v_mfma_f32_16x16x32_bf16 v[48:51], v[164:167], v[132:135], v[48:51]
ds_read_b64_tr_b16 v[182:183], v14 offset:20992
v_mfma_f32_16x16x32_bf16 v[44:47], v[160:163], v[132:135], v[44:47]
ds_read_b128 v[128:131], v13 offset:0
v_mfma_f32_16x16x32_bf16 v[56:59], v[160:163], v[136:139], v[56:59]
ds_read_b128 v[132:135], v13 offset:2048
v_mfma_f32_16x16x32_bf16 v[60:63], v[164:167], v[136:139], v[60:63]
v_mfma_f32_16x16x32_bf16 v[64:67], v[136:139], v[168:171], v[64:67]
v_mfma_f32_16x16x32_bf16 v[76:79], v[140:143], v[168:171], v[76:79]
ds_read_b128 v[136:139], v13 offset:4096
v_mfma_f32_16x16x32_bf16 v[72:75], v[164:167], v[140:143], v[72:75]
v_mfma_f32_16x16x32_bf16 v[68:71], v[160:163], v[140:143], v[68:71]
s_waitcnt lgkmcnt(8)
v_mfma_f32_16x16x32_bf16 v[80:83], v[160:163], v[144:147], v[80:83]
ds_read_b128 v[140:143], v13 offset:6144
v_mfma_f32_16x16x32_bf16 v[84:87], v[164:167], v[144:147], v[84:87]
v_mfma_f32_16x16x32_bf16 v[88:91], v[144:147], v[168:171], v[88:91]
WS_A1:
WS_6211:
s_cbranch_execz WR_A
s_nop 0
v_mfma_f32_16x16x32_bf16 v[100:103], v[148:151], v[168:171], v[100:103]
ds_read_b128 v[144:147], v13 offset:8192
v_mfma_f32_16x16x32_bf16 v[96:99], v[164:167], v[148:151], v[96:99]
v_mfma_f32_16x16x32_bf16 v[92:95], v[160:163], v[148:151], v[92:95]
v_mfma_f32_16x16x32_bf16 v[104:107], v[160:163], v[152:155], v[104:107]
ds_read_b128 v[148:151], v13 offset:10240
v_mfma_f32_16x16x32_bf16 v[108:111], v[164:167], v[152:155], v[108:111]
v_mfma_f32_16x16x32_bf16 v[112:115], v[152:155], v[168:171], v[112:115]
v_mfma_f32_16x16x32_bf16 v[124:127], v[156:159], v[168:171], v[124:127]
ds_read_b128 v[152:155], v13 offset:12288
v_mfma_f32_16x16x32_bf16 v[120:123], v[164:167], v[156:159], v[120:123]
v_mfma_f32_16x16x32_bf16 v[116:119], v[160:163], v[156:159], v[116:119]
s_waitcnt lgkmcnt(6)
v_mfma_f32_16x16x32_bf16 v[32:35], v[172:175], v[128:131], v[32:35]
ds_read_b128 v[156:159], v13 offset:14336
v_mfma_f32_16x16x32_bf16 v[36:39], v[176:179], v[128:131], v[36:39]
v_and_b32 v160, 15, v1
v_lshlrev_b32 v160, 2, v160
v_mfma_f32_16x16x32_bf16 v[40:43], v[128:131], v[180:183], v[40:43]
v_and_b32 v161, 48, v1
v_and_b32 v162, 31, v1
s_waitcnt lgkmcnt(6)
v_mfma_f32_16x16x32_bf16 v[52:55], v[132:135], v[180:183], v[52:55]
v_add_u32_e64 v163, s101, v160
v_add_u32 v160, 151552, v160
v_mfma_f32_16x16x32_bf16 v[48:51], v[176:179], v[132:135], v[48:51]
v_lshlrev_b32_e64 v162, 2, v162
v_add_u32 v162, 152064, v162
v_mfma_f32_16x16x32_bf16 v[44:47], v[172:175], v[132:135], v[44:47]
v_add_u32_e64 v164, s101, v161
v_add_u32 v161, 151552, v161
s_waitcnt lgkmcnt(5)
v_mfma_f32_16x16x32_bf16 v[56:59], v[172:175], v[136:139], v[56:59]
v_add_u32 v165, s45, v3
v_mfma_f32_16x16x32_bf16 v[60:63], v[176:179], v[136:139], v[60:63]
v_mfma_f32_16x16x32_bf16 v[64:67], v[136:139], v[180:183], v[64:67]
s_waitcnt lgkmcnt(0)
s_barrier
v_mfma_f32_16x16x32_bf16 v[76:79], v[140:143], v[180:183], v[76:79]
ds_read2_b32 v[10:11], v163 offset0:128 offset1:128
ds_read_b128 v[184:187], v161 offset:0
v_mfma_f32_16x16x32_bf16 v[72:75], v[176:179], v[140:143], v[72:75]
ds_read_b128 v[188:191], v161 offset:1024
ds_read_b128 v[192:195], v161 offset:64
v_mfma_f32_16x16x32_bf16 v[68:71], v[172:175], v[140:143], v[68:71]
ds_read_b128 v[196:199], v161 offset:1088
ds_read_b128 v[200:203], v161 offset:128
v_mfma_f32_16x16x32_bf16 v[80:83], v[172:175], v[144:147], v[80:83]
ds_read_b128 v[204:207], v161 offset:1152
ds_read_b128 v[208:211], v161 offset:192
v_mfma_f32_16x16x32_bf16 v[84:87], v[176:179], v[144:147], v[84:87]
ds_read_b128 v[212:215], v161 offset:1216
ds_read_b128 v[216:219], v161 offset:256
v_mfma_f32_16x16x32_bf16 v[88:91], v[144:147], v[180:183], v[88:91]
ds_read_b128 v[220:223], v161 offset:1280
ds_read_b128 v[224:227], v161 offset:320
v_mfma_f32_16x16x32_bf16 v[100:103], v[148:151], v[180:183], v[100:103]
ds_read_b128 v[228:231], v161 offset:1344
ds_read_b128 v[232:235], v161 offset:384
v_mfma_f32_16x16x32_bf16 v[96:99], v[176:179], v[148:151], v[96:99]
ds_read_b128 v[236:239], v161 offset:1408
ds_read_b128 v[240:243], v161 offset:448
v_mfma_f32_16x16x32_bf16 v[92:95], v[172:175], v[148:151], v[92:95]
ds_read_b128 v[244:247], v161 offset:1472
ds_read_b128 v[4:7], v165
v_mfma_f32_16x16x32_bf16 v[104:107], v[172:175], v[152:155], v[104:107]
ds_read2_b32 v[128:129], v160 offset0:0 offset1:0
ds_read2_b32 v[130:131], v160 offset0:16 offset1:16
v_mfma_f32_16x16x32_bf16 v[108:111], v[176:179], v[152:155], v[108:111]
ds_read2_b32 v[132:133], v160 offset0:32 offset1:32
ds_read2_b32 v[134:135], v160 offset0:48 offset1:48
v_mfma_f32_16x16x32_bf16 v[112:115], v[152:155], v[180:183], v[112:115]
ds_read2_b32 v[136:137], v160 offset0:64 offset1:64
ds_read2_b32 v[138:139], v160 offset0:80 offset1:80
v_mfma_f32_16x16x32_bf16 v[124:127], v[156:159], v[180:183], v[124:127]
ds_read2_b32 v[140:141], v160 offset0:96 offset1:96
ds_read2_b32 v[142:143], v160 offset0:112 offset1:112
v_mfma_f32_16x16x32_bf16 v[120:123], v[176:179], v[156:159], v[120:123]
ds_read2_b32 v[144:145], v162 offset0:0 offset1:0
ds_read2_b32 v[146:147], v162 offset0:32 offset1:32
v_mfma_f32_16x16x32_bf16 v[116:119], v[172:175], v[156:159], v[116:119]
ds_read2_b32 v[148:149], v162 offset0:64 offset1:64
ds_read2_b32 v[150:151], v162 offset0:96 offset1:96
ds_read_b128 v[152:155], v164 offset:256
ds_read_b128 v[156:159], v164
s_waitcnt lgkmcnt(0)
s_nop 0
v_pk_fma_f32 v[36:37], v[152:153], v[128:129], v[36:37]
v_pk_fma_f32 v[38:39], v[154:155], v[128:129], v[38:39]
v_cvt_pk_bf16_f32 v36, v36, v37
v_pk_fma_f32 v[48:49], v[152:153], v[130:131], v[48:49]
v_pk_fma_f32 v[50:51], v[154:155], v[130:131], v[50:51]
v_cvt_pk_bf16_f32 v37, v38, v39
v_pk_fma_f32 v[60:61], v[152:153], v[132:133], v[60:61]
v_cvt_pk_bf16_f32 v38, v48, v49
v_cvt_pk_bf16_f32 v39, v50, v51
v_pk_fma_f32 v[62:63], v[154:155], v[132:133], v[62:63]
v_cvt_pk_bf16_f32 v60, v60, v61
v_pk_fma_f32 v[72:73], v[152:153], v[134:135], v[72:73]
v_pk_fma_f32 v[74:75], v[154:155], v[134:135], v[74:75]
v_cvt_pk_bf16_f32 v61, v62, v63
v_pk_fma_f32 v[84:85], v[152:153], v[136:137], v[84:85]
v_cvt_pk_bf16_f32 v62, v72, v73
v_cvt_pk_bf16_f32 v63, v74, v75
v_pk_fma_f32 v[86:87], v[154:155], v[136:137], v[86:87]
v_cvt_pk_bf16_f32 v84, v84, v85
v_permlane16_swap_b32 v36, v38
v_permlane16_swap_b32 v37, v39
v_pk_fma_f32 v[96:97], v[152:153], v[138:139], v[96:97]
v_pk_fma_f32 v[98:99], v[154:155], v[138:139], v[98:99]
v_cvt_pk_bf16_f32 v85, v86, v87
v_pk_fma_f32 v[108:109], v[152:153], v[140:141], v[108:109]
v_cvt_pk_bf16_f32 v86, v96, v97
v_cvt_pk_bf16_f32 v87, v98, v99
v_pk_fma_f32 v[110:111], v[154:155], v[140:141], v[110:111]
v_cvt_pk_bf16_f32 v108, v108, v109
v_pk_fma_f32 v[40:41], v[184:185], v[10:11], v[40:41]
v_pk_fma_f32 v[42:43], v[186:187], v[10:11], v[42:43]
v_pk_fma_f32 v[52:53], v[192:193], v[10:11], v[52:53]
v_pk_fma_f32 v[54:55], v[194:195], v[10:11], v[54:55]
v_permlane16_swap_b32 v60, v62
v_permlane16_swap_b32 v61, v63
v_pk_fma_f32 v[120:121], v[152:153], v[142:143], v[120:121]
v_pk_fma_f32 v[122:123], v[154:155], v[142:143], v[122:123]
v_cvt_pk_bf16_f32 v109, v110, v111
v_pk_mul_f32 v[40:41], v[40:41], v[188:189]
v_pk_mul_f32 v[42:43], v[42:43], v[190:191]
v_pk_mul_f32 v[52:53], v[52:53], v[196:197]
v_pk_mul_f32 v[54:55], v[54:55], v[198:199]
v_cvt_pk_bf16_f32 v110, v120, v121
v_cvt_pk_bf16_f32 v111, v122, v123
v_mfma_f32_32x32x16_bf16 v[184:199], v[4:7], v[36:39], 0
v_permlane16_swap_b32 v84, v86
v_permlane16_swap_b32 v85, v87
v_permlane16_swap_b32_e64 v108, v110
v_pk_fma_f32 v[64:65], v[200:201], v[10:11], v[64:65]
v_pk_fma_f32 v[66:67], v[202:203], v[10:11], v[66:67]
v_pk_fma_f32 v[76:77], v[208:209], v[10:11], v[76:77]
v_pk_fma_f32 v[78:79], v[210:211], v[10:11], v[78:79]
v_pk_mul_f32 v[64:65], v[64:65], v[204:205]
v_pk_mul_f32 v[66:67], v[66:67], v[206:207]
v_pk_mul_f32 v[76:77], v[76:77], v[212:213]
v_pk_mul_f32 v[78:79], v[78:79], v[214:215]
v_mfma_f32_32x32x16_bf16 v[200:215], v[4:7], v[60:63], 0
v_permlane16_swap_b32_e64 v109, v111
v_max3_f32 v36, v184, v185, v186
v_max3_f32 v37, v187, v188, v189
v_max3_f32 v36, v36, v190, v191
v_max3_f32 v37, v37, v192, v193
v_pk_fma_f32 v[88:89], v[216:217], v[10:11], v[88:89]
v_pk_fma_f32 v[90:91], v[218:219], v[10:11], v[90:91]
v_pk_fma_f32 v[100:101], v[224:225], v[10:11], v[100:101]
v_pk_fma_f32 v[102:103], v[226:227], v[10:11], v[102:103]
v_pk_mul_f32 v[88:89], v[88:89], v[220:221]
v_pk_mul_f32 v[90:91], v[90:91], v[222:223]
v_pk_mul_f32 v[100:101], v[100:101], v[228:229]
v_pk_mul_f32 v[102:103], v[102:103], v[230:231]
v_mfma_f32_32x32x16_bf16 v[216:231], v[4:7], v[84:87], 0
v_max3_f32 v36, v36, v194, v195
v_max3_f32 v60, v200, v201, v202
v_max3_f32 v37, v37, v196, v197
v_max3_f32 v36, v36, v198, v199
v_max3_f32 v61, v203, v204, v205
v_max3_f32 v60, v60, v206, v207
v_pk_fma_f32 v[112:113], v[232:233], v[10:11], v[112:113]
v_pk_fma_f32 v[114:115], v[234:235], v[10:11], v[114:115]
v_pk_fma_f32 v[124:125], v[240:241], v[10:11], v[124:125]
v_pk_fma_f32 v[126:127], v[242:243], v[10:11], v[126:127]
v_pk_mul_f32 v[112:113], v[112:113], v[236:237]
v_pk_mul_f32 v[114:115], v[114:115], v[238:239]
v_pk_mul_f32 v[124:125], v[124:125], v[244:245]
v_pk_mul_f32 v[126:127], v[126:127], v[246:247]
v_mfma_f32_32x32x16_bf16 v[232:247], v[4:7], v[108:111], 0
v_max_f32_e64 v36, v36, v37
v_max3_f32 v61, v61, v208, v209
v_max3_f32 v60, v60, v210, v211
v_max3_f32 v84, v216, v217, v218
v_mul_f32_e64 v38, -v36, v144
v_mul_f32_e64 v39, -v36, v144
v_max3_f32 v61, v61, v212, v213
v_max3_f32 v60, v60, v214, v215
v_max3_f32 v85, v219, v220, v221
v_max3_f32 v84, v84, v222, v223
v_pk_fma_f32 v[184:185], v[184:185], v[144:145], v[38:39]
v_pk_fma_f32 v[186:187], v[186:187], v[144:145], v[38:39]
v_pk_fma_f32 v[188:189], v[188:189], v[144:145], v[38:39]
v_pk_fma_f32 v[190:191], v[190:191], v[144:145], v[38:39]
v_max_f32_e64 v60, v60, v61
v_max3_f32 v85, v85, v224, v225
v_max3_f32 v84, v84, v226, v227
v_max3_f32 v108, v232, v233, v234
v_pk_fma_f32 v[192:193], v[192:193], v[144:145], v[38:39]
v_pk_fma_f32 v[194:195], v[194:195], v[144:145], v[38:39]
v_exp_f32 v184, v184
v_exp_f32 v185, v185
v_exp_f32 v186, v186
v_exp_f32 v187, v187
v_exp_f32 v188, v188
v_exp_f32 v189, v189
v_exp_f32 v190, v190
v_exp_f32 v191, v191
v_mul_f32_e64 v62, -v60, v146
v_mul_f32_e64 v63, -v60, v146
v_max3_f32 v85, v85, v228, v229
v_max3_f32 v84, v84, v230, v231
v_max3_f32 v109, v235, v236, v237
v_max3_f32 v108, v108, v238, v239
v_pk_fma_f32 v[196:197], v[196:197], v[144:145], v[38:39]
v_pk_fma_f32 v[198:199], v[198:199], v[144:145], v[38:39]
v_exp_f32 v192, v192
v_exp_f32 v193, v193
v_exp_f32 v194, v194
v_exp_f32 v195, v195
v_pk_fma_f32 v[200:201], v[200:201], v[146:147], v[62:63]
v_pk_fma_f32 v[202:203], v[202:203], v[146:147], v[62:63]
v_pk_fma_f32 v[204:205], v[204:205], v[146:147], v[62:63]
v_pk_fma_f32 v[206:207], v[206:207], v[146:147], v[62:63]
v_max_f32_e64 v84, v84, v85
v_max3_f32 v109, v109, v240, v241
v_max3_f32 v108, v108, v242, v243
v_exp_f32 v196, v196
v_exp_f32 v197, v197
v_exp_f32 v198, v198
v_exp_f32 v199, v199
v_pk_fma_f32 v[208:209], v[208:209], v[146:147], v[62:63]
v_pk_fma_f32 v[210:211], v[210:211], v[146:147], v[62:63]
v_exp_f32 v200, v200
v_exp_f32 v201, v201
v_exp_f32 v202, v202
v_exp_f32 v203, v203
v_exp_f32 v204, v204
v_exp_f32 v205, v205
v_exp_f32 v206, v206
v_exp_f32 v207, v207
v_mul_f32_e64 v86, -v84, v148
v_mul_f32_e64 v87, -v84, v148
v_max3_f32 v109, v109, v244, v245
v_max3_f32 v108, v108, v246, v247
v_pk_add_f32 v[36:37], v[184:185], v[186:187]
v_pk_add_f32 v[38:39], v[188:189], v[190:191]
v_pk_fma_f32 v[212:213], v[212:213], v[146:147], v[62:63]
v_pk_fma_f32 v[214:215], v[214:215], v[146:147], v[62:63]
v_exp_f32 v208, v208
v_exp_f32 v209, v209
v_exp_f32 v210, v210
v_exp_f32 v211, v211
v_pk_fma_f32 v[216:217], v[216:217], v[148:149], v[86:87]
v_pk_fma_f32 v[218:219], v[218:219], v[148:149], v[86:87]
v_pk_fma_f32 v[220:221], v[220:221], v[148:149], v[86:87]
v_pk_fma_f32 v[222:223], v[222:223], v[148:149], v[86:87]
v_max_f32_e64 v108, v108, v109
v_pk_add_f32 v[36:37], v[36:37], v[192:193]
v_pk_add_f32 v[38:39], v[38:39], v[194:195]
v_exp_f32 v212, v212
v_exp_f32 v213, v213
v_exp_f32 v214, v214
v_exp_f32 v215, v215
v_pk_fma_f32 v[224:225], v[224:225], v[148:149], v[86:87]
v_pk_fma_f32 v[226:227], v[226:227], v[148:149], v[86:87]
v_exp_f32 v216, v216
v_exp_f32 v217, v217
v_exp_f32 v218, v218
v_exp_f32 v219, v219
v_exp_f32 v220, v220
v_exp_f32 v221, v221
v_exp_f32 v222, v222
v_exp_f32 v223, v223
v_mul_f32_e64 v110, -v108, v150
v_mul_f32_e64 v111, -v108, v150
v_pk_add_f32 v[36:37], v[36:37], v[196:197]
v_pk_add_f32 v[38:39], v[38:39], v[198:199]
v_pk_add_f32 v[60:61], v[200:201], v[202:203]
v_pk_add_f32 v[62:63], v[204:205], v[206:207]
v_pk_fma_f32 v[228:229], v[228:229], v[148:149], v[86:87]
v_pk_fma_f32 v[230:231], v[230:231], v[148:149], v[86:87]
v_exp_f32 v224, v224
v_exp_f32 v225, v225
v_exp_f32 v226, v226
v_exp_f32 v227, v227
v_pk_fma_f32 v[232:233], v[232:233], v[150:151], v[110:111]
v_pk_fma_f32 v[234:235], v[234:235], v[150:151], v[110:111]
v_pk_fma_f32 v[236:237], v[236:237], v[150:151], v[110:111]
v_pk_fma_f32 v[238:239], v[238:239], v[150:151], v[110:111]
v_pk_add_f32 v[36:37], v[36:37], v[38:39]
v_pk_add_f32 v[60:61], v[60:61], v[208:209]
v_pk_add_f32 v[62:63], v[62:63], v[210:211]
v_exp_f32 v228, v228
v_exp_f32 v229, v229
v_exp_f32 v230, v230
v_exp_f32 v231, v231
v_pk_fma_f32 v[240:241], v[240:241], v[150:151], v[110:111]
v_pk_fma_f32 v[242:243], v[242:243], v[150:151], v[110:111]
v_exp_f32 v232, v232
v_exp_f32 v233, v233
v_exp_f32 v234, v234
v_exp_f32 v235, v235
v_exp_f32 v236, v236
v_exp_f32 v237, v237
v_exp_f32 v238, v238
v_exp_f32 v239, v239
v_add_f32_e64 v36, v36, v37
v_pk_add_f32 v[60:61], v[60:61], v[212:213]
v_pk_add_f32 v[62:63], v[62:63], v[214:215]
v_pk_add_f32 v[84:85], v[216:217], v[218:219]
v_pk_add_f32 v[86:87], v[220:221], v[222:223]
v_pk_fma_f32 v[244:245], v[244:245], v[150:151], v[110:111]
v_pk_fma_f32 v[246:247], v[246:247], v[150:151], v[110:111]
v_exp_f32 v240, v240
v_exp_f32 v241, v241
v_exp_f32 v242, v242
v_exp_f32 v243, v243
v_rcp_f32_e64 v36, v36
v_pk_add_f32 v[60:61], v[60:61], v[62:63]
v_pk_add_f32 v[84:85], v[84:85], v[224:225]
v_pk_add_f32 v[86:87], v[86:87], v[226:227]
v_exp_f32 v244, v244
v_exp_f32 v245, v245
v_exp_f32 v246, v246
v_exp_f32 v247, v247
v_add_f32_e64 v60, v60, v61
v_pk_add_f32 v[84:85], v[84:85], v[228:229]
v_pk_add_f32 v[86:87], v[86:87], v[230:231]
v_pk_add_f32 v[108:109], v[232:233], v[234:235]
v_pk_add_f32 v[110:111], v[236:237], v[238:239]
v_rcp_f32_e64 v60, v60
v_pk_add_f32 v[84:85], v[84:85], v[86:87]
v_pk_add_f32 v[108:109], v[108:109], v[240:241]
v_pk_add_f32 v[110:111], v[110:111], v[242:243]
v_mov_b32 v37, v36
v_add_f32 v84, v84, v85
v_pk_add_f32 v[108:109], v[108:109], v[244:245]
v_pk_add_f32 v[110:111], v[110:111], v[246:247]
v_cvt_pk_bf16_f32 v40, v40, v41
v_pk_mul_f32 v[184:185], v[184:185], v[36:37]
v_pk_mul_f32 v[186:187], v[186:187], v[36:37]
v_pk_mul_f32 v[188:189], v[188:189], v[36:37]
v_pk_mul_f32 v[190:191], v[190:191], v[36:37]
v_rcp_f32_e64 v84, v84
v_pk_add_f32 v[108:109], v[108:109], v[110:111]
v_cvt_pk_bf16_f32 v41, v42, v43
v_cvt_pk_bf16_f32 v48, v184, v185
v_cvt_pk_bf16_f32 v49, v186, v187
v_cvt_pk_bf16_f32 v50, v188, v189
v_cvt_pk_bf16_f32 v51, v190, v191
v_mov_b32 v61, v60
v_add_f32 v108, v108, v109
v_cvt_pk_bf16_f32 v42, v52, v53
v_cvt_pk_bf16_f32 v43, v54, v55
v_pk_mul_f32 v[192:193], v[192:193], v[36:37]
v_pk_mul_f32 v[194:195], v[194:195], v[36:37]
v_pk_mul_f32 v[196:197], v[196:197], v[36:37]
v_pk_mul_f32 v[198:199], v[198:199], v[36:37]
v_pk_mul_f32 v[200:201], v[200:201], v[60:61]
v_pk_mul_f32 v[202:203], v[202:203], v[60:61]
v_pk_mul_f32 v[204:205], v[204:205], v[60:61]
v_pk_mul_f32 v[206:207], v[206:207], v[60:61]
v_rcp_f32_e64 v108, v108
v_cvt_pk_bf16_f32 v52, v192, v193
v_cvt_pk_bf16_f32 v53, v194, v195
v_cvt_pk_bf16_f32 v54, v196, v197
v_cvt_pk_bf16_f32 v55, v198, v199
v_cvt_pk_bf16_f32 v72, v200, v201
v_cvt_pk_bf16_f32 v73, v202, v203
v_cvt_pk_bf16_f32 v74, v204, v205
v_cvt_pk_bf16_f32 v75, v206, v207
v_mov_b32_e64 v85, v84
v_mfma_f32_16x16x32_bf16 v[184:187], v[48:51], v[16:19], 0
v_cvt_pk_bf16_f32 v64, v64, v65
v_cvt_pk_bf16_f32 v65, v66, v67
v_mfma_f32_16x16x32_bf16 v[188:191], v[48:51], v[20:23], 0
v_mov_b32_e64 v109, v108
v_cvt_pk_bf16_f32 v66, v76, v77
v_pk_mul_f32 v[216:217], v[216:217], v[84:85]
v_pk_mul_f32 v[218:219], v[218:219], v[84:85]
v_pk_mul_f32 v[220:221], v[220:221], v[84:85]
v_pk_mul_f32 v[222:223], v[222:223], v[84:85]
v_cvt_pk_bf16_f32 v96, v216, v217
v_cvt_pk_bf16_f32 v97, v218, v219
v_cvt_pk_bf16_f32 v98, v220, v221
v_cvt_pk_bf16_f32 v99, v222, v223
v_mfma_f32_16x16x32_bf16 v[192:195], v[52:55], v[16:19], 0
v_cvt_pk_bf16_f32 v67, v78, v79
v_cvt_pk_bf16_f32 v88, v88, v89
v_mfma_f32_16x16x32_bf16 v[196:199], v[52:55], v[20:23], 0
v_cvt_pk_bf16_f32 v89, v90, v91
v_cvt_pk_bf16_f32 v90, v100, v101
v_pk_mul_f32 v[208:209], v[208:209], v[60:61]
v_pk_mul_f32 v[210:211], v[210:211], v[60:61]
v_pk_mul_f32 v[212:213], v[212:213], v[60:61]
v_pk_mul_f32 v[214:215], v[214:215], v[60:61]
v_mfma_f32_16x16x32_bf16 v[200:203], v[72:75], v[16:19], 0
v_cvt_pk_bf16_f32 v76, v208, v209
v_cvt_pk_bf16_f32 v77, v210, v211
v_mfma_f32_16x16x32_bf16 v[204:207], v[72:75], v[20:23], 0
v_cvt_pk_bf16_f32 v78, v212, v213
v_cvt_pk_bf16_f32 v79, v214, v215
v_pk_mul_f32 v[232:233], v[232:233], v[108:109]
v_pk_mul_f32 v[234:235], v[234:235], v[108:109]
v_pk_mul_f32 v[236:237], v[236:237], v[108:109]
v_pk_mul_f32 v[238:239], v[238:239], v[108:109]
v_cvt_pk_bf16_f32 v120, v232, v233
v_cvt_pk_bf16_f32 v121, v234, v235
v_cvt_pk_bf16_f32 v122, v236, v237
v_cvt_pk_bf16_f32 v123, v238, v239
v_cvt_pk_bf16_f32 v91, v102, v103
v_pk_mul_f32 v[224:225], v[224:225], v[84:85]
v_pk_mul_f32 v[226:227], v[226:227], v[84:85]
v_pk_mul_f32 v[228:229], v[228:229], v[84:85]
v_pk_mul_f32 v[230:231], v[230:231], v[84:85]
v_mfma_f32_16x16x32_bf16 v[216:219], v[96:99], v[16:19], 0
v_cvt_pk_bf16_f32 v112, v112, v113
v_cvt_pk_bf16_f32 v100, v224, v225
v_mfma_f32_16x16x32_bf16 v[220:223], v[96:99], v[20:23], 0
v_cvt_pk_bf16_f32 v101, v226, v227
v_cvt_pk_bf16_f32 v102, v228, v229
v_cvt_pk_bf16_f32 v103, v230, v231
v_cvt_pk_bf16_f32 v113, v114, v115
v_mfma_f32_16x16x32_bf16 v[208:211], v[76:79], v[16:19], 0
v_cvt_pk_bf16_f32 v114, v124, v125
v_cvt_pk_bf16_f32 v115, v126, v127
v_mfma_f32_16x16x32_bf16 v[212:215], v[76:79], v[20:23], 0
v_cvt_pk_bf16_f32 v48, v184, v185
v_cvt_pk_bf16_f32 v49, v186, v187
v_pk_mul_f32 v[240:241], v[240:241], v[108:109]
v_pk_mul_f32 v[242:243], v[242:243], v[108:109]
v_pk_mul_f32 v[244:245], v[244:245], v[108:109]
v_pk_mul_f32 v[246:247], v[246:247], v[108:109]
v_mfma_f32_16x16x32_bf16 v[232:235], v[120:123], v[16:19], 0
v_cvt_pk_bf16_f32 v124, v240, v241
v_cvt_pk_bf16_f32 v125, v242, v243
v_mfma_f32_16x16x32_bf16 v[236:239], v[120:123], v[20:23], 0
v_cvt_pk_bf16_f32 v126, v244, v245
v_cvt_pk_bf16_f32 v127, v246, v247
v_mfma_f32_16x16x32_bf16 v[224:227], v[100:103], v[16:19], 0
v_cvt_pk_bf16_f32 v50, v188, v189
v_cvt_pk_bf16_f32 v51, v190, v191
v_mfma_f32_16x16x32_bf16 v[228:231], v[100:103], v[20:23], 0
v_cvt_pk_bf16_f32 v52, v192, v193
v_cvt_pk_bf16_f32 v53, v194, v195
v_mfma_f32_16x16x32_bf16 v[240:243], v[124:127], v[16:19], 0
v_cvt_pk_bf16_f32 v54, v196, v197
v_cvt_pk_bf16_f32 v55, v198, v199
v_mfma_f32_16x16x32_bf16 v[244:247], v[124:127], v[20:23], 0
v_cvt_pk_bf16_f32 v72, v200, v201
v_cvt_pk_bf16_f32 v73, v202, v203
v_cvt_pk_bf16_f32 v74, v204, v205
v_cvt_pk_bf16_f32 v75, v206, v207
v_mfma_f32_16x16x32_bf16 v[160:163], v[40:43], v[48:51], 0
v_cvt_pk_bf16_f32 v96, v216, v217
v_cvt_pk_bf16_f32 v97, v218, v219
v_mfma_f32_16x16x32_bf16 v[168:171], v[24:27], v[48:51], 0
v_cvt_pk_bf16_f32 v98, v220, v221
v_cvt_pk_bf16_f32 v99, v222, v223
v_mfma_f32_16x16x32_bf16 v[168:171], v[28:31], v[52:55], v[168:171]
v_cvt_pk_bf16_f32 v76, v208, v209
v_cvt_pk_bf16_f32 v77, v210, v211
v_mfma_f32_16x16x32_bf16 v[160:163], v[64:67], v[72:75], v[160:163]
v_cvt_pk_bf16_f32 v78, v212, v213
v_cvt_pk_bf16_f32 v79, v214, v215
v_cvt_pk_bf16_f32 v120, v232, v233
v_cvt_pk_bf16_f32 v121, v234, v235
v_cvt_pk_bf16_f32 v122, v236, v237
v_cvt_pk_bf16_f32 v123, v238, v239
v_mfma_f32_16x16x32_bf16 v[164:167], v[40:43], v[52:55], 0
v_cvt_pk_bf16_f32 v100, v224, v225
v_cvt_pk_bf16_f32 v101, v226, v227
v_mfma_f32_16x16x32_bf16 v[168:171], v[24:27], v[72:75], v[168:171]
v_cvt_pk_bf16_f32 v102, v228, v229
v_cvt_pk_bf16_f32 v103, v230, v231
v_mfma_f32_16x16x32_bf16 v[160:163], v[88:91], v[96:99], v[160:163]
v_cvt_pk_bf16_f32 v124, v240, v241
v_cvt_pk_bf16_f32 v125, v242, v243
v_mfma_f32_16x16x32_bf16 v[164:167], v[64:67], v[76:79], v[164:167]
v_cvt_pk_bf16_f32 v126, v244, v245
v_cvt_pk_bf16_f32 v127, v246, v247
v_mfma_f32_16x16x32_bf16 v[168:171], v[28:31], v[76:79], v[168:171]
v_and_b32 v175, 15, v1
v_lshrrev_b32 v176, 4, v1
v_mfma_f32_16x16x32_bf16 v[160:163], v[112:115], v[120:123], v[160:163]
v_lshlrev_b32_e64 v175, 2, v175
v_lshl_add_u32 v172, v176, 8, v175
v_mfma_f32_16x16x32_bf16 v[164:167], v[88:91], v[100:103], v[164:167]
v_mul_u32_u24 v173, 1088, v176
v_add_u32 v173, v173, v175
v_mfma_f32_16x16x32_bf16 v[168:171], v[24:27], v[96:99], v[168:171]
v_lshrrev_b32 v176, 1, v176
v_lshl_add_u32 v173, v176, 27, v173
buffer_atomic_add_f32 v160, v172, s[16:19], s68 offen offset:0 sc1
buffer_atomic_add_f32 v161, v172, s[16:19], s68 offen offset:64 sc1
buffer_atomic_add_f32 v162, v172, s[16:19], s68 offen offset:128 sc1
buffer_atomic_add_f32 v163, v172, s[16:19], s68 offen offset:192 sc1
v_mfma_f32_16x16x32_bf16 v[168:171], v[28:31], v[100:103], v[168:171]
v_lshlrev_b32 v181, 26, v1
v_mov_b32 v182, s50
v_mfma_f32_16x16x32_bf16 v[164:167], v[112:115], v[124:127], v[164:167]
v_mfma_f32_16x16x32_bf16 v[168:171], v[24:27], v[120:123], v[168:171]
v_mfma_f32_16x16x32_bf16 v[168:171], v[28:31], v[124:127], v[168:171]
s_nop 0
s_nop 4
buffer_atomic_add_f32 v164, v172, s[16:19], s68 offen offset:1088 sc1
buffer_atomic_add_f32 v165, v172, s[16:19], s68 offen offset:1152 sc1
buffer_atomic_add_f32 v166, v172, s[16:19], s68 offen offset:1216 sc1
buffer_atomic_add_f32 v167, v172, s[16:19], s68 offen offset:1280 sc1
buffer_atomic_add_f32 v168, v173, s[16:19], s68 offen offset:1024 sc1
v_pk_fma_f32 v[32:33], v[156:157], v[128:129], v[32:33]
v_pk_fma_f32 v[56:57], v[156:157], v[132:133], v[56:57]
v_pk_fma_f32 v[34:35], v[158:159], v[128:129], v[34:35]
v_cvt_pk_bf16_f32 v32, v32, v33
v_pk_fma_f32 v[58:59], v[158:159], v[132:133], v[58:59]
v_cvt_pk_bf16_f32 v56, v56, v57
v_pk_fma_f32 v[44:45], v[156:157], v[130:131], v[44:45]
v_pk_fma_f32 v[46:47], v[158:159], v[130:131], v[46:47]
v_cvt_pk_bf16_f32 v33, v34, v35
v_pk_fma_f32 v[68:69], v[156:157], v[134:135], v[68:69]
v_pk_fma_f32 v[70:71], v[158:159], v[134:135], v[70:71]
v_cvt_pk_bf16_f32 v57, v58, v59
v_cvt_pk_bf16_f32 v34, v44, v45
v_cvt_pk_bf16_f32 v35, v46, v47
v_cvt_pk_bf16_f32 v58, v68, v69
v_cvt_pk_bf16_f32 v59, v70, v71
v_permlane16_swap_b32 v32, v34
v_permlane16_swap_b32 v33, v35
v_permlane16_swap_b32 v56, v58
v_permlane16_swap_b32 v57, v59
v_mfma_f32_32x32x16_bf16 v[184:199], v[4:7], v[32:35], 0
v_and_b32_e64 v180, 15, v1
v_bfe_u32 v175, v1, 4, 1
v_lshlrev_b32 v180, 4, v180
v_and_b32 v179, 31, v1
v_lshl_add_u32 v180, v175, 14, v180
v_min_u32 v179, 16, v179
v_mfma_f32_32x32x16_bf16 v[200:215], v[4:7], v[56:59], 0
v_lshrrev_b32 v175, 5, v1
v_lshlrev_b32_e64 v179, 6, v179
v_lshl_add_u32 v180, v175, 8, v180
v_lshl_add_u32 v179, v175, 5, v179
s_nop 0
s_nop 0
v_max3_f32 v32, v184, v185, v186
v_max3_f32 v33, v187, v188, v189
v_max3_f32 v32, v32, v190, v191
v_max3_f32 v33, v33, v192, v193
v_max3_f32 v32, v32, v194, v195
v_max3_f32 v33, v33, v196, v197
v_max3_f32 v32, v32, v198, v199
v_max3_f32 v56, v200, v201, v202
v_max3_f32 v57, v203, v204, v205
v_max3_f32 v56, v56, v206, v207
v_max3_f32 v57, v57, v208, v209
v_max3_f32 v56, v56, v210, v211
v_max3_f32 v57, v57, v212, v213
v_max3_f32 v56, v56, v214, v215
v_max_f32 v32, v32, v33
v_max_f32 v56, v56, v57
v_mul_f32_e64 v34, -v32, v144
v_mul_f32_e64 v35, -v32, v144
v_mul_f32_e64 v58, -v56, v146
v_mul_f32_e64 v59, -v56, v146
v_pk_fma_f32 v[184:185], v[184:185], v[144:145], v[34:35]
v_pk_fma_f32 v[186:187], v[186:187], v[144:145], v[34:35]
v_pk_fma_f32 v[188:189], v[188:189], v[144:145], v[34:35]
v_pk_fma_f32 v[190:191], v[190:191], v[144:145], v[34:35]
v_pk_fma_f32 v[200:201], v[200:201], v[146:147], v[58:59]
v_pk_fma_f32 v[202:203], v[202:203], v[146:147], v[58:59]
WS_A2:
WS_6775:
s_cbranch_execz WS_7392
s_nop 0
v_pk_fma_f32 v[204:205], v[204:205], v[146:147], v[58:59]
v_pk_fma_f32 v[206:207], v[206:207], v[146:147], v[58:59]
v_pk_fma_f32 v[192:193], v[192:193], v[144:145], v[34:35]
v_pk_fma_f32 v[194:195], v[194:195], v[144:145], v[34:35]
v_exp_f32 v184, v184
v_exp_f32 v185, v185
v_exp_f32 v186, v186
v_exp_f32 v187, v187
v_exp_f32 v188, v188
v_exp_f32 v189, v189
v_exp_f32 v190, v190
v_exp_f32 v191, v191
v_pk_fma_f32 v[208:209], v[208:209], v[146:147], v[58:59]
v_pk_fma_f32 v[210:211], v[210:211], v[146:147], v[58:59]
v_exp_f32 v200, v200
v_exp_f32 v201, v201
v_exp_f32 v202, v202
v_exp_f32 v203, v203
v_exp_f32 v204, v204
v_exp_f32 v205, v205
v_exp_f32 v206, v206
v_exp_f32 v207, v207
v_pk_fma_f32 v[196:197], v[196:197], v[144:145], v[34:35]
v_pk_fma_f32 v[198:199], v[198:199], v[144:145], v[34:35]
v_exp_f32 v192, v192
v_exp_f32 v193, v193
v_exp_f32 v194, v194
v_exp_f32 v195, v195
v_pk_fma_f32 v[212:213], v[212:213], v[146:147], v[58:59]
v_pk_fma_f32 v[214:215], v[214:215], v[146:147], v[58:59]
v_exp_f32 v208, v208
v_exp_f32 v209, v209
v_exp_f32 v210, v210
v_exp_f32 v211, v211
v_exp_f32 v196, v196
v_exp_f32 v197, v197
v_exp_f32 v198, v198
v_exp_f32 v199, v199
v_exp_f32 v212, v212
v_exp_f32 v213, v213
v_exp_f32 v214, v214
v_exp_f32 v215, v215
v_pk_add_f32 v[32:33], v[184:185], v[186:187]
v_pk_add_f32 v[34:35], v[188:189], v[190:191]
v_pk_add_f32 v[56:57], v[200:201], v[202:203]
v_pk_add_f32 v[58:59], v[204:205], v[206:207]
v_pk_add_f32 v[32:33], v[32:33], v[192:193]
v_pk_add_f32 v[34:35], v[34:35], v[194:195]
v_pk_add_f32 v[56:57], v[56:57], v[208:209]
v_pk_add_f32 v[58:59], v[58:59], v[210:211]
v_pk_add_f32 v[32:33], v[32:33], v[196:197]
v_pk_add_f32 v[34:35], v[34:35], v[198:199]
v_pk_add_f32 v[56:57], v[56:57], v[212:213]
v_pk_add_f32 v[58:59], v[58:59], v[214:215]
v_pk_add_f32 v[32:33], v[32:33], v[34:35]
v_pk_add_f32 v[56:57], v[56:57], v[58:59]
v_add_f32 v32, v32, v33
v_add_f32 v56, v56, v57
v_rcp_f32 v32, v32
v_rcp_f32 v56, v56
v_mov_b32 v33, v32
v_mov_b32 v57, v56
v_pk_mul_f32 v[184:185], v[184:185], v[32:33]
v_pk_mul_f32 v[186:187], v[186:187], v[32:33]
v_pk_mul_f32 v[188:189], v[188:189], v[32:33]
v_pk_mul_f32 v[190:191], v[190:191], v[32:33]
v_pk_mul_f32 v[192:193], v[192:193], v[32:33]
v_pk_mul_f32 v[194:195], v[194:195], v[32:33]
v_pk_mul_f32 v[196:197], v[196:197], v[32:33]
v_pk_mul_f32 v[198:199], v[198:199], v[32:33]
v_pk_mul_f32 v[200:201], v[200:201], v[56:57]
v_pk_mul_f32 v[202:203], v[202:203], v[56:57]
v_pk_mul_f32 v[204:205], v[204:205], v[56:57]
v_pk_mul_f32 v[206:207], v[206:207], v[56:57]
v_pk_mul_f32 v[208:209], v[208:209], v[56:57]
v_pk_mul_f32 v[210:211], v[210:211], v[56:57]
v_pk_mul_f32 v[212:213], v[212:213], v[56:57]
v_pk_mul_f32 v[214:215], v[214:215], v[56:57]
v_cvt_pk_bf16_f32 v44, v184, v185
v_cvt_pk_bf16_f32 v45, v186, v187
v_cvt_pk_bf16_f32 v46, v188, v189
v_cvt_pk_bf16_f32 v47, v190, v191
v_cvt_pk_bf16_f32 v36, v192, v193
v_cvt_pk_bf16_f32 v37, v194, v195
v_cvt_pk_bf16_f32 v38, v196, v197
v_cvt_pk_bf16_f32 v39, v198, v199
v_cvt_pk_bf16_f32 v68, v200, v201
v_cvt_pk_bf16_f32 v69, v202, v203
v_cvt_pk_bf16_f32 v70, v204, v205
v_cvt_pk_bf16_f32 v71, v206, v207
v_cvt_pk_bf16_f32 v60, v208, v209
v_cvt_pk_bf16_f32 v61, v210, v211
v_cvt_pk_bf16_f32 v62, v212, v213
v_cvt_pk_bf16_f32 v63, v214, v215
s_waitcnt vmcnt(0)
s_nop 0
s_atomic_add s60, s[16:17], s46 offset:0
s_add_u32 s66, s98, 32768
s_add_u32 s67, s98, 294912
s_add_u32 s69, s67, 32768
v_pk_fma_f32 v[80:81], v[156:157], v[136:137], v[80:81]
v_pk_fma_f32 v[82:83], v[158:159], v[136:137], v[82:83]
v_cvt_pk_bf16_f32 v80, v80, v81
v_pk_fma_f32 v[92:93], v[156:157], v[138:139], v[92:93]
v_pk_fma_f32 v[94:95], v[158:159], v[138:139], v[94:95]
v_cvt_pk_bf16_f32 v81, v82, v83
v_cvt_pk_bf16_f32 v82, v92, v93
v_cvt_pk_bf16_f32 v83, v94, v95
s_nop 0
v_permlane16_swap_b32 v80, v82
v_permlane16_swap_b32 v81, v83
s_nop 1
v_mfma_f32_32x32x16_bf16 v[216:231], v[4:7], v[80:83], 0
s_nop 0
s_nop 10
v_max3_f32 v80, v216, v217, v218
v_max3_f32 v81, v219, v220, v221
v_max3_f32 v80, v80, v222, v223
v_max3_f32 v81, v81, v224, v225
v_max3_f32 v80, v80, v226, v227
v_max3_f32 v81, v81, v228, v229
v_max3_f32 v80, v80, v230, v231
v_max_f32_e64 v80, v80, v81
v_mul_f32_e64 v82, -v80, v148
v_mul_f32_e64 v83, -v80, v148
v_pk_fma_f32 v[216:217], v[216:217], v[148:149], v[82:83]
v_pk_fma_f32 v[218:219], v[218:219], v[148:149], v[82:83]
v_pk_fma_f32 v[220:221], v[220:221], v[148:149], v[82:83]
v_pk_fma_f32 v[222:223], v[222:223], v[148:149], v[82:83]
v_pk_fma_f32 v[224:225], v[224:225], v[148:149], v[82:83]
v_pk_fma_f32 v[226:227], v[226:227], v[148:149], v[82:83]
v_exp_f32 v216, v216
v_exp_f32 v217, v217
v_exp_f32 v218, v218
v_exp_f32 v219, v219
v_exp_f32 v220, v220
v_exp_f32 v221, v221
v_exp_f32 v222, v222
v_exp_f32 v223, v223
v_pk_fma_f32 v[228:229], v[228:229], v[148:149], v[82:83]
v_pk_fma_f32 v[230:231], v[230:231], v[148:149], v[82:83]
v_exp_f32 v224, v224
v_exp_f32 v225, v225
v_exp_f32 v226, v226
v_exp_f32 v227, v227
v_exp_f32 v228, v228
v_exp_f32 v229, v229
v_exp_f32 v230, v230
v_exp_f32 v231, v231
v_pk_add_f32 v[80:81], v[216:217], v[218:219]
v_pk_add_f32 v[82:83], v[220:221], v[222:223]
v_pk_add_f32 v[80:81], v[80:81], v[224:225]
v_pk_add_f32 v[82:83], v[82:83], v[226:227]
v_pk_add_f32 v[80:81], v[80:81], v[228:229]
v_pk_add_f32 v[82:83], v[82:83], v[230:231]
v_pk_add_f32 v[80:81], v[80:81], v[82:83]
v_add_f32 v80, v80, v81
v_rcp_f32 v80, v80
s_nop 0
v_mov_b32 v81, v80
v_pk_mul_f32 v[216:217], v[216:217], v[80:81]
v_pk_mul_f32 v[218:219], v[218:219], v[80:81]
v_pk_mul_f32 v[220:221], v[220:221], v[80:81]
v_pk_mul_f32 v[222:223], v[222:223], v[80:81]
v_pk_mul_f32 v[224:225], v[224:225], v[80:81]
v_pk_mul_f32 v[226:227], v[226:227], v[80:81]
v_pk_mul_f32 v[228:229], v[228:229], v[80:81]
v_pk_mul_f32 v[230:231], v[230:231], v[80:81]
v_cvt_pk_bf16_f32 v92, v216, v217
v_cvt_pk_bf16_f32 v93, v218, v219
v_cvt_pk_bf16_f32 v94, v220, v221
v_cvt_pk_bf16_f32 v95, v222, v223
v_cvt_pk_bf16_f32 v84, v224, v225
v_cvt_pk_bf16_f32 v85, v226, v227
v_cvt_pk_bf16_f32 v86, v228, v229
v_cvt_pk_bf16_f32 v87, v230, v231
s_add_u32 s42, s50, 16
s_mov_b32 s51, 400000
SP_40:
s_mov_b32 s41, 0
s_atomic_add s41, s[16:17], s43 glc
s_waitcnt lgkmcnt(0)
s_cmp_eq_u32 s41, s42
s_cbranch_scc1 SD_41
s_sub_u32 s51, s51, 1
s_cbranch_scc0 SP_40
s_nop 0
SD_41:
buffer_load_dwordx4 v[16:19], v179, s[16:19], s68 offen offset:0 sc1
buffer_load_dwordx4 v[20:23], v179, s[16:19], s68 offen offset:16 sc1
buffer_load_dwordx4 v[24:27], v179, s[16:19], s68 offen offset:1088 sc1
buffer_load_dwordx4 v[28:31], v179, s[16:19], s68 offen offset:1104 sc1
buffer_store_dword v182, v181, s[16:19], s100 offen sc1
v_pk_fma_f32 v[104:105], v[156:157], v[140:141], v[104:105]
v_pk_fma_f32 v[106:107], v[158:159], v[140:141], v[106:107]
v_cvt_pk_bf16_f32 v104, v104, v105
v_pk_fma_f32 v[116:117], v[156:157], v[142:143], v[116:117]
v_pk_fma_f32 v[118:119], v[158:159], v[142:143], v[118:119]
v_cvt_pk_bf16_f32 v105, v106, v107
v_cvt_pk_bf16_f32 v106, v116, v117
v_cvt_pk_bf16_f32 v107, v118, v119
s_nop 0
v_permlane16_swap_b32 v104, v106
v_permlane16_swap_b32 v105, v107
s_nop 1
v_mfma_f32_32x32x16_bf16 v[232:247], v[4:7], v[104:107], 0
s_nop 0
s_nop 10
v_max3_f32 v104, v232, v233, v234
v_max3_f32 v105, v235, v236, v237
v_max3_f32 v104, v104, v238, v239
v_max3_f32 v105, v105, v240, v241
v_max3_f32 v104, v104, v242, v243
v_max3_f32 v105, v105, v244, v245
v_max3_f32 v104, v104, v246, v247
v_max_f32_e64 v104, v104, v105
v_mul_f32_e64 v106, -v104, v150
v_mul_f32_e64 v107, -v104, v150
v_pk_fma_f32 v[232:233], v[232:233], v[150:151], v[106:107]
v_pk_fma_f32 v[234:235], v[234:235], v[150:151], v[106:107]
v_pk_fma_f32 v[236:237], v[236:237], v[150:151], v[106:107]
v_pk_fma_f32 v[238:239], v[238:239], v[150:151], v[106:107]
v_pk_fma_f32 v[240:241], v[240:241], v[150:151], v[106:107]
v_pk_fma_f32 v[242:243], v[242:243], v[150:151], v[106:107]
v_exp_f32 v232, v232
v_exp_f32 v233, v233
v_exp_f32 v234, v234
v_exp_f32 v235, v235
v_exp_f32 v236, v236
v_exp_f32 v237, v237
v_exp_f32 v238, v238
v_exp_f32 v239, v239
v_pk_fma_f32 v[244:245], v[244:245], v[150:151], v[106:107]
v_pk_fma_f32 v[246:247], v[246:247], v[150:151], v[106:107]
v_exp_f32 v240, v240
v_exp_f32 v241, v241
v_exp_f32 v242, v242
v_exp_f32 v243, v243
v_exp_f32 v244, v244
v_exp_f32 v245, v245
v_exp_f32 v246, v246
v_exp_f32 v247, v247
v_pk_add_f32 v[104:105], v[232:233], v[234:235]
v_pk_add_f32 v[106:107], v[236:237], v[238:239]
v_pk_add_f32 v[104:105], v[104:105], v[240:241]
v_pk_add_f32 v[106:107], v[106:107], v[242:243]
v_pk_add_f32 v[104:105], v[104:105], v[244:245]
v_pk_add_f32 v[106:107], v[106:107], v[246:247]
v_pk_add_f32 v[104:105], v[104:105], v[106:107]
v_add_f32 v104, v104, v105
v_rcp_f32 v104, v104
s_nop 0
v_mov_b32 v105, v104
v_pk_mul_f32 v[232:233], v[232:233], v[104:105]
v_pk_mul_f32 v[234:235], v[234:235], v[104:105]
v_pk_mul_f32 v[236:237], v[236:237], v[104:105]
v_pk_mul_f32 v[238:239], v[238:239], v[104:105]
v_pk_mul_f32 v[240:241], v[240:241], v[104:105]
v_pk_mul_f32 v[242:243], v[242:243], v[104:105]
v_pk_mul_f32 v[244:245], v[244:245], v[104:105]
v_pk_mul_f32 v[246:247], v[246:247], v[104:105]
v_cvt_pk_bf16_f32 v116, v232, v233
v_cvt_pk_bf16_f32 v117, v234, v235
v_cvt_pk_bf16_f32 v118, v236, v237
v_cvt_pk_bf16_f32 v119, v238, v239
v_cvt_pk_bf16_f32 v108, v240, v241
v_cvt_pk_bf16_f32 v109, v242, v243
v_cvt_pk_bf16_f32 v110, v244, v245
v_cvt_pk_bf16_f32 v111, v246, v247
s_waitcnt vmcnt(1)
s_nop 0
v_cvt_pk_bf16_f32 v160, v16, v17
v_cvt_pk_bf16_f32 v161, v18, v19
v_cvt_pk_bf16_f32 v162, v20, v21
v_cvt_pk_bf16_f32 v163, v22, v23
v_cvt_pk_bf16_f32 v164, v24, v25
v_cvt_pk_bf16_f32 v165, v26, v27
v_cvt_pk_bf16_f32 v166, v28, v29
v_cvt_pk_bf16_f32 v167, v30, v31
v_mfma_f32_32x32x16_bf16 v[184:199], v[160:163], v[44:47], 0
v_mfma_f32_32x32x16_bf16 v[200:215], v[160:163], v[68:71], 0
v_mfma_f32_32x32x16_bf16 v[184:199], v[164:167], v[36:39], v[184:199]
v_mfma_f32_32x32x16_bf16 v[216:231], v[160:163], v[92:95], 0
v_mfma_f32_32x32x16_bf16 v[200:215], v[164:167], v[60:63], v[200:215]
v_mfma_f32_32x32x16_bf16 v[232:247], v[160:163], v[116:119], 0
v_mfma_f32_32x32x16_bf16 v[216:231], v[164:167], v[84:87], v[216:231]
v_mfma_f32_32x32x16_bf16 v[232:247], v[164:167], v[108:111], v[232:247]
s_nop 0
s_nop 5
v_add_f32 v192, 0x358637bd, v192
v_rcp_f32_e64 v192, v192
v_add_f32 v208, 0x358637bd, v208
v_rcp_f32_e64 v208, v208
v_add_f32 v224, 0x358637bd, v224
v_rcp_f32_e64 v224, v224
v_add_f32 v240, 0x358637bd, v240
v_mov_b32 v193, v192
v_rcp_f32 v240, v240
v_pk_mul_f32 v[184:185], v[184:185], v[192:193]
v_pk_mul_f32 v[186:187], v[186:187], v[192:193]
v_pk_mul_f32 v[188:189], v[188:189], v[192:193]
v_pk_mul_f32 v[190:191], v[190:191], v[192:193]
v_mov_b32_e64 v209, v208
v_cvt_pk_bf16_f32 v40, v184, v185
v_cvt_pk_bf16_f32 v41, v186, v187
v_cvt_pk_bf16_f32 v42, v188, v189
v_cvt_pk_bf16_f32 v43, v190, v191
buffer_store_dwordx4 v[40:43], v180, s[16:19], s98 offen sc1
v_pk_mul_f32 v[200:201], v[200:201], v[208:209]
v_pk_mul_f32 v[202:203], v[202:203], v[208:209]
v_pk_mul_f32 v[204:205], v[204:205], v[208:209]
v_pk_mul_f32 v[206:207], v[206:207], v[208:209]
v_mov_b32_e64 v225, v224
v_cvt_pk_bf16_f32 v64, v200, v201
v_cvt_pk_bf16_f32 v65, v202, v203
v_cvt_pk_bf16_f32 v66, v204, v205
v_cvt_pk_bf16_f32 v67, v206, v207
buffer_store_dwordx4 v[64:67], v180, s[16:19], s66 offen sc1
v_pk_mul_f32 v[216:217], v[216:217], v[224:225]
v_pk_mul_f32 v[218:219], v[218:219], v[224:225]
v_pk_mul_f32 v[220:221], v[220:221], v[224:225]
v_pk_mul_f32 v[222:223], v[222:223], v[224:225]
v_mov_b32_e64 v241, v240
v_cvt_pk_bf16_f32 v88, v216, v217
v_cvt_pk_bf16_f32 v89, v218, v219
v_cvt_pk_bf16_f32 v90, v220, v221
v_cvt_pk_bf16_f32 v91, v222, v223
buffer_store_dwordx4 v[88:91], v180, s[16:19], s67 offen sc1
v_pk_mul_f32 v[232:233], v[232:233], v[240:241]
v_pk_mul_f32 v[234:235], v[234:235], v[240:241]
v_pk_mul_f32 v[236:237], v[236:237], v[240:241]
v_pk_mul_f32 v[238:239], v[238:239], v[240:241]
v_cvt_pk_bf16_f32 v112, v232, v233
v_cvt_pk_bf16_f32 v113, v234, v235
v_cvt_pk_bf16_f32 v114, v236, v237
v_cvt_pk_bf16_f32 v115, v238, v239
buffer_store_dwordx4 v[112:115], v180, s[16:19], s69 offen sc1
s_waitcnt vmcnt(0)
s_atomic_add s60, s[16:17], s99 offset:0
s_atomic_add s60, s[16:17], s48 offset:0
K_C2:
WS_7116:
s_cbranch_execz K_wret
s_nop 0
v_and_b32 v10, 15, v1
v_lshlrev_b32_e64 v8, 10, v10
v_bfe_u32 v10, v1, 4, 1
v_lshl_add_u32 v8, v10, 5, v8
v_lshrrev_b32_e64 v10, 5, v1
v_lshl_add_u32 v8, v10, 4, v8
s_lshl_b32 s66, s52, 16
s_lshl_b32 s41, s39, 14
s_add_u32 s66, s66, s41
s_lshl_b32 s42, s53, 7
s_add_u32 s66, s66, s42
buffer_load_dwordx4 v[16:19], v8, s[8:11], s66 offen offset:0
buffer_load_dwordx4 v[20:23], v8, s[8:11], s66 offen offset:64
s_mul_i32 s67, s52, 294912
s_add_u32 s67, s67, s41
s_add_u32 s67, s67, 1277952
s_add_u32 s68, s67, 4096
s_add_u32 s69, s67, 8192
s_add_u32 s70, s67, 12288
s_lshr_b32 s71, s52, 1
s_lshl_b32 s71, s71, 14
s_and_b32 s4, s52, 1
s_lshl_b32 s4, s4, 11
s_add_u32 s71, s71, s4
s_add_u32 s71, s71, 529408
v_lshrrev_b32 v10, 2, v1
v_lshlrev_b32 v10, 7, v10
v_and_b32 v11, 3, v1
v_lshl_add_u32 v10, v11, 3, v10
v_add_u32 v10, 32768, v10
v_bfe_u32 v11, v1, 3, 2
v_xor_b32_e64 v4, 0, v11
v_lshl_add_u32 v4, v4, 5, v10
v_xor_b32_e64 v5, 1, v11
v_lshl_add_u32 v5, v5, 5, v10
v_xor_b32_e64 v6, 2, v11
v_lshl_add_u32 v6, v6, 5, v10
v_xor_b32_e64 v7, 3, v11
v_lshl_add_u32 v7, v7, 5, v10
v_mov_b32 v9, 154112
s_cmp_lg_u32 s38, 0
s_cbranch_scc1 EP_43
s_add_u32 s42, s50, 32
s_mov_b32 s51, 400000
EO_42:
s_mov_b32 s41, 0
s_atomic_add s41, s[16:17], s71 glc
s_waitcnt lgkmcnt(0)
ds_read_b32 v10, v9 offset:4
s_cmp_eq_u32 s41, s42
s_cbranch_scc1 EQ_44
s_waitcnt lgkmcnt(0)
v_readfirstlane_b32 s41, v10
s_nop 0
s_cmp_ge_u32 s41, 4
s_cbranch_scc1 EP_43
s_sleep 4
s_sub_u32 s51, s51, 1
s_cbranch_scc0 EO_42
s_branch EP_43
EQ_44:
s_mov_b32 s38, 8
v_mov_b32 v12, 16
s_mov_b64 exec, 1
ds_add_u32 v9, v12 offset:12
s_mov_b64 exec, -1
EP_43:
s_mov_b32 s51, 1600000
LS_45:
ds_read_b32 v10, v9 offset:4
s_waitcnt lgkmcnt(0)
v_readfirstlane_b32 s41, v10
s_nop 0
s_cmp_ge_u32 s41, 4
s_cbranch_scc1 LD_46
s_sleep 4
s_sub_u32 s51, s51, 1
s_cbranch_scc0 LS_45
LD_46:
ds_read_b64_tr_b16 v[104:105], v4 offset:0
ds_read_b64_tr_b16 v[106:107], v4 offset:2048
ds_read_b64_tr_b16 v[108:109], v5 offset:0
ds_read_b64_tr_b16 v[110:111], v5 offset:2048
ds_read_b64_tr_b16 v[112:113], v6 offset:0
ds_read_b64_tr_b16 v[114:115], v6 offset:2048
ds_read_b64_tr_b16 v[116:117], v7 offset:0
ds_read_b64_tr_b16 v[118:119], v7 offset:2048
ds_read_b64_tr_b16 v[120:121], v4 offset:4096
ds_read_b64_tr_b16 v[122:123], v4 offset:6144
ds_read_b64_tr_b16 v[124:125], v5 offset:4096
ds_read_b64_tr_b16 v[126:127], v5 offset:6144
ds_read_b64_tr_b16 v[128:129], v6 offset:4096
ds_read_b64_tr_b16 v[130:131], v6 offset:6144
ds_read_b64_tr_b16 v[132:133], v7 offset:4096
ds_read_b64_tr_b16 v[134:135], v7 offset:6144
ds_read_b64_tr_b16 v[136:137], v4 offset:8192
ds_read_b64_tr_b16 v[138:139], v4 offset:10240
ds_read_b64_tr_b16 v[140:141], v5 offset:8192
ds_read_b64_tr_b16 v[142:143], v5 offset:10240
ds_read_b64_tr_b16 v[144:145], v6 offset:8192
ds_read_b64_tr_b16 v[146:147], v6 offset:10240
ds_read_b64_tr_b16 v[148:149], v7 offset:8192
ds_read_b64_tr_b16 v[150:151], v7 offset:10240
ds_read_b64_tr_b16 v[152:153], v4 offset:12288
ds_read_b64_tr_b16 v[154:155], v4 offset:14336
ds_read_b64_tr_b16 v[156:157], v5 offset:12288
ds_read_b64_tr_b16 v[158:159], v5 offset:14336
ds_read_b64_tr_b16 v[160:161], v6 offset:12288
ds_read_b64_tr_b16 v[162:163], v6 offset:14336
ds_read_b64_tr_b16 v[164:165], v7 offset:12288
ds_read_b64_tr_b16 v[166:167], v7 offset:14336
ds_read_b64_tr_b16 v[168:169], v4 offset:16384
ds_read_b64_tr_b16 v[170:171], v4 offset:18432
ds_read_b64_tr_b16 v[172:173], v5 offset:16384
ds_read_b64_tr_b16 v[174:175], v5 offset:18432
ds_read_b64_tr_b16 v[176:177], v6 offset:16384
ds_read_b64_tr_b16 v[178:179], v6 offset:18432
ds_read_b64_tr_b16 v[180:181], v7 offset:16384
ds_read_b64_tr_b16 v[182:183], v7 offset:18432
ds_read_b64_tr_b16 v[184:185], v4 offset:20480
ds_read_b64_tr_b16 v[186:187], v4 offset:22528
ds_read_b64_tr_b16 v[188:189], v5 offset:20480
ds_read_b64_tr_b16 v[190:191], v5 offset:22528
ds_read_b64_tr_b16 v[192:193], v6 offset:20480
ds_read_b64_tr_b16 v[194:195], v6 offset:22528
ds_read_b64_tr_b16 v[196:197], v7 offset:20480
ds_read_b64_tr_b16 v[198:199], v7 offset:22528
ds_read_b64_tr_b16 v[200:201], v4 offset:24576
ds_read_b64_tr_b16 v[202:203], v4 offset:26624
ds_read_b64_tr_b16 v[204:205], v5 offset:24576
ds_read_b64_tr_b16 v[206:207], v5 offset:26624
ds_read_b64_tr_b16 v[208:209], v6 offset:24576
ds_read_b64_tr_b16 v[210:211], v6 offset:26624
ds_read_b64_tr_b16 v[212:213], v7 offset:24576
ds_read_b64_tr_b16 v[214:215], v7 offset:26624
ds_read_b64_tr_b16 v[216:217], v4 offset:28672
ds_read_b64_tr_b16 v[218:219], v4 offset:30720
ds_read_b64_tr_b16 v[220:221], v5 offset:28672
ds_read_b64_tr_b16 v[222:223], v5 offset:30720
ds_read_b64_tr_b16 v[224:225], v6 offset:28672
ds_read_b64_tr_b16 v[226:227], v6 offset:30720
ds_read_b64_tr_b16 v[228:229], v7 offset:28672
ds_read_b64_tr_b16 v[230:231], v7 offset:30720
ds_read_b64_tr_b16 v[232:233], v4 offset:32768
ds_read_b64_tr_b16 v[234:235], v4 offset:34816
ds_read_b64_tr_b16 v[236:237], v5 offset:32768
ds_read_b64_tr_b16 v[238:239], v5 offset:34816
ds_read_b64_tr_b16 v[240:241], v6 offset:32768
ds_read_b64_tr_b16 v[242:243], v6 offset:34816
ds_read_b64_tr_b16 v[244:245], v7 offset:32768
ds_read_b64_tr_b16 v[246:247], v7 offset:34816
s_cmp_lg_u32 s38, 0
s_cbranch_scc1 NO_47
s_add_u32 s42, s50, 32
s_mov_b32 s51, 400000
SP_49:
s_mov_b32 s41, 0
s_atomic_add s41, s[16:17], s71 glc
s_waitcnt lgkmcnt(0)
s_cmp_eq_u32 s41, s42
s_cbranch_scc1 SD_50
s_sleep 4
s_sub_u32 s51, s51, 1
s_cbranch_scc0 SP_49
SD_50:
v_mov_b32 v10, 16
s_mov_b64 exec, 1
ds_add_u32 v9, v10 offset:12
s_mov_b64 exec, -1
NO_47:
s_lshl_b32 s42, 1, s39
s_or_b32 s42, s42, 16
s_mov_b32 s51, 1600000
LS_51:
ds_read_b32 v10, v9 offset:12
s_waitcnt lgkmcnt(0)
v_readfirstlane_b32 s41, v10
s_nop 0
s_and_b32 s41, s41, s42
s_cmp_ge_u32 s41, s42
s_cbranch_scc1 LD_52
s_sleep 1
s_sub_u32 s51, s51, 1
s_cbranch_scc0 LS_51
LD_52:
s_and_b32 s38, s38, 7
buffer_load_dwordx4 v[40:43], v3, s[16:19], s67 offen offset:0 sc1
buffer_load_dwordx4 v[44:47], v3, s[16:19], s67 offen offset:1024 sc1
buffer_load_dwordx4 v[48:51], v3, s[16:19], s67 offen offset:2048 sc1
buffer_load_dwordx4 v[52:55], v3, s[16:19], s67 offen offset:3072 sc1
buffer_load_dwordx4 v[56:59], v3, s[16:19], s68 offen offset:0 sc1
buffer_load_dwordx4 v[60:63], v3, s[16:19], s68 offen offset:1024 sc1
buffer_load_dwordx4 v[64:67], v3, s[16:19], s68 offen offset:2048 sc1
buffer_load_dwordx4 v[68:71], v3, s[16:19], s68 offen offset:3072 sc1
buffer_load_dwordx4 v[72:75], v3, s[16:19], s69 offen offset:0 sc1
buffer_load_dwordx4 v[76:79], v3, s[16:19], s69 offen offset:1024 sc1
buffer_load_dwordx4 v[80:83], v3, s[16:19], s69 offen offset:2048 sc1
buffer_load_dwordx4 v[84:87], v3, s[16:19], s69 offen offset:3072 sc1
buffer_load_dwordx4 v[88:91], v3, s[16:19], s70 offen offset:0 sc1
buffer_load_dwordx4 v[92:95], v3, s[16:19], s70 offen offset:1024 sc1
buffer_load_dwordx4 v[96:99], v3, s[16:19], s70 offen offset:2048 sc1
buffer_load_dwordx4 v[100:103], v3, s[16:19], s70 offen offset:3072 sc1
s_waitcnt lgkmcnt(0)
s_lshl_b32 s41, s39, 12
v_add_u32 v11, s41, v3
s_waitcnt vmcnt(15)
v_permlane16_swap_b32 v16, v18
v_permlane16_swap_b32 v17, v19
v_permlane16_swap_b32 v20, v22
v_permlane16_swap_b32 v21, v23
v_mfma_f32_16x16x32_bf16 v[24:27], v[104:107], v[40:43], 0
v_mfma_f32_16x16x32_bf16 v[28:31], v[108:111], v[40:43], 0
v_mfma_f32_16x16x32_bf16 v[32:35], v[112:115], v[40:43], 0
v_mfma_f32_16x16x32_bf16 v[36:39], v[116:119], v[40:43], 0
s_waitcnt vmcnt(14)
v_mfma_f32_16x16x32_bf16 v[24:27], v[120:123], v[44:47], v[24:27]
ds_read_b64_tr_b16 v[104:105], v4 offset:36864
ds_read_b64_tr_b16 v[106:107], v4 offset:38912
v_mfma_f32_16x16x32_bf16 v[28:31], v[124:127], v[44:47], v[28:31]
ds_read_b64_tr_b16 v[108:109], v5 offset:36864
ds_read_b64_tr_b16 v[110:111], v5 offset:38912
v_mfma_f32_16x16x32_bf16 v[32:35], v[128:131], v[44:47], v[32:35]
ds_read_b64_tr_b16 v[112:113], v6 offset:36864
ds_read_b64_tr_b16 v[114:115], v6 offset:38912
v_mfma_f32_16x16x32_bf16 v[36:39], v[132:135], v[44:47], v[36:39]
ds_read_b64_tr_b16 v[116:117], v7 offset:36864
ds_read_b64_tr_b16 v[118:119], v7 offset:38912
s_waitcnt vmcnt(13)
v_mfma_f32_16x16x32_bf16 v[24:27], v[136:139], v[48:51], v[24:27]
ds_read_b64_tr_b16 v[120:121], v4 offset:40960
ds_read_b64_tr_b16 v[122:123], v4 offset:43008
v_mfma_f32_16x16x32_bf16 v[28:31], v[140:143], v[48:51], v[28:31]
ds_read_b64_tr_b16 v[124:125], v5 offset:40960
ds_read_b64_tr_b16 v[126:127], v5 offset:43008
v_mfma_f32_16x16x32_bf16 v[32:35], v[144:147], v[48:51], v[32:35]
ds_read_b64_tr_b16 v[128:129], v6 offset:40960
ds_read_b64_tr_b16 v[130:131], v6 offset:43008
v_mfma_f32_16x16x32_bf16 v[36:39], v[148:151], v[48:51], v[36:39]
ds_read_b64_tr_b16 v[132:133], v7 offset:40960
ds_read_b64_tr_b16 v[134:135], v7 offset:43008
s_waitcnt vmcnt(12)
v_mfma_f32_16x16x32_bf16 v[24:27], v[152:155], v[52:55], v[24:27]
ds_read_b64_tr_b16 v[136:137], v4 offset:45056
ds_read_b64_tr_b16 v[138:139], v4 offset:47104
v_mfma_f32_16x16x32_bf16 v[28:31], v[156:159], v[52:55], v[28:31]
ds_read_b64_tr_b16 v[140:141], v5 offset:45056
ds_read_b64_tr_b16 v[142:143], v5 offset:47104
v_mfma_f32_16x16x32_bf16 v[32:35], v[160:163], v[52:55], v[32:35]
ds_read_b64_tr_b16 v[144:145], v6 offset:45056
ds_read_b64_tr_b16 v[146:147], v6 offset:47104
v_mfma_f32_16x16x32_bf16 v[36:39], v[164:167], v[52:55], v[36:39]
ds_read_b64_tr_b16 v[148:149], v7 offset:45056
ds_read_b64_tr_b16 v[150:151], v7 offset:47104
s_waitcnt vmcnt(11)
v_mfma_f32_16x16x32_bf16 v[24:27], v[168:171], v[56:59], v[24:27]
ds_read_b64_tr_b16 v[152:153], v4 offset:49152
ds_read_b64_tr_b16 v[154:155], v4 offset:51200
v_mfma_f32_16x16x32_bf16 v[28:31], v[172:175], v[56:59], v[28:31]
ds_read_b64_tr_b16 v[156:157], v5 offset:49152
ds_read_b64_tr_b16 v[158:159], v5 offset:51200
v_mfma_f32_16x16x32_bf16 v[32:35], v[176:179], v[56:59], v[32:35]
ds_read_b64_tr_b16 v[160:161], v6 offset:49152
ds_read_b64_tr_b16 v[162:163], v6 offset:51200
v_mfma_f32_16x16x32_bf16 v[36:39], v[180:183], v[56:59], v[36:39]
ds_read_b64_tr_b16 v[164:165], v7 offset:49152
ds_read_b64_tr_b16 v[166:167], v7 offset:51200
s_waitcnt vmcnt(10)
v_mfma_f32_16x16x32_bf16 v[24:27], v[184:187], v[60:63], v[24:27]
ds_read_b64_tr_b16 v[168:169], v4 offset:53248
ds_read_b64_tr_b16 v[170:171], v4 offset:55296
v_mfma_f32_16x16x32_bf16 v[28:31], v[188:191], v[60:63], v[28:31]
ds_read_b64_tr_b16 v[172:173], v5 offset:53248
ds_read_b64_tr_b16 v[174:175], v5 offset:55296
v_mfma_f32_16x16x32_bf16 v[32:35], v[192:195], v[60:63], v[32:35]
ds_read_b64_tr_b16 v[176:177], v6 offset:53248
ds_read_b64_tr_b16 v[178:179], v6 offset:55296
WS_7392:
s_cbranch_execz K_wret
s_nop 0
v_mfma_f32_16x16x32_bf16 v[36:39], v[196:199], v[60:63], v[36:39]
ds_read_b64_tr_b16 v[180:181], v7 offset:53248
ds_read_b64_tr_b16 v[182:183], v7 offset:55296
s_waitcnt vmcnt(9)
v_mfma_f32_16x16x32_bf16 v[24:27], v[200:203], v[64:67], v[24:27]
ds_read_b64_tr_b16 v[184:185], v4 offset:57344
ds_read_b64_tr_b16 v[186:187], v4 offset:59392
v_mfma_f32_16x16x32_bf16 v[28:31], v[204:207], v[64:67], v[28:31]
ds_read_b64_tr_b16 v[188:189], v5 offset:57344
ds_read_b64_tr_b16 v[190:191], v5 offset:59392
v_mfma_f32_16x16x32_bf16 v[32:35], v[208:211], v[64:67], v[32:35]
ds_read_b64_tr_b16 v[192:193], v6 offset:57344
ds_read_b64_tr_b16 v[194:195], v6 offset:59392
v_mfma_f32_16x16x32_bf16 v[36:39], v[212:215], v[64:67], v[36:39]
ds_read_b64_tr_b16 v[196:197], v7 offset:57344
ds_read_b64_tr_b16 v[198:199], v7 offset:59392
s_waitcnt vmcnt(8)
v_mfma_f32_16x16x32_bf16 v[24:27], v[216:219], v[68:71], v[24:27]
ds_read_b64_tr_b16 v[200:201], v4 offset:61440
ds_read_b64_tr_b16 v[202:203], v4 offset:63488
v_mfma_f32_16x16x32_bf16 v[28:31], v[220:223], v[68:71], v[28:31]
ds_read_b64_tr_b16 v[204:205], v5 offset:61440
ds_read_b64_tr_b16 v[206:207], v5 offset:63488
v_mfma_f32_16x16x32_bf16 v[32:35], v[224:227], v[68:71], v[32:35]
ds_read_b64_tr_b16 v[208:209], v6 offset:61440
ds_read_b64_tr_b16 v[210:211], v6 offset:63488
v_mfma_f32_16x16x32_bf16 v[36:39], v[228:231], v[68:71], v[36:39]
ds_read_b64_tr_b16 v[212:213], v7 offset:61440
ds_read_b64_tr_b16 v[214:215], v7 offset:63488
s_waitcnt vmcnt(7)
v_mfma_f32_16x16x32_bf16 v[24:27], v[232:235], v[72:75], v[24:27]
v_mfma_f32_16x16x32_bf16 v[28:31], v[236:239], v[72:75], v[28:31]
v_mfma_f32_16x16x32_bf16 v[32:35], v[240:243], v[72:75], v[32:35]
v_mfma_f32_16x16x32_bf16 v[36:39], v[244:247], v[72:75], v[36:39]
v_lshlrev_b32 v40, 16, v16
v_and_b32 v41, 0xffff0000, v16
s_waitcnt vmcnt(6)
s_waitcnt lgkmcnt(8)
v_mfma_f32_16x16x32_bf16 v[24:27], v[104:107], v[76:79], v[24:27]
v_mfma_f32_16x16x32_bf16 v[28:31], v[108:111], v[76:79], v[28:31]
v_mfma_f32_16x16x32_bf16 v[32:35], v[112:115], v[76:79], v[32:35]
v_mfma_f32_16x16x32_bf16 v[36:39], v[116:119], v[76:79], v[36:39]
v_lshlrev_b32_e64 v42, 16, v17
v_and_b32 v43, 0xffff0000, v17
s_waitcnt vmcnt(5)
v_mfma_f32_16x16x32_bf16 v[24:27], v[120:123], v[80:83], v[24:27]
v_mfma_f32_16x16x32_bf16 v[28:31], v[124:127], v[80:83], v[28:31]
v_mfma_f32_16x16x32_bf16 v[32:35], v[128:131], v[80:83], v[32:35]
v_mfma_f32_16x16x32_bf16 v[36:39], v[132:135], v[80:83], v[36:39]
v_lshlrev_b32 v44, 16, v18
v_and_b32 v45, 0xffff0000, v18
s_waitcnt vmcnt(4)
v_mfma_f32_16x16x32_bf16 v[24:27], v[136:139], v[84:87], v[24:27]
v_mfma_f32_16x16x32_bf16 v[28:31], v[140:143], v[84:87], v[28:31]
v_mfma_f32_16x16x32_bf16 v[32:35], v[144:147], v[84:87], v[32:35]
v_mfma_f32_16x16x32_bf16 v[36:39], v[148:151], v[84:87], v[36:39]
v_lshlrev_b32 v46, 16, v19
v_and_b32 v47, 0xffff0000, v19
s_waitcnt vmcnt(3)
v_mfma_f32_16x16x32_bf16 v[24:27], v[152:155], v[88:91], v[24:27]
v_mfma_f32_16x16x32_bf16 v[28:31], v[156:159], v[88:91], v[28:31]
v_mfma_f32_16x16x32_bf16 v[32:35], v[160:163], v[88:91], v[32:35]
v_mfma_f32_16x16x32_bf16 v[36:39], v[164:167], v[88:91], v[36:39]
v_lshlrev_b32 v48, 16, v20
v_and_b32 v49, 0xffff0000, v20
s_waitcnt vmcnt(2)
v_mfma_f32_16x16x32_bf16 v[24:27], v[168:171], v[92:95], v[24:27]
v_mfma_f32_16x16x32_bf16 v[28:31], v[172:175], v[92:95], v[28:31]
v_mfma_f32_16x16x32_bf16 v[32:35], v[176:179], v[92:95], v[32:35]
v_mfma_f32_16x16x32_bf16 v[36:39], v[180:183], v[92:95], v[36:39]
v_lshlrev_b32 v50, 16, v21
v_and_b32 v51, 0xffff0000, v21
s_waitcnt vmcnt(1)
v_mfma_f32_16x16x32_bf16 v[24:27], v[184:187], v[96:99], v[24:27]
v_mfma_f32_16x16x32_bf16 v[28:31], v[188:191], v[96:99], v[28:31]
v_mfma_f32_16x16x32_bf16 v[32:35], v[192:195], v[96:99], v[32:35]
v_mfma_f32_16x16x32_bf16 v[36:39], v[196:199], v[96:99], v[36:39]
v_lshlrev_b32 v52, 16, v22
v_and_b32 v53, 0xffff0000, v22
s_waitcnt vmcnt(0)
s_waitcnt lgkmcnt(6)
v_mfma_f32_16x16x32_bf16 v[24:27], v[200:203], v[100:103], v[24:27]
s_waitcnt lgkmcnt(4)
v_mfma_f32_16x16x32_bf16 v[28:31], v[204:207], v[100:103], v[28:31]
s_waitcnt lgkmcnt(2)
v_mfma_f32_16x16x32_bf16 v[32:35], v[208:211], v[100:103], v[32:35]
s_waitcnt lgkmcnt(0)
v_mfma_f32_16x16x32_bf16 v[36:39], v[212:215], v[100:103], v[36:39]
v_lshlrev_b32 v54, 16, v23
v_and_b32 v55, 0xffff0000, v23
s_barrier
ds_read_b128 v[56:59], v11 offset:0
ds_read_b128 v[60:63], v11 offset:1024
ds_read_b128 v[64:67], v11 offset:2048
ds_read_b128 v[68:71], v11 offset:3072
s_waitcnt lgkmcnt(2)
v_pk_fma_f32 v[56:57], v[56:57], v[24:25], v[40:41]
v_pk_fma_f32 v[58:59], v[58:59], v[26:27], v[42:43]
v_pk_fma_f32 v[60:61], v[60:61], v[28:29], v[44:45]
v_pk_fma_f32 v[62:63], v[62:63], v[30:31], v[46:47]
v_cvt_pk_bf16_f32 v16, v56, v57
v_cvt_pk_bf16_f32 v17, v58, v59
v_cvt_pk_bf16_f32 v18, v60, v61
v_cvt_pk_bf16_f32 v19, v62, v63
s_waitcnt lgkmcnt(0)
s_nop 0
v_pk_fma_f32 v[64:65], v[64:65], v[32:33], v[48:49]
v_pk_fma_f32 v[66:67], v[66:67], v[34:35], v[50:51]
v_pk_fma_f32 v[68:69], v[68:69], v[36:37], v[52:53]
v_pk_fma_f32 v[70:71], v[70:71], v[38:39], v[54:55]
v_cvt_pk_bf16_f32 v20, v64, v65
v_cvt_pk_bf16_f32 v21, v66, v67
v_cvt_pk_bf16_f32 v22, v68, v69
v_cvt_pk_bf16_f32 v23, v70, v71
v_permlane16_swap_b32 v16, v18
v_permlane16_swap_b32 v17, v19
v_permlane16_swap_b32 v20, v22
v_permlane16_swap_b32 v21, v23
buffer_store_dwordx4 v[16:19], v8, s[28:31], s66 offen offset:0 sc1
buffer_store_dwordx4 v[20:23], v8, s[28:31], s66 offen offset:64 sc1
K_end:
K_done:
s_endpgm
.section .rodata,"a"
.p2align 6
.amdhsa_kernel recurrent_scan__linear_kernel_hedgehog__dense_activation_silu__prompt_kernel
  .amdhsa_next_free_vgpr 256
  .amdhsa_next_free_sgpr 102
  .amdhsa_accum_offset 256
  .amdhsa_group_segment_fixed_size 0
  .amdhsa_kernarg_size 80
  .amdhsa_user_sgpr_count 2
  .amdhsa_user_sgpr_kernarg_segment_ptr 1
  .amdhsa_system_sgpr_workgroup_id_x 1
.end_amdhsa_kernel
```
